```python
import torch

def _softmax(x, axis=-1):
    return torch.softmax(x, dim=axis)
def _gelu(x):
    return torch.nn.functional.gelu(x, approximate="tanh")
def _silu(x):
    return torch.nn.functional.silu(x)
def _sigmoid(x):
    return torch.sigmoid(x)
def _layernorm(x, axis=-1, eps=1e-5):
    m = x.mean(dim=axis, keepdim=True)
    v = x.var(dim=axis, keepdim=True, unbiased=False)
    return (x - m) / torch.sqrt(v + eps)
def _scatter_add(tgt, idx, src, axis=0):
    return tgt.clone().index_add_(axis, idx, src)
def _segment_sum(src, seg, n):
    out = torch.zeros((n,) + src.shape[1:], dtype=src.dtype)
    return out.index_add_(0, seg, src)
def _pad(x, pw):
    flat = tuple(v for pair in reversed(pw) for v in pair)
    return torch.nn.functional.pad(x, flat)

kernel_name = 'concat_heads__compressed_kv_cla__spectral_gfnet__prompt'

def setup_inputs():

    _w = (lambda a: (lambda t: t.to(torch.bfloat16) if t.is_floating_point() else t)(torch.as_tensor(a)))
    def _A_setup():
        B, H, Sq, Sk, D, M = 1, 32, 2048, 2048, 128, 576
        Dc = 4 * D
        return {
            "x": _w((lambda *s: torch.randn(*s, dtype=torch.bfloat16) * 3.2)(B, Sq, M)),
            "c_kv": _w((lambda *s: torch.randn(*s, dtype=torch.bfloat16) * 0.05)(B, Sk, Dc)),
            "w_q": _w((lambda *s: torch.randn(*s, dtype=torch.bfloat16) * 3.2)(M, H, D) * (M ** -0.5)),
            "w_uk": _w((lambda *s: torch.randn(*s, dtype=torch.bfloat16) * 3.2)(Dc, H, D) * (Dc ** -0.5)),
            "w_uv": _w((lambda *s: torch.randn(*s, dtype=torch.bfloat16) * 0.05)(Dc, H, D) * (Dc ** -0.5)),
            "w_o": _w((lambda *s: torch.randn(*s, dtype=torch.bfloat16) * 0.05)(H, D, M) * ((H * D) ** -0.5)),
        }
    _A_in = _A_setup()

    def _B_setup():
        B, S, D = 1, 2048, 576
        Df = D // 2 + 1
        return {
            "x": _w((lambda *s: torch.randn(*s, dtype=torch.bfloat16) * 0.05)(B, S, D)),
            "w_r": _w((lambda *s: torch.randn(*s, dtype=torch.bfloat16) * 0.05)(S, Df) * 0.02),
            "w_i": _w((lambda *s: torch.randn(*s, dtype=torch.bfloat16) * 0.05)(S, Df) * 0.02),
        }
    _B_in = _B_setup()

    return {
        "A_x": _A_in["x"],
        "A_c_kv": _A_in["c_kv"],
        "A_w_q": _A_in["w_q"],
        "A_w_uk": _A_in["w_uk"],
        "A_w_uv": _A_in["w_uv"],
        "A_w_o": _A_in["w_o"],
        "B_x": _B_in["x"],
        "B_w_r": _B_in["w_r"],
        "B_w_i": _B_in["w_i"],
    }

def reference(A_x, A_c_kv, A_w_q, A_w_uk, A_w_uv, A_w_o, B_x, B_w_r, B_w_i):
    def _A_ref(x, c_kv, w_q, w_uk, w_uv, w_o):
        B, Sq, M = x.shape[0], x.shape[1], x.shape[2]
        Sk = c_kv.shape[1]
        H, D = w_q.shape[1], w_q.shape[2]
        q = torch.einsum("bqm,mhd->bhqd", x, w_q)
        k = torch.einsum("bkc,chd->bhkd", c_kv, w_uk)
        v = torch.einsum("bkc,chd->bhkd", c_kv, w_uv)
        scores = torch.einsum("bhqd,bhkd->bhqk", q, k) * (D ** -0.5)
        off = Sk - Sq
        qi = torch.arange(Sq)[:, None]
        kj = torch.arange(Sk)[None, :]
        cmask = kj <= (qi + off)
        scores = torch.where(cmask[None, None], scores, -1e9)
        p = _softmax(scores, axis=-1)
        ctx = torch.einsum("bhqk,bhkd->bhqd", p, v)
        return torch.einsum("bhqd,hdm->bqm", ctx, w_o)

    def _B_ref(x, w_r, w_i):
        B, S, D = x.shape
        X = (lambda x, axes=(-2,-1): torch.fft.rfft2(x.float(), dim=axes))(x, axes=(-2, -1))
        W = w_r + 1j * w_i
        X = X * W
        y = (lambda x, s, axes=(-2,-1): torch.fft.irfft2(x, s=s, dim=axes).to(torch.bfloat16))(X, (S, D), axes=(-2, -1))
        return y

    a = _A_ref(A_x, A_c_kv, A_w_q, A_w_uk, A_w_uv, A_w_o)
    b = _B_ref(B_x, B_w_r, B_w_i)
    return torch.concatenate([a, b], axis=-1)
```

```asm
; @launch kernel=qkv_kernel grid=(256,1,1) block=(512,1,1) lds=163840
; @launch kernel=attn_kernel grid=(256,1,1) block=(512,1,1) lds=163840
; @launch kernel=oproj_kernel grid=(256,1,1) block=(512,1,1) lds=163840
.amdgcn_target "amdgcn-amd-amdhsa--gfx950"
.text
.globl qkv_kernel
.p2align 8
.type qkv_kernel,@function
qkv_kernel:
    s_cmp_ge_u32 s2, 256
    s_cbranch_scc1 L_qkv_end
    s_load_dwordx4 s[24:27], s[0:1], 0
    s_load_dwordx4 s[28:31], s[0:1], 16
    s_load_dwordx2 s[32:33], s[0:1], 32
    s_load_dwordx2 s[34:35], s[0:1], 88
    v_and_b32 v1, 63, v0
    v_lshrrev_b32 v18, 6, v0
    s_nop 1
    v_readfirstlane_b32 s40, v18
    s_and_b32 s41, s2, 7
    s_lshl_b32 s41, s41, 2
    s_lshr_b32 s47, s2, 3
    s_and_b32 s47, s47, 3
    s_add_u32 s41, s41, s47
    s_lshr_b32 s42, s2, 5
    s_lshr_b32 s43, s40, 1
    s_and_b32 s44, s40, 1
    s_lshl_b32 s45, s40, 11
    s_lshl_b32 s46, s40, 10
    s_add_u32 s46, s46, 98304
    s_waitcnt lgkmcnt(0)
    s_mov_b32 s4, s24
    s_and_b32 s5, s25, 0xffff
    s_mov_b32 s6, 2359296
    s_mov_b32 s7, 0x00020000
    s_mov_b32 s8, s26
    s_and_b32 s9, s27, 0xffff
    s_mov_b32 s10, 2097152
    s_mov_b32 s11, 0x00020000
    s_mov_b32 s12, s28
    s_and_b32 s13, s29, 0xffff
    s_mov_b32 s14, 4718592
    s_mov_b32 s15, 0x00020000
    s_mov_b32 s16, s30
    s_and_b32 s17, s31, 0xffff
    s_mov_b32 s18, 4194304
    s_mov_b32 s19, 0x00020000
    s_mov_b32 s20, s32
    s_and_b32 s21, s33, 0xffff
    s_mov_b32 s22, 4194304
    s_mov_b32 s23, 0x00020000
    s_lshl_b32 s47, s42, 8
    s_lshl_b32 s48, s40, 4
    s_add_u32 s47, s47, s48
    v_bfe_u32 v19, v1, 4, 2
    v_and_b32 v20, 7, v1
    v_xor_b32 v19, v19, v20
    v_lshrrev_b32 v18, 3, v1
    v_add_u32 v18, s47, v18
    v_add_u32 v18, 0, v18
    v_mul_u32_u24 v21, 1152, v18
    v_lshl_add_u32 v21, v19, 4, v21
    v_subrev_u32 v2, 0, v21
    v_lshlrev_b32 v21, 10, v18
    v_lshl_add_u32 v21, v19, 4, v21
    v_subrev_u32 v4, 0, v21
    v_bfe_u32 v19, v1, 4, 2
    v_or_b32 v19, 4, v19
    v_and_b32 v20, 7, v1
    v_xor_b32 v19, v19, v20
    v_lshrrev_b32 v18, 3, v1
    v_add_u32 v18, s47, v18
    v_add_u32 v18, 8, v18
    v_mul_u32_u24 v21, 1152, v18
    v_lshl_add_u32 v21, v19, 4, v21
    v_subrev_u32 v3, 1024, v21
    v_lshlrev_b32 v21, 10, v18
    v_lshl_add_u32 v21, v19, 4, v21
    v_subrev_u32 v5, 1024, v21
    s_lshl_b32 s47, s40, 2
    s_lshl_b32 s48, s41, 8
    v_lshrrev_b32 v18, 4, v1
    v_lshlrev_b32 v19, 2, v18
    v_add_u32 v18, s47, v18
    v_lshlrev_b32 v18, 13, v18
    v_and_b32 v20, 15, v1
    v_xor_b32 v19, v19, v20
    v_lshl_add_u32 v18, v19, 4, v18
    v_add_u32 v6, s48, v18
    s_add_u32 m0, s45, 0
    s_mov_b32 s47, 0
    buffer_load_dwordx4 v2, s[4:7], s47 offen offset:0 lds
    buffer_load_dwordx4 v3, s[4:7], s47 offen offset:1024 lds
    s_add_u32 m0, s45, 16384
    s_mov_b32 s47, 147456
    buffer_load_dwordx4 v2, s[4:7], s47 offen offset:0 lds
    buffer_load_dwordx4 v3, s[4:7], s47 offen offset:1024 lds
    s_add_u32 m0, s46, 0
    s_mov_b32 s48, 0
    buffer_load_dwordx4 v6, s[12:15], s48 offen lds
    s_add_u32 m0, s46, 16384
    s_mov_b32 s48, 262144
    buffer_load_dwordx4 v6, s[12:15], s48 offen lds
    s_add_u32 m0, s45, 32768
    s_mov_b32 s47, 128
    buffer_load_dwordx4 v2, s[4:7], s47 offen offset:0 lds
    buffer_load_dwordx4 v3, s[4:7], s47 offen offset:1024 lds
    s_add_u32 m0, s45, 49152
    s_mov_b32 s47, 147584
    buffer_load_dwordx4 v2, s[4:7], s47 offen offset:0 lds
    buffer_load_dwordx4 v3, s[4:7], s47 offen offset:1024 lds
    s_add_u32 m0, s46, 32768
    s_mov_b32 s48, 524288
    buffer_load_dwordx4 v6, s[12:15], s48 offen lds
    v_and_b32 v18, 31, v1
    v_lshrrev_b32 v19, 1, v18
    v_and_b32 v19, 7, v19
    s_lshl_b32 s47, s43, 6
    v_add_u32 v18, s47, v18
    v_lshlrev_b32 v18, 7, v18
    v_lshrrev_b32 v20, 5, v1
    v_add_u32 v21, 0, v20
    v_xor_b32 v21, v21, v19
    v_lshl_add_u32 v8, v21, 4, v18
    v_add_u32 v12, 0x10000, v8
    v_add_u32 v21, 2, v20
    v_xor_b32 v21, v21, v19
    v_lshl_add_u32 v9, v21, 4, v18
    v_add_u32 v13, 0x10000, v9
    v_add_u32 v21, 4, v20
    v_xor_b32 v21, v21, v19
    v_lshl_add_u32 v10, v21, 4, v18
    v_add_u32 v14, 0x10000, v10
    v_add_u32 v21, 6, v20
    v_xor_b32 v21, v21, v19
    v_lshl_add_u32 v11, v21, 4, v18
    v_add_u32 v15, 0x10000, v11
    v_lshrrev_b32 v18, 5, v1
    v_lshlrev_b32 v18, 3, v18
    v_bfe_u32 v19, v1, 2, 2
    v_add_u32 v18, v18, v19
    v_lshlrev_b32 v18, 8, v18
    v_bfe_u32 v20, v1, 4, 1
    v_lshl_add_u32 v18, v20, 5, v18
    v_and_b32 v20, 3, v1
    v_lshl_add_u32 v18, v20, 3, v18
    v_add_u32 v18, 98304, v18
    s_lshl_b32 s47, s44, 1
    v_mov_b32 v20, s47
    v_xor_b32 v20, v20, v19
    v_lshl_add_u32 v16, v20, 6, v18
    v_mov_b32 v20, s47
    v_add_u32 v20, 1, v20
    v_xor_b32 v20, v20, v19
    v_lshl_add_u32 v17, v20, 6, v18
    s_cmp_lt_u32 s2, 96
    s_cbranch_scc1 L_qkv_b1
    s_load_dwordx4 s[60:63], s[0:1], 56
    s_load_dwordx2 s[64:65], s[0:1], 88
    s_sub_u32 s66, s2, 96
    s_lshl_b32 s66, s66, 9
    s_waitcnt lgkmcnt(0)
    s_mov_b32 s80, s60
    s_and_b32 s81, s61, 0xffff
    s_mov_b32 s82, 1183744
    s_mov_b32 s83, 0x00020000
    s_mov_b32 s84, s62
    s_and_b32 s85, s63, 0xffff
    s_mov_b32 s86, 1183744
    s_mov_b32 s87, 0x00020000
    s_add_u32 s88, s64, 88080384
    s_addc_u32 s89, s65, 0
    s_and_b32 s89, s89, 0xffff
    s_mov_b32 s90, 2621440
    s_mov_b32 s91, 0x00020000
    s_mov_b32 s67, 429496730
    v_add_u32 v220, s66, v0
    v_and_b32 v244, 1, v220
    v_bfe_u32 v245, v220, 1, 6
    v_bfe_u32 v221, v220, 7, 1
    v_lshrrev_b32 v247, 8, v220
    v_mul_hi_u32 v248, v247, s67
    v_mul_u32_u24 v249, 10, v248
    v_sub_u32 v249, v247, v249
    v_cmp_le_u32 vcc, 5, v249
    v_mov_b32 v250, 0
    v_mov_b32 v251, 1
    v_cndmask_b32 v250, v250, v251, vcc
    v_mul_u32_u24 v251, 5, v250
    v_sub_u32 v249, v249, v251
    v_and_b32 v251, 31, v245
    v_lshl_add_u32 v249, v249, 5, v251
    v_lshl_add_u32 v249, v249, 1, v250
    v_lshrrev_b32 v251, 5, v245
    v_lshlrev_b32 v251, 2, v251
    v_lshl_add_u32 v251, v244, 4, v251
    v_lshl_add_u32 v251, v251, 6, v248
    v_mul_u32_u24 v251, 578, v251
    v_lshl_add_u32 v251, v249, 1, v251
    v_cmp_lt_u32 vcc, 288, v249
    v_mov_b32 v250, 0x7fffffff
    s_nop 0
    v_cndmask_b32 v251, v251, v250, vcc
    s_mov_b32 s68, 0
    buffer_load_ushort v204, v251, s[80:83], s68 offen
    buffer_load_ushort v212, v251, s[84:87], s68 offen
    s_mov_b32 s68, 36992
    buffer_load_ushort v205, v251, s[80:83], s68 offen
    buffer_load_ushort v213, v251, s[84:87], s68 offen
    s_mov_b32 s68, 73984
    buffer_load_ushort v206, v251, s[80:83], s68 offen
    buffer_load_ushort v214, v251, s[84:87], s68 offen
    s_mov_b32 s68, 110976
    buffer_load_ushort v207, v251, s[80:83], s68 offen
    buffer_load_ushort v215, v251, s[84:87], s68 offen
    s_mov_b32 s68, 295936
    buffer_load_ushort v208, v251, s[80:83], s68 offen
    buffer_load_ushort v216, v251, s[84:87], s68 offen
    s_mov_b32 s68, 332928
    buffer_load_ushort v209, v251, s[80:83], s68 offen
    buffer_load_ushort v217, v251, s[84:87], s68 offen
    s_mov_b32 s68, 369920
    buffer_load_ushort v210, v251, s[80:83], s68 offen
    buffer_load_ushort v218, v251, s[84:87], s68 offen
    s_mov_b32 s68, 406912
    buffer_load_ushort v211, v251, s[80:83], s68 offen
    buffer_load_ushort v219, v251, s[84:87], s68 offen
    v_add_u32 v240, s66, v0
    v_add_u32 v240, 81920, v240
    v_and_b32 v244, 1, v240
    v_bfe_u32 v245, v240, 1, 6
    v_bfe_u32 v241, v240, 7, 1
    v_lshrrev_b32 v247, 8, v240
    v_mul_hi_u32 v248, v247, s67
    v_mul_u32_u24 v249, 10, v248
    v_sub_u32 v249, v247, v249
    v_cmp_le_u32 vcc, 5, v249
    v_mov_b32 v250, 0
    v_mov_b32 v251, 1
    v_cndmask_b32 v250, v250, v251, vcc
    v_mul_u32_u24 v251, 5, v250
    v_sub_u32 v249, v249, v251
    v_and_b32 v251, 31, v245
    v_lshl_add_u32 v249, v249, 5, v251
    v_lshl_add_u32 v249, v249, 1, v250
    v_lshrrev_b32 v251, 5, v245
    v_lshlrev_b32 v251, 2, v251
    v_lshl_add_u32 v251, v244, 4, v251
    v_lshl_add_u32 v251, v251, 6, v248
    v_mul_u32_u24 v251, 578, v251
    v_lshl_add_u32 v251, v249, 1, v251
    v_cmp_lt_u32 vcc, 288, v249
    v_mov_b32 v250, 0x7fffffff
    s_nop 0
    v_cndmask_b32 v251, v251, v250, vcc
    s_mov_b32 s68, 0
    buffer_load_ushort v224, v251, s[80:83], s68 offen
    buffer_load_ushort v232, v251, s[84:87], s68 offen
    s_mov_b32 s68, 36992
    buffer_load_ushort v225, v251, s[80:83], s68 offen
    buffer_load_ushort v233, v251, s[84:87], s68 offen
    s_mov_b32 s68, 73984
    buffer_load_ushort v226, v251, s[80:83], s68 offen
    buffer_load_ushort v234, v251, s[84:87], s68 offen
    s_mov_b32 s68, 110976
    buffer_load_ushort v227, v251, s[80:83], s68 offen
    buffer_load_ushort v235, v251, s[84:87], s68 offen
    s_mov_b32 s68, 295936
    buffer_load_ushort v228, v251, s[80:83], s68 offen
    buffer_load_ushort v236, v251, s[84:87], s68 offen
    s_mov_b32 s68, 332928
    buffer_load_ushort v229, v251, s[80:83], s68 offen
    buffer_load_ushort v237, v251, s[84:87], s68 offen
    s_mov_b32 s68, 369920
    buffer_load_ushort v230, v251, s[80:83], s68 offen
    buffer_load_ushort v238, v251, s[84:87], s68 offen
    s_mov_b32 s68, 406912
    buffer_load_ushort v231, v251, s[80:83], s68 offen
    buffer_load_ushort v239, v251, s[84:87], s68 offen
    s_load_dwordx2 s[92:93], s[0:1], 88
    s_sub_u32 s96, s2, 96
    s_lshl_b32 s96, s96, 9
    v_add_u32 v76, s96, v0
    v_lshlrev_b32 v77, 1, v76
    v_lshlrev_b32 v78, 2, v76
    s_waitcnt lgkmcnt(0)
    s_add_u32 s24, s92, 85983232
    s_addc_u32 s25, s93, 0
    s_and_b32 s25, s25, 0xffff
    s_mov_b32 s26, 368640
    s_mov_b32 s27, 0x00020000
    s_add_u32 s28, s92, 87031808
    s_addc_u32 s29, s93, 0
    s_and_b32 s29, s29, 0xffff
    s_mov_b32 s30, 368640
    s_mov_b32 s31, 0x00020000
    s_mov_b32 s94, 7456541
    s_mov_b32 s95, 0x3ae38e39
    s_mov_b32 s96, 119304648
    s_mov_b32 s97, 429496730
    v_lshrrev_b32 v72, 9, v77
    v_bfe_u32 v73, v77, 3, 5
    v_bfe_u32 v74, v77, 8, 1
    v_and_b32 v75, 7, v77
    v_lshrrev_b32 v59, 1, v72
    v_mul_hi_u32 v56, v59, s97
    v_mul_u32_u24 v57, 10, v56
    v_sub_u32 v57, v59, v57
    v_lshl_add_u32 v56, v56, 5, v73
    v_cmp_le_u32 vcc, 5, v57
    v_mov_b32 v61, 0
    v_mov_b32 v62, 1
    v_cndmask_b32 v61, v61, v62, vcc
    v_mul_u32_u24 v62, 5, v61
    v_sub_u32 v57, v57, v62
    v_lshlrev_b32 v57, 5, v57
    v_and_b32 v59, 1, v72
    v_lshl_add_u32 v57, v59, 4, v57
    v_lshl_add_u32 v57, v74, 2, v57
    v_bfe_u32 v59, v75, 2, 1
    v_lshl_add_u32 v57, v59, 3, v57
    v_and_b32 v59, 3, v75
    v_add_u32 v57, v57, v59
    v_lshl_add_u32 v57, v57, 1, v61
    v_add_u32 v58, 2, v57
    v_mul_u32_u24 v60, v57, v56
    v_mul_hi_u32 v61, v60, s94
    v_mul_u32_u24 v61, 576, v61
    v_sub_u32 v60, v60, v61
    v_cvt_f32_u32 v60, v60
    v_mul_f32 v60, s95, v60
    v_mul_u32_u24 v62, v58, v56
    v_mul_hi_u32 v63, v62, s94
    v_mul_u32_u24 v63, 576, v63
    v_sub_u32 v62, v62, v63
    v_cvt_f32_u32 v62, v62
    v_mul_f32 v62, s95, v62
    v_cos_f32 v64, v60
    v_cos_f32 v65, v62
    v_sin_f32 v66, v60
    v_sin_f32 v67, v62
    v_mov_b32 v68, 0x35e38e39
    v_mov_b32 v69, 0xb5e38e39
    v_mov_b32 v70, 0x35638e39
    v_cmp_eq_u32 vcc, 0, v57
    s_nop 1
    v_cndmask_b32 v68, v68, v70, vcc
    v_cndmask_b32 v69, v69, 0, vcc
    v_cmp_eq_u32 vcc, 288, v57
    s_nop 1
    v_cndmask_b32 v68, v68, v70, vcc
    v_cmp_le_u32 vcc, 288, v57
    s_nop 1
    v_cndmask_b32 v69, v69, 0, vcc
    v_cmp_lt_u32 vcc, 288, v57
    s_nop 1
    v_cndmask_b32 v68, v68, 0, vcc
    v_mul_f32 v64, v64, v68
    v_mul_f32 v66, v66, v69
    v_mov_b32 v68, 0x35e38e39
    v_mov_b32 v69, 0xb5e38e39
    v_mov_b32 v70, 0x35638e39
    v_cmp_eq_u32 vcc, 0, v58
    s_nop 1
    v_cndmask_b32 v68, v68, v70, vcc
    v_cndmask_b32 v69, v69, 0, vcc
    v_cmp_eq_u32 vcc, 288, v58
    s_nop 1
    v_cndmask_b32 v68, v68, v70, vcc
    v_cmp_le_u32 vcc, 288, v58
    s_nop 1
    v_cndmask_b32 v69, v69, 0, vcc
    v_cmp_lt_u32 vcc, 288, v58
    s_nop 1
    v_cndmask_b32 v68, v68, 0, vcc
    v_mul_f32 v65, v65, v68
    v_mul_f32 v67, v67, v69
    v_cvt_pk_bf16_f32 v64, v64, v65
    v_cvt_pk_bf16_f32 v66, v66, v67
    buffer_store_dword v64, v78, s[24:27], 0 offen
    buffer_store_dword v66, v78, s[28:31], 0 offen
    s_load_dwordx2 s[92:93], s[0:1], 88
    s_sub_u32 s96, s2, 96
    s_lshl_b32 s96, s96, 9
    v_add_u32 v76, s96, v0
    v_add_u32 v76, 81920, v76
    v_lshlrev_b32 v77, 1, v76
    v_lshlrev_b32 v78, 2, v76
    s_waitcnt lgkmcnt(0)
    s_add_u32 s24, s92, 85983232
    s_addc_u32 s25, s93, 0
    s_and_b32 s25, s25, 0xffff
    s_mov_b32 s26, 368640
    s_mov_b32 s27, 0x00020000
    s_add_u32 s28, s92, 87031808
    s_addc_u32 s29, s93, 0
    s_and_b32 s29, s29, 0xffff
    s_mov_b32 s30, 368640
    s_mov_b32 s31, 0x00020000
    s_mov_b32 s94, 7456541
    s_mov_b32 s95, 0x3ae38e39
    s_mov_b32 s96, 119304648
    s_mov_b32 s97, 429496730
    v_lshrrev_b32 v72, 9, v77
    v_bfe_u32 v73, v77, 3, 5
    v_bfe_u32 v74, v77, 8, 1
    v_and_b32 v75, 7, v77
    v_lshrrev_b32 v59, 1, v72
    v_mul_hi_u32 v56, v59, s97
    v_mul_u32_u24 v57, 10, v56
    v_sub_u32 v57, v59, v57
    v_lshl_add_u32 v56, v56, 5, v73
    v_cmp_le_u32 vcc, 5, v57
    v_mov_b32 v61, 0
    v_mov_b32 v62, 1
    v_cndmask_b32 v61, v61, v62, vcc
    v_mul_u32_u24 v62, 5, v61
    v_sub_u32 v57, v57, v62
    v_lshlrev_b32 v57, 5, v57
    v_and_b32 v59, 1, v72
    v_lshl_add_u32 v57, v59, 4, v57
    v_lshl_add_u32 v57, v74, 2, v57
    v_bfe_u32 v59, v75, 2, 1
    v_lshl_add_u32 v57, v59, 3, v57
    v_and_b32 v59, 3, v75
    v_add_u32 v57, v57, v59
    v_lshl_add_u32 v57, v57, 1, v61
    v_add_u32 v58, 2, v57
    v_mul_u32_u24 v60, v57, v56
    v_mul_hi_u32 v61, v60, s94
    v_mul_u32_u24 v61, 576, v61
    v_sub_u32 v60, v60, v61
    v_cvt_f32_u32 v60, v60
    v_mul_f32 v60, s95, v60
    v_mul_u32_u24 v62, v58, v56
    v_mul_hi_u32 v63, v62, s94
    v_mul_u32_u24 v63, 576, v63
    v_sub_u32 v62, v62, v63
    v_cvt_f32_u32 v62, v62
    v_mul_f32 v62, s95, v62
    v_cos_f32 v64, v60
    v_cos_f32 v65, v62
    v_sin_f32 v66, v60
    v_sin_f32 v67, v62
    v_mov_b32 v68, 0x35e38e39
    v_mov_b32 v69, 0xb5e38e39
    v_mov_b32 v70, 0x35638e39
    v_cmp_eq_u32 vcc, 0, v57
    s_nop 1
    v_cndmask_b32 v68, v68, v70, vcc
    v_cndmask_b32 v69, v69, 0, vcc
    v_cmp_eq_u32 vcc, 288, v57
    s_nop 1
    v_cndmask_b32 v68, v68, v70, vcc
    v_cmp_le_u32 vcc, 288, v57
    s_nop 1
    v_cndmask_b32 v69, v69, 0, vcc
    v_cmp_lt_u32 vcc, 288, v57
    s_nop 1
    v_cndmask_b32 v68, v68, 0, vcc
    v_mul_f32 v64, v64, v68
    v_mul_f32 v66, v66, v69
    v_mov_b32 v68, 0x35e38e39
    v_mov_b32 v69, 0xb5e38e39
    v_mov_b32 v70, 0x35638e39
    v_cmp_eq_u32 vcc, 0, v58
    s_nop 1
    v_cndmask_b32 v68, v68, v70, vcc
    v_cndmask_b32 v69, v69, 0, vcc
    v_cmp_eq_u32 vcc, 288, v58
    s_nop 1
    v_cndmask_b32 v68, v68, v70, vcc
    v_cmp_le_u32 vcc, 288, v58
    s_nop 1
    v_cndmask_b32 v69, v69, 0, vcc
    v_cmp_lt_u32 vcc, 288, v58
    s_nop 1
    v_cndmask_b32 v68, v68, 0, vcc
    v_mul_f32 v65, v65, v68
    v_mul_f32 v67, v67, v69
    v_cvt_pk_bf16_f32 v64, v64, v65
    v_cvt_pk_bf16_f32 v66, v66, v67
    buffer_store_dword v64, v78, s[24:27], 0 offen
    buffer_store_dword v66, v78, s[28:31], 0 offen
    s_waitcnt vmcnt(0)
    v_cmp_eq_u32 vcc, 1, v221
    s_nop 1
    v_cndmask_b32 v204, v204, v212, vcc
    v_cndmask_b32 v205, v205, v213, vcc
    v_cndmask_b32 v206, v206, v214, vcc
    v_cndmask_b32 v207, v207, v215, vcc
    v_cndmask_b32 v208, v208, v216, vcc
    v_cndmask_b32 v209, v209, v217, vcc
    v_cndmask_b32 v210, v210, v218, vcc
    v_cndmask_b32 v211, v211, v219, vcc
    v_lshl_or_b32 v244, v205, 16, v204
    v_lshl_or_b32 v245, v207, 16, v206
    v_lshl_or_b32 v246, v209, 16, v208
    v_lshl_or_b32 v247, v211, 16, v210
    v_lshlrev_b32 v248, 4, v220
    buffer_store_dwordx4 v[244:247], v248, s[88:91], 0 offen
    s_nop 1
    v_cmp_eq_u32 vcc, 1, v241
    s_nop 1
    v_cndmask_b32 v224, v224, v232, vcc
    v_cndmask_b32 v225, v225, v233, vcc
    v_cndmask_b32 v226, v226, v234, vcc
    v_cndmask_b32 v227, v227, v235, vcc
    v_cndmask_b32 v228, v228, v236, vcc
    v_cndmask_b32 v229, v229, v237, vcc
    v_cndmask_b32 v230, v230, v238, vcc
    v_cndmask_b32 v231, v231, v239, vcc
    v_lshl_or_b32 v244, v225, 16, v224
    v_lshl_or_b32 v245, v227, 16, v226
    v_lshl_or_b32 v246, v229, 16, v228
    v_lshl_or_b32 v247, v231, 16, v230
    v_lshlrev_b32 v248, 4, v240
    buffer_store_dwordx4 v[244:247], v248, s[88:91], 0 offen
    s_nop 1
    s_branch L_qkv_bdone
L_qkv_b1:
    s_load_dwordx2 s[60:61], s[0:1], 48
    s_load_dwordx2 s[62:63], s[0:1], 88
    v_and_b32 v24, 63, v0
    s_mul_i32 s64, s2, 21846
    s_lshr_b32 s64, s64, 16
    s_mul_i32 s77, s64, 3
    s_sub_u32 s65, s2, s77
    s_mul_i32 s65, s65, 3
    s_add_u32 s65, s65, s40
    s_cmp_lt_u32 s2, 96
    s_cselect_b32 s79, 1, 0
    s_cmp_lt_u32 s40, 3
    s_cselect_b32 s78, s79, 0
    s_waitcnt lgkmcnt(0)
    s_mov_b32 s68, s60
    s_and_b32 s69, s61, 0xffff
    s_mov_b32 s70, 2359296
    s_mov_b32 s71, 0x00020000
    s_add_u32 s72, s62, 67108864
    s_addc_u32 s73, s63, 0
    s_and_b32 s73, s73, 0xffff
    s_mov_b32 s74, 4718592
    s_mov_b32 s75, 0x00020000
    v_and_b32 v26, 31, v24
    s_cmp_eq_u32 s79, 0
    s_cbranch_scc1 L_b1_skip_qkv_kernel_4
    s_mul_i32 s76, s64, 3
    s_sub_u32 s76, s2, s76
    s_mul_i32 s76, s76, 192
    s_mul_i32 s77, s64, 1152
    s_add_u32 s76, s76, s77
    s_mul_i32 s77, s40, 192
    s_mov_b32 s60, 43691
    v_add_u32 v25, s77, v24
    v_add_u32 v25, 0, v25
    v_mul_lo_u32 v27, v25, s60
    v_lshrrev_b32 v27, 19, v27
    v_mul_u32_u24 v28, 12, v27
    v_sub_u32 v28, v25, v28
    v_and_b32 v29, 63, v27
    v_mul_u32_u24 v29, 36864, v29
    v_lshrrev_b32 v27, 6, v27
    v_mul_u32_u24 v27, 576, v27
    v_add_u32 v29, v29, v27
    v_lshl_add_u32 v29, v28, 4, v29
    s_mul_i32 s61, s40, 3072
    s_add_u32 m0, s61, 65536
    s_nop 0
    buffer_load_dwordx4 v29, s[68:71], s76 offen lds
    v_add_u32 v25, s77, v24
    v_add_u32 v25, 64, v25
    v_mul_lo_u32 v27, v25, s60
    v_lshrrev_b32 v27, 19, v27
    v_mul_u32_u24 v28, 12, v27
    v_sub_u32 v28, v25, v28
    v_and_b32 v29, 63, v27
    v_mul_u32_u24 v29, 36864, v29
    v_lshrrev_b32 v27, 6, v27
    v_mul_u32_u24 v27, 576, v27
    v_add_u32 v29, v29, v27
    v_lshl_add_u32 v29, v28, 4, v29
    s_mul_i32 s61, s40, 3072
    s_add_u32 m0, s61, 66560
    s_nop 0
    buffer_load_dwordx4 v29, s[68:71], s76 offen lds
    v_add_u32 v25, s77, v24
    v_add_u32 v25, 128, v25
    v_mul_lo_u32 v27, v25, s60
    v_lshrrev_b32 v27, 19, v27
    v_mul_u32_u24 v28, 12, v27
    v_sub_u32 v28, v25, v28
    v_and_b32 v29, 63, v27
    v_mul_u32_u24 v29, 36864, v29
    v_lshrrev_b32 v27, 6, v27
    v_mul_u32_u24 v27, 576, v27
    v_add_u32 v29, v29, v27
    v_lshl_add_u32 v29, v28, 4, v29
    s_mul_i32 s61, s40, 3072
    s_add_u32 m0, s61, 67584
    s_nop 0
    buffer_load_dwordx4 v29, s[68:71], s76 offen lds
L_b1_skip_qkv_kernel_4:
    s_cmp_eq_u32 s79, 0
    s_cbranch_scc1 L_b1_skip2_qkv_kernel_5
    s_lshr_b32 s76, s40, 2
    s_lshl_b32 s76, s76, 5
    v_add_u32 v28, s76, v26
    s_and_b32 s76, s40, 3
    s_lshl_b32 s76, s76, 9
    s_add_u32 s76, s76, s64
    v_lshrrev_b32 v27, 5, v24
    v_lshlrev_b32 v27, 8, v27
    v_add_u32 v27, s76, v27
    v_add_u32 v29, 0, v27
    v_mul_u32_u24 v29, v29, v28
    v_and_b32 v29, 2047, v29
    v_cvt_f32_u32 v29, v29
    v_mul_f32 v29, 0x3a000000, v29
    v_add_u32 v30, 32, v27
    v_mul_u32_u24 v30, v30, v28
    v_and_b32 v30, 2047, v30
    v_cvt_f32_u32 v30, v30
    v_mul_f32 v30, 0x3a000000, v30
    v_cos_f32 v31, v29
    v_cos_f32 v32, v30
    v_sin_f32 v33, v29
    v_sin_f32 v34, v30
    s_nop 0
    v_cvt_pk_bf16_f32 v40, v31, v32
    v_cvt_pk_bf16_f32 v44, -v33, -v34
    v_add_u32 v29, 64, v27
    v_mul_u32_u24 v29, v29, v28
    v_and_b32 v29, 2047, v29
    v_cvt_f32_u32 v29, v29
    v_mul_f32 v29, 0x3a000000, v29
    v_add_u32 v30, 96, v27
    v_mul_u32_u24 v30, v30, v28
    v_and_b32 v30, 2047, v30
    v_cvt_f32_u32 v30, v30
    v_mul_f32 v30, 0x3a000000, v30
    v_cos_f32 v31, v29
    v_cos_f32 v32, v30
    v_sin_f32 v33, v29
    v_sin_f32 v34, v30
    s_nop 0
    v_cvt_pk_bf16_f32 v41, v31, v32
    v_cvt_pk_bf16_f32 v45, -v33, -v34
    v_add_u32 v29, 128, v27
    v_mul_u32_u24 v29, v29, v28
    v_and_b32 v29, 2047, v29
    v_cvt_f32_u32 v29, v29
    v_mul_f32 v29, 0x3a000000, v29
    v_add_u32 v30, 160, v27
    v_mul_u32_u24 v30, v30, v28
    v_and_b32 v30, 2047, v30
    v_cvt_f32_u32 v30, v30
    v_mul_f32 v30, 0x3a000000, v30
    v_cos_f32 v31, v29
    v_cos_f32 v32, v30
    v_sin_f32 v33, v29
    v_sin_f32 v34, v30
    s_nop 0
    v_cvt_pk_bf16_f32 v42, v31, v32
    v_cvt_pk_bf16_f32 v46, -v33, -v34
    v_add_u32 v29, 192, v27
    v_mul_u32_u24 v29, v29, v28
    v_and_b32 v29, 2047, v29
    v_cvt_f32_u32 v29, v29
    v_mul_f32 v29, 0x3a000000, v29
    v_add_u32 v30, 224, v27
    v_mul_u32_u24 v30, v30, v28
    v_and_b32 v30, 2047, v30
    v_cvt_f32_u32 v30, v30
    v_mul_f32 v30, 0x3a000000, v30
    v_cos_f32 v31, v29
    v_cos_f32 v32, v30
    v_sin_f32 v33, v29
    v_sin_f32 v34, v30
    s_nop 0
    v_cvt_pk_bf16_f32 v43, v31, v32
    v_cvt_pk_bf16_f32 v47, -v33, -v34
    s_lshl_b32 s76, s40, 10
    s_add_u32 s76, s76, 147456
    v_lshlrev_b32 v29, 4, v24
    v_add_u32 v29, s76, v29
    ds_write_b128 v29, v[40:43]
    ds_write_b128 v29, v[44:47] offset:8192
    s_waitcnt lgkmcnt(0)
L_b1_skip2_qkv_kernel_5:
    s_waitcnt vmcnt(0)
    s_barrier
    s_cmp_eq_u32 s78, 0
    s_cbranch_scc1 L_b1_end_qkv_kernel_3
    v_lshlrev_b32 v29, 4, v24
    v_add_u32 v29, 147456, v29
    ds_read_b128 v[40:43], v29 offset:0
    ds_read_b128 v[44:47], v29 offset:1024
    ds_read_b128 v[48:51], v29 offset:2048
    ds_read_b128 v[52:55], v29 offset:3072
    ds_read_b128 v[56:59], v29 offset:4096
    ds_read_b128 v[60:63], v29 offset:5120
    ds_read_b128 v[64:67], v29 offset:6144
    ds_read_b128 v[68:71], v29 offset:7168
    ds_read_b128 v[72:75], v29 offset:8192
    ds_read_b128 v[76:79], v29 offset:9216
    ds_read_b128 v[80:83], v29 offset:10240
    ds_read_b128 v[84:87], v29 offset:11264
    ds_read_b128 v[88:91], v29 offset:12288
    ds_read_b128 v[92:95], v29 offset:13312
    ds_read_b128 v[96:99], v29 offset:14336
    ds_read_b128 v[100:103], v29 offset:15360
    v_lshrrev_b32 v25, 5, v24
    v_lshlrev_b32 v25, 3, v25
    v_bfe_u32 v27, v24, 2, 2
    v_add_u32 v25, v25, v27
    v_mul_u32_u24 v25, 192, v25
    v_bfe_u32 v27, v24, 4, 1
    v_lshl_add_u32 v25, v27, 5, v25
    v_and_b32 v27, 3, v24
    v_lshl_add_u32 v25, v27, 3, v25
    s_lshl_b32 s76, s40, 6
    s_add_u32 s76, s76, 65536
    v_add_u32 v25, s76, v25
    ds_read_b64_tr_b16 v[104:105], v25 offset:0
    ds_read_b64_tr_b16 v[106:107], v25 offset:768
    ds_read_b64_tr_b16 v[108:109], v25 offset:3072
    ds_read_b64_tr_b16 v[110:111], v25 offset:3840
    ds_read_b64_tr_b16 v[112:113], v25 offset:6144
    ds_read_b64_tr_b16 v[114:115], v25 offset:6912
    ds_read_b64_tr_b16 v[116:117], v25 offset:9216
    ds_read_b64_tr_b16 v[118:119], v25 offset:9984
    ds_read_b64_tr_b16 v[120:121], v25 offset:12288
    ds_read_b64_tr_b16 v[122:123], v25 offset:13056
    ds_read_b64_tr_b16 v[124:125], v25 offset:15360
    ds_read_b64_tr_b16 v[126:127], v25 offset:16128
    ds_read_b64_tr_b16 v[128:129], v25 offset:18432
    ds_read_b64_tr_b16 v[130:131], v25 offset:19200
    ds_read_b64_tr_b16 v[132:133], v25 offset:21504
    ds_read_b64_tr_b16 v[134:135], v25 offset:22272
    s_waitcnt lgkmcnt(0)
    v_lshlrev_b32 v27, 16, v104
    v_and_b32 v28, 0xffff0000, v104
    v_lshlrev_b32 v29, 16, v120
    v_and_b32 v30, 0xffff0000, v120
    v_add_f32 v31, v27, v29
    v_add_f32 v32, v28, v30
    v_sub_f32 v33, v27, v29
    v_sub_f32 v34, v28, v30
    v_cvt_pk_bf16_f32 v168, v31, v32
    v_cvt_pk_bf16_f32 v184, v33, v34
    v_lshlrev_b32 v27, 16, v105
    v_and_b32 v28, 0xffff0000, v105
    v_lshlrev_b32 v29, 16, v121
    v_and_b32 v30, 0xffff0000, v121
    v_add_f32 v31, v27, v29
    v_add_f32 v32, v28, v30
    v_sub_f32 v33, v27, v29
    v_sub_f32 v34, v28, v30
    v_cvt_pk_bf16_f32 v169, v31, v32
    v_cvt_pk_bf16_f32 v185, v33, v34
    v_lshlrev_b32 v27, 16, v106
    v_and_b32 v28, 0xffff0000, v106
    v_lshlrev_b32 v29, 16, v122
    v_and_b32 v30, 0xffff0000, v122
    v_add_f32 v31, v27, v29
    v_add_f32 v32, v28, v30
    v_sub_f32 v33, v27, v29
    v_sub_f32 v34, v28, v30
    v_cvt_pk_bf16_f32 v170, v31, v32
    v_cvt_pk_bf16_f32 v186, v33, v34
    v_lshlrev_b32 v27, 16, v107
    v_and_b32 v28, 0xffff0000, v107
    v_lshlrev_b32 v29, 16, v123
    v_and_b32 v30, 0xffff0000, v123
    v_add_f32 v31, v27, v29
    v_add_f32 v32, v28, v30
    v_sub_f32 v33, v27, v29
    v_sub_f32 v34, v28, v30
    v_cvt_pk_bf16_f32 v171, v31, v32
    v_cvt_pk_bf16_f32 v187, v33, v34
    v_lshlrev_b32 v27, 16, v108
    v_and_b32 v28, 0xffff0000, v108
    v_lshlrev_b32 v29, 16, v124
    v_and_b32 v30, 0xffff0000, v124
    v_add_f32 v31, v27, v29
    v_add_f32 v32, v28, v30
    v_sub_f32 v33, v27, v29
    v_sub_f32 v34, v28, v30
    v_cvt_pk_bf16_f32 v172, v31, v32
    v_cvt_pk_bf16_f32 v188, v33, v34
    v_lshlrev_b32 v27, 16, v109
    v_and_b32 v28, 0xffff0000, v109
    v_lshlrev_b32 v29, 16, v125
    v_and_b32 v30, 0xffff0000, v125
    v_add_f32 v31, v27, v29
    v_add_f32 v32, v28, v30
    v_sub_f32 v33, v27, v29
    v_sub_f32 v34, v28, v30
    v_cvt_pk_bf16_f32 v173, v31, v32
    v_cvt_pk_bf16_f32 v189, v33, v34
    v_lshlrev_b32 v27, 16, v110
    v_and_b32 v28, 0xffff0000, v110
    v_lshlrev_b32 v29, 16, v126
    v_and_b32 v30, 0xffff0000, v126
    v_add_f32 v31, v27, v29
    v_add_f32 v32, v28, v30
    v_sub_f32 v33, v27, v29
    v_sub_f32 v34, v28, v30
    v_cvt_pk_bf16_f32 v174, v31, v32
    v_cvt_pk_bf16_f32 v190, v33, v34
    v_lshlrev_b32 v27, 16, v111
    v_and_b32 v28, 0xffff0000, v111
    v_lshlrev_b32 v29, 16, v127
    v_and_b32 v30, 0xffff0000, v127
    v_add_f32 v31, v27, v29
    v_add_f32 v32, v28, v30
    v_sub_f32 v33, v27, v29
    v_sub_f32 v34, v28, v30
    v_cvt_pk_bf16_f32 v175, v31, v32
    v_cvt_pk_bf16_f32 v191, v33, v34
    v_lshlrev_b32 v27, 16, v112
    v_and_b32 v28, 0xffff0000, v112
    v_lshlrev_b32 v29, 16, v128
    v_and_b32 v30, 0xffff0000, v128
    v_add_f32 v31, v27, v29
    v_add_f32 v32, v28, v30
    v_sub_f32 v33, v27, v29
    v_sub_f32 v34, v28, v30
    v_cvt_pk_bf16_f32 v176, v31, v32
    v_cvt_pk_bf16_f32 v192, v33, v34
    v_lshlrev_b32 v27, 16, v113
    v_and_b32 v28, 0xffff0000, v113
    v_lshlrev_b32 v29, 16, v129
    v_and_b32 v30, 0xffff0000, v129
    v_add_f32 v31, v27, v29
    v_add_f32 v32, v28, v30
    v_sub_f32 v33, v27, v29
    v_sub_f32 v34, v28, v30
    v_cvt_pk_bf16_f32 v177, v31, v32
    v_cvt_pk_bf16_f32 v193, v33, v34
    v_lshlrev_b32 v27, 16, v114
    v_and_b32 v28, 0xffff0000, v114
    v_lshlrev_b32 v29, 16, v130
    v_and_b32 v30, 0xffff0000, v130
    v_add_f32 v31, v27, v29
    v_add_f32 v32, v28, v30
    v_sub_f32 v33, v27, v29
    v_sub_f32 v34, v28, v30
    v_cvt_pk_bf16_f32 v178, v31, v32
    v_cvt_pk_bf16_f32 v194, v33, v34
    v_lshlrev_b32 v27, 16, v115
    v_and_b32 v28, 0xffff0000, v115
    v_lshlrev_b32 v29, 16, v131
    v_and_b32 v30, 0xffff0000, v131
    v_add_f32 v31, v27, v29
    v_add_f32 v32, v28, v30
    v_sub_f32 v33, v27, v29
    v_sub_f32 v34, v28, v30
    v_cvt_pk_bf16_f32 v179, v31, v32
    v_cvt_pk_bf16_f32 v195, v33, v34
    v_lshlrev_b32 v27, 16, v116
    v_and_b32 v28, 0xffff0000, v116
    v_lshlrev_b32 v29, 16, v132
    v_and_b32 v30, 0xffff0000, v132
    v_add_f32 v31, v27, v29
    v_add_f32 v32, v28, v30
    v_sub_f32 v33, v27, v29
    v_sub_f32 v34, v28, v30
    v_cvt_pk_bf16_f32 v180, v31, v32
    v_cvt_pk_bf16_f32 v196, v33, v34
    v_lshlrev_b32 v27, 16, v117
    v_and_b32 v28, 0xffff0000, v117
    v_lshlrev_b32 v29, 16, v133
    v_and_b32 v30, 0xffff0000, v133
    v_add_f32 v31, v27, v29
    v_add_f32 v32, v28, v30
    v_sub_f32 v33, v27, v29
    v_sub_f32 v34, v28, v30
    v_cvt_pk_bf16_f32 v181, v31, v32
    v_cvt_pk_bf16_f32 v197, v33, v34
    v_lshlrev_b32 v27, 16, v118
    v_and_b32 v28, 0xffff0000, v118
    v_lshlrev_b32 v29, 16, v134
    v_and_b32 v30, 0xffff0000, v134
    v_add_f32 v31, v27, v29
    v_add_f32 v32, v28, v30
    v_sub_f32 v33, v27, v29
    v_sub_f32 v34, v28, v30
    v_cvt_pk_bf16_f32 v182, v31, v32
    v_cvt_pk_bf16_f32 v198, v33, v34
    v_lshlrev_b32 v27, 16, v119
    v_and_b32 v28, 0xffff0000, v119
    v_lshlrev_b32 v29, 16, v135
    v_and_b32 v30, 0xffff0000, v135
    v_add_f32 v31, v27, v29
    v_add_f32 v32, v28, v30
    v_sub_f32 v33, v27, v29
    v_sub_f32 v34, v28, v30
    v_cvt_pk_bf16_f32 v183, v31, v32
    v_cvt_pk_bf16_f32 v199, v33, v34
    s_waitcnt lgkmcnt(0)
    v_mfma_f32_32x32x16_bf16 v[104:119], v[168:171], v[40:43], 0
    v_mfma_f32_32x32x16_bf16 v[104:119], v[172:175], v[44:47], v[104:119]
    v_mfma_f32_32x32x16_bf16 v[104:119], v[176:179], v[48:51], v[104:119]
    v_mfma_f32_32x32x16_bf16 v[104:119], v[180:183], v[52:55], v[104:119]
    v_mfma_f32_32x32x16_bf16 v[120:135], v[168:171], v[56:59], 0
    v_mfma_f32_32x32x16_bf16 v[120:135], v[172:175], v[60:63], v[120:135]
    v_mfma_f32_32x32x16_bf16 v[120:135], v[176:179], v[64:67], v[120:135]
    v_mfma_f32_32x32x16_bf16 v[120:135], v[180:183], v[68:71], v[120:135]
    v_mfma_f32_32x32x16_bf16 v[136:151], v[168:171], v[72:75], 0
    v_mfma_f32_32x32x16_bf16 v[136:151], v[172:175], v[76:79], v[136:151]
    v_mfma_f32_32x32x16_bf16 v[136:151], v[176:179], v[80:83], v[136:151]
    v_mfma_f32_32x32x16_bf16 v[136:151], v[180:183], v[84:87], v[136:151]
    v_mfma_f32_32x32x16_bf16 v[152:167], v[168:171], v[88:91], 0
    v_mfma_f32_32x32x16_bf16 v[152:167], v[172:175], v[92:95], v[152:167]
    v_mfma_f32_32x32x16_bf16 v[152:167], v[176:179], v[96:99], v[152:167]
    v_mfma_f32_32x32x16_bf16 v[152:167], v[180:183], v[100:103], v[152:167]
    s_nop 15
    s_nop 3
    v_add_u32 v28, 0, v26
    v_lshlrev_b32 v28, 2, v28
    v_add_u32 v28, 0, v28
    v_mul_u32_u24 v28, 18432, v28
    s_lshl_b32 s76, s65, 11
    s_lshl_b32 s77, s64, 4
    s_add_u32 s76, s76, s77
    v_add_u32 v28, s76, v28
    v_lshrrev_b32 v29, 5, v24
    v_lshl_add_u32 v28, v29, 9, v28
    v_cvt_pk_bf16_f32 v104, v104, v105
    v_cvt_pk_bf16_f32 v105, v106, v107
    v_cvt_pk_bf16_f32 v106, v108, v109
    v_cvt_pk_bf16_f32 v107, v110, v111
    v_cvt_pk_bf16_f32 v112, v112, v113
    v_cvt_pk_bf16_f32 v113, v114, v115
    v_cvt_pk_bf16_f32 v114, v116, v117
    v_cvt_pk_bf16_f32 v115, v118, v119
    s_nop 1
    v_permlane32_swap_b32 v104, v106
    v_permlane32_swap_b32 v105, v107
    v_permlane32_swap_b32 v112, v114
    v_permlane32_swap_b32 v113, v115
    buffer_store_dwordx4 v[104:107], v28, s[72:75], 0 offen offset:0
    buffer_store_dwordx4 v[112:115], v28, s[72:75], 0 offen offset:1024
    v_add_u32 v28, 0, v26
    v_lshlrev_b32 v28, 2, v28
    v_add_u32 v28, 2, v28
    v_mul_u32_u24 v28, 18432, v28
    s_lshl_b32 s76, s65, 11
    s_lshl_b32 s77, s64, 4
    s_add_u32 s76, s76, s77
    v_add_u32 v28, s76, v28
    v_lshrrev_b32 v29, 5, v24
    v_lshl_add_u32 v28, v29, 9, v28
    v_cvt_pk_bf16_f32 v136, v136, v137
    v_cvt_pk_bf16_f32 v137, v138, v139
    v_cvt_pk_bf16_f32 v138, v140, v141
    v_cvt_pk_bf16_f32 v139, v142, v143
    v_cvt_pk_bf16_f32 v144, v144, v145
    v_cvt_pk_bf16_f32 v145, v146, v147
    v_cvt_pk_bf16_f32 v146, v148, v149
    v_cvt_pk_bf16_f32 v147, v150, v151
    s_nop 1
    v_permlane32_swap_b32 v136, v138
    v_permlane32_swap_b32 v137, v139
    v_permlane32_swap_b32 v144, v146
    v_permlane32_swap_b32 v145, v147
    buffer_store_dwordx4 v[136:139], v28, s[72:75], 0 offen offset:0
    buffer_store_dwordx4 v[144:147], v28, s[72:75], 0 offen offset:1024
    v_add_u32 v28, 32, v26
    v_lshlrev_b32 v28, 2, v28
    v_add_u32 v28, 0, v28
    v_mul_u32_u24 v28, 18432, v28
    s_lshl_b32 s76, s65, 11
    s_lshl_b32 s77, s64, 4
    s_add_u32 s76, s76, s77
    v_add_u32 v28, s76, v28
    v_lshrrev_b32 v29, 5, v24
    v_lshl_add_u32 v28, v29, 9, v28
    v_cvt_pk_bf16_f32 v120, v120, v121
    v_cvt_pk_bf16_f32 v121, v122, v123
    v_cvt_pk_bf16_f32 v122, v124, v125
    v_cvt_pk_bf16_f32 v123, v126, v127
    v_cvt_pk_bf16_f32 v128, v128, v129
    v_cvt_pk_bf16_f32 v129, v130, v131
    v_cvt_pk_bf16_f32 v130, v132, v133
    v_cvt_pk_bf16_f32 v131, v134, v135
    s_nop 1
    v_permlane32_swap_b32 v120, v122
    v_permlane32_swap_b32 v121, v123
    v_permlane32_swap_b32 v128, v130
    v_permlane32_swap_b32 v129, v131
    buffer_store_dwordx4 v[120:123], v28, s[72:75], 0 offen offset:0
    buffer_store_dwordx4 v[128:131], v28, s[72:75], 0 offen offset:1024
    v_add_u32 v28, 32, v26
    v_lshlrev_b32 v28, 2, v28
    v_add_u32 v28, 2, v28
    v_mul_u32_u24 v28, 18432, v28
    s_lshl_b32 s76, s65, 11
    s_lshl_b32 s77, s64, 4
    s_add_u32 s76, s76, s77
    v_add_u32 v28, s76, v28
    v_lshrrev_b32 v29, 5, v24
    v_lshl_add_u32 v28, v29, 9, v28
    v_cvt_pk_bf16_f32 v152, v152, v153
    v_cvt_pk_bf16_f32 v153, v154, v155
    v_cvt_pk_bf16_f32 v154, v156, v157
    v_cvt_pk_bf16_f32 v155, v158, v159
    v_cvt_pk_bf16_f32 v160, v160, v161
    v_cvt_pk_bf16_f32 v161, v162, v163
    v_cvt_pk_bf16_f32 v162, v164, v165
    v_cvt_pk_bf16_f32 v163, v166, v167
    s_nop 1
    v_permlane32_swap_b32 v152, v154
    v_permlane32_swap_b32 v153, v155
    v_permlane32_swap_b32 v160, v162
    v_permlane32_swap_b32 v161, v163
    buffer_store_dwordx4 v[152:155], v28, s[72:75], 0 offen offset:0
    buffer_store_dwordx4 v[160:163], v28, s[72:75], 0 offen offset:1024
    s_nop 1
    v_mfma_f32_32x32x16_bf16 v[104:119], v[184:187], v[40:43], 0
    v_mfma_f32_32x32x16_bf16 v[104:119], v[188:191], v[44:47], v[104:119]
    v_mfma_f32_32x32x16_bf16 v[104:119], v[192:195], v[48:51], v[104:119]
    v_mfma_f32_32x32x16_bf16 v[104:119], v[196:199], v[52:55], v[104:119]
    v_mfma_f32_32x32x16_bf16 v[120:135], v[184:187], v[56:59], 0
    v_mfma_f32_32x32x16_bf16 v[120:135], v[188:191], v[60:63], v[120:135]
    v_mfma_f32_32x32x16_bf16 v[120:135], v[192:195], v[64:67], v[120:135]
    v_mfma_f32_32x32x16_bf16 v[120:135], v[196:199], v[68:71], v[120:135]
    v_mfma_f32_32x32x16_bf16 v[136:151], v[184:187], v[72:75], 0
    v_mfma_f32_32x32x16_bf16 v[136:151], v[188:191], v[76:79], v[136:151]
    v_mfma_f32_32x32x16_bf16 v[136:151], v[192:195], v[80:83], v[136:151]
    v_mfma_f32_32x32x16_bf16 v[136:151], v[196:199], v[84:87], v[136:151]
    v_mfma_f32_32x32x16_bf16 v[152:167], v[184:187], v[88:91], 0
    v_mfma_f32_32x32x16_bf16 v[152:167], v[188:191], v[92:95], v[152:167]
    v_mfma_f32_32x32x16_bf16 v[152:167], v[192:195], v[96:99], v[152:167]
    v_mfma_f32_32x32x16_bf16 v[152:167], v[196:199], v[100:103], v[152:167]
    s_nop 15
    s_nop 3
    v_add_u32 v28, 0, v26
    v_lshlrev_b32 v28, 2, v28
    v_add_u32 v28, 1, v28
    v_mul_u32_u24 v28, 18432, v28
    s_lshl_b32 s76, s65, 11
    s_lshl_b32 s77, s64, 4
    s_add_u32 s76, s76, s77
    v_add_u32 v28, s76, v28
    v_lshrrev_b32 v29, 5, v24
    v_lshl_add_u32 v28, v29, 9, v28
    v_cvt_pk_bf16_f32 v104, v104, v105
    v_cvt_pk_bf16_f32 v105, v106, v107
    v_cvt_pk_bf16_f32 v106, v108, v109
    v_cvt_pk_bf16_f32 v107, v110, v111
    v_cvt_pk_bf16_f32 v112, v112, v113
    v_cvt_pk_bf16_f32 v113, v114, v115
    v_cvt_pk_bf16_f32 v114, v116, v117
    v_cvt_pk_bf16_f32 v115, v118, v119
    s_nop 1
    v_permlane32_swap_b32 v104, v106
    v_permlane32_swap_b32 v105, v107
    v_permlane32_swap_b32 v112, v114
    v_permlane32_swap_b32 v113, v115
    buffer_store_dwordx4 v[104:107], v28, s[72:75], 0 offen offset:0
    buffer_store_dwordx4 v[112:115], v28, s[72:75], 0 offen offset:1024
    v_add_u32 v28, 0, v26
    v_lshlrev_b32 v28, 2, v28
    v_add_u32 v28, 3, v28
    v_mul_u32_u24 v28, 18432, v28
    s_lshl_b32 s76, s65, 11
    s_lshl_b32 s77, s64, 4
    s_add_u32 s76, s76, s77
    v_add_u32 v28, s76, v28
    v_lshrrev_b32 v29, 5, v24
    v_lshl_add_u32 v28, v29, 9, v28
    v_cvt_pk_bf16_f32 v136, v136, v137
    v_cvt_pk_bf16_f32 v137, v138, v139
    v_cvt_pk_bf16_f32 v138, v140, v141
    v_cvt_pk_bf16_f32 v139, v142, v143
    v_cvt_pk_bf16_f32 v144, v144, v145
    v_cvt_pk_bf16_f32 v145, v146, v147
    v_cvt_pk_bf16_f32 v146, v148, v149
    v_cvt_pk_bf16_f32 v147, v150, v151
    s_nop 1
    v_permlane32_swap_b32 v136, v138
    v_permlane32_swap_b32 v137, v139
    v_permlane32_swap_b32 v144, v146
    v_permlane32_swap_b32 v145, v147
    buffer_store_dwordx4 v[136:139], v28, s[72:75], 0 offen offset:0
    buffer_store_dwordx4 v[144:147], v28, s[72:75], 0 offen offset:1024
    v_add_u32 v28, 32, v26
    v_lshlrev_b32 v28, 2, v28
    v_add_u32 v28, 1, v28
    v_mul_u32_u24 v28, 18432, v28
    s_lshl_b32 s76, s65, 11
    s_lshl_b32 s77, s64, 4
    s_add_u32 s76, s76, s77
    v_add_u32 v28, s76, v28
    v_lshrrev_b32 v29, 5, v24
    v_lshl_add_u32 v28, v29, 9, v28
    v_cvt_pk_bf16_f32 v120, v120, v121
    v_cvt_pk_bf16_f32 v121, v122, v123
    v_cvt_pk_bf16_f32 v122, v124, v125
    v_cvt_pk_bf16_f32 v123, v126, v127
    v_cvt_pk_bf16_f32 v128, v128, v129
    v_cvt_pk_bf16_f32 v129, v130, v131
    v_cvt_pk_bf16_f32 v130, v132, v133
    v_cvt_pk_bf16_f32 v131, v134, v135
    s_nop 1
    v_permlane32_swap_b32 v120, v122
    v_permlane32_swap_b32 v121, v123
    v_permlane32_swap_b32 v128, v130
    v_permlane32_swap_b32 v129, v131
    buffer_store_dwordx4 v[120:123], v28, s[72:75], 0 offen offset:0
    buffer_store_dwordx4 v[128:131], v28, s[72:75], 0 offen offset:1024
    v_add_u32 v28, 32, v26
    v_lshlrev_b32 v28, 2, v28
    v_add_u32 v28, 3, v28
    v_mul_u32_u24 v28, 18432, v28
    s_lshl_b32 s76, s65, 11
    s_lshl_b32 s77, s64, 4
    s_add_u32 s76, s76, s77
    v_add_u32 v28, s76, v28
    v_lshrrev_b32 v29, 5, v24
    v_lshl_add_u32 v28, v29, 9, v28
    v_cvt_pk_bf16_f32 v152, v152, v153
    v_cvt_pk_bf16_f32 v153, v154, v155
    v_cvt_pk_bf16_f32 v154, v156, v157
    v_cvt_pk_bf16_f32 v155, v158, v159
    v_cvt_pk_bf16_f32 v160, v160, v161
    v_cvt_pk_bf16_f32 v161, v162, v163
    v_cvt_pk_bf16_f32 v162, v164, v165
    v_cvt_pk_bf16_f32 v163, v166, v167
    s_nop 1
    v_permlane32_swap_b32 v152, v154
    v_permlane32_swap_b32 v153, v155
    v_permlane32_swap_b32 v160, v162
    v_permlane32_swap_b32 v161, v163
    buffer_store_dwordx4 v[152:155], v28, s[72:75], 0 offen offset:0
    buffer_store_dwordx4 v[160:163], v28, s[72:75], 0 offen offset:1024
    s_nop 1
L_b1_end_qkv_kernel_3:
L_qkv_bdone:
    s_waitcnt vmcnt(7)
    s_waitcnt vmcnt(6)
    s_barrier
    ds_read_b128 v[24:27], v8 offset:0
    ds_read_b128 v[28:31], v8 offset:4096
    ds_read_b64_tr_b16 v[32:33], v16 offset:0
    ds_read_b64_tr_b16 v[34:35], v16 offset:1024
    ds_read_b64_tr_b16 v[36:37], v17 offset:0
    ds_read_b64_tr_b16 v[38:39], v17 offset:1024
    ds_read_b128 v[48:51], v9 offset:0
    ds_read_b128 v[52:55], v9 offset:4096
    ds_read_b64_tr_b16 v[56:57], v16 offset:4096
    ds_read_b64_tr_b16 v[58:59], v16 offset:5120
    ds_read_b64_tr_b16 v[60:61], v17 offset:4096
    ds_read_b64_tr_b16 v[62:63], v17 offset:5120
    s_waitcnt lgkmcnt(6)
    v_mfma_f32_32x32x16_bf16 v[72:87], v[32:35], v[24:27], 0
    v_mfma_f32_32x32x16_bf16 v[88:103], v[36:39], v[24:27], 0
    s_add_u32 m0, s45, 65536
    s_mov_b32 s47, 256
    buffer_load_dwordx4 v2, s[4:7], s47 offen offset:0 lds
    v_mfma_f32_32x32x16_bf16 v[104:119], v[32:35], v[28:31], 0
    v_mfma_f32_32x32x16_bf16 v[120:135], v[36:39], v[28:31], 0
    buffer_load_dwordx4 v3, s[4:7], s47 offen offset:1024 lds
    s_waitcnt lgkmcnt(0)
    v_mfma_f32_32x32x16_bf16 v[72:87], v[56:59], v[48:51], v[72:87]
    v_mfma_f32_32x32x16_bf16 v[88:103], v[60:63], v[48:51], v[88:103]
    s_add_u32 m0, s46, 49152
    s_mov_b32 s48, 786432
    buffer_load_dwordx4 v6, s[12:15], s48 offen lds
    v_mfma_f32_32x32x16_bf16 v[104:119], v[56:59], v[52:55], v[104:119]
    v_mfma_f32_32x32x16_bf16 v[120:135], v[60:63], v[52:55], v[120:135]
    s_waitcnt vmcnt(8)
    s_barrier
    ds_read_b128 v[24:27], v10 offset:0
    ds_read_b128 v[28:31], v10 offset:4096
    ds_read_b64_tr_b16 v[32:33], v16 offset:16384
    ds_read_b64_tr_b16 v[34:35], v16 offset:17408
    ds_read_b64_tr_b16 v[36:37], v17 offset:16384
    ds_read_b64_tr_b16 v[38:39], v17 offset:17408
    ds_read_b128 v[48:51], v11 offset:0
    ds_read_b128 v[52:55], v11 offset:4096
    ds_read_b64_tr_b16 v[56:57], v16 offset:20480
    ds_read_b64_tr_b16 v[58:59], v16 offset:21504
    ds_read_b64_tr_b16 v[60:61], v17 offset:20480
    ds_read_b64_tr_b16 v[62:63], v17 offset:21504
    s_waitcnt lgkmcnt(6)
    v_mfma_f32_32x32x16_bf16 v[72:87], v[32:35], v[24:27], v[72:87]
    v_mfma_f32_32x32x16_bf16 v[88:103], v[36:39], v[24:27], v[88:103]
    s_add_u32 m0, s45, 81920
    s_mov_b32 s47, 147712
    buffer_load_dwordx4 v2, s[4:7], s47 offen offset:0 lds
    v_mfma_f32_32x32x16_bf16 v[104:119], v[32:35], v[28:31], v[104:119]
    v_mfma_f32_32x32x16_bf16 v[120:135], v[36:39], v[28:31], v[120:135]
    buffer_load_dwordx4 v3, s[4:7], s47 offen offset:1024 lds
    s_waitcnt lgkmcnt(0)
    v_mfma_f32_32x32x16_bf16 v[72:87], v[56:59], v[48:51], v[72:87]
    v_mfma_f32_32x32x16_bf16 v[88:103], v[60:63], v[48:51], v[88:103]
    s_add_u32 m0, s46, 0
    s_mov_b32 s48, 1048576
    buffer_load_dwordx4 v6, s[12:15], s48 offen lds
    v_mfma_f32_32x32x16_bf16 v[104:119], v[56:59], v[52:55], v[104:119]
    v_mfma_f32_32x32x16_bf16 v[120:135], v[60:63], v[52:55], v[120:135]
    s_waitcnt vmcnt(7)
    s_waitcnt vmcnt(6)
    s_barrier
    ds_read_b128 v[24:27], v8 offset:32768
    ds_read_b128 v[28:31], v8 offset:36864
    ds_read_b64_tr_b16 v[32:33], v16 offset:32768
    ds_read_b64_tr_b16 v[34:35], v16 offset:33792
    ds_read_b64_tr_b16 v[36:37], v17 offset:32768
    ds_read_b64_tr_b16 v[38:39], v17 offset:33792
    ds_read_b128 v[48:51], v9 offset:32768
    ds_read_b128 v[52:55], v9 offset:36864
    ds_read_b64_tr_b16 v[56:57], v16 offset:36864
    ds_read_b64_tr_b16 v[58:59], v16 offset:37888
    ds_read_b64_tr_b16 v[60:61], v17 offset:36864
    ds_read_b64_tr_b16 v[62:63], v17 offset:37888
    s_waitcnt lgkmcnt(6)
    v_mfma_f32_32x32x16_bf16 v[72:87], v[32:35], v[24:27], v[72:87]
    v_mfma_f32_32x32x16_bf16 v[88:103], v[36:39], v[24:27], v[88:103]
    s_add_u32 m0, s45, 0
    s_mov_b32 s47, 384
    buffer_load_dwordx4 v2, s[4:7], s47 offen offset:0 lds
    v_mfma_f32_32x32x16_bf16 v[104:119], v[32:35], v[28:31], v[104:119]
    v_mfma_f32_32x32x16_bf16 v[120:135], v[36:39], v[28:31], v[120:135]
    buffer_load_dwordx4 v3, s[4:7], s47 offen offset:1024 lds
    s_waitcnt lgkmcnt(0)
    v_mfma_f32_32x32x16_bf16 v[72:87], v[56:59], v[48:51], v[72:87]
    v_mfma_f32_32x32x16_bf16 v[88:103], v[60:63], v[48:51], v[88:103]
    s_add_u32 m0, s46, 16384
    s_mov_b32 s48, 1310720
    buffer_load_dwordx4 v6, s[12:15], s48 offen lds
    v_mfma_f32_32x32x16_bf16 v[104:119], v[56:59], v[52:55], v[104:119]
    v_mfma_f32_32x32x16_bf16 v[120:135], v[60:63], v[52:55], v[120:135]
    s_waitcnt vmcnt(6)
    s_barrier
    ds_read_b128 v[24:27], v10 offset:32768
    ds_read_b128 v[28:31], v10 offset:36864
    ds_read_b64_tr_b16 v[32:33], v16 offset:49152
    ds_read_b64_tr_b16 v[34:35], v16 offset:50176
    ds_read_b64_tr_b16 v[36:37], v17 offset:49152
    ds_read_b64_tr_b16 v[38:39], v17 offset:50176
    ds_read_b128 v[48:51], v11 offset:32768
    ds_read_b128 v[52:55], v11 offset:36864
    ds_read_b64_tr_b16 v[56:57], v16 offset:53248
    ds_read_b64_tr_b16 v[58:59], v16 offset:54272
    ds_read_b64_tr_b16 v[60:61], v17 offset:53248
    ds_read_b64_tr_b16 v[62:63], v17 offset:54272
    s_waitcnt lgkmcnt(6)
    v_mfma_f32_32x32x16_bf16 v[72:87], v[32:35], v[24:27], v[72:87]
    v_mfma_f32_32x32x16_bf16 v[88:103], v[36:39], v[24:27], v[88:103]
    s_add_u32 m0, s45, 16384
    s_mov_b32 s47, 147840
    buffer_load_dwordx4 v2, s[4:7], s47 offen offset:0 lds
    v_mfma_f32_32x32x16_bf16 v[104:119], v[32:35], v[28:31], v[104:119]
    v_mfma_f32_32x32x16_bf16 v[120:135], v[36:39], v[28:31], v[120:135]
    buffer_load_dwordx4 v3, s[4:7], s47 offen offset:1024 lds
    s_waitcnt lgkmcnt(0)
    v_mfma_f32_32x32x16_bf16 v[72:87], v[56:59], v[48:51], v[72:87]
    v_mfma_f32_32x32x16_bf16 v[88:103], v[60:63], v[48:51], v[88:103]
    s_add_u32 m0, s46, 32768
    s_mov_b32 s48, 1572864
    buffer_load_dwordx4 v6, s[12:15], s48 offen lds
    v_mfma_f32_32x32x16_bf16 v[104:119], v[56:59], v[52:55], v[104:119]
    v_mfma_f32_32x32x16_bf16 v[120:135], v[60:63], v[52:55], v[120:135]
    s_waitcnt vmcnt(7)
    s_waitcnt vmcnt(6)
    s_barrier
    ds_read_b128 v[24:27], v12 offset:0
    ds_read_b128 v[28:31], v12 offset:4096
    ds_read_b64_tr_b16 v[32:33], v16 offset:0
    ds_read_b64_tr_b16 v[34:35], v16 offset:1024
    ds_read_b64_tr_b16 v[36:37], v17 offset:0
    ds_read_b64_tr_b16 v[38:39], v17 offset:1024
    ds_read_b128 v[48:51], v13 offset:0
    ds_read_b128 v[52:55], v13 offset:4096
    ds_read_b64_tr_b16 v[56:57], v16 offset:4096
    ds_read_b64_tr_b16 v[58:59], v16 offset:5120
    ds_read_b64_tr_b16 v[60:61], v17 offset:4096
    ds_read_b64_tr_b16 v[62:63], v17 offset:5120
    s_waitcnt lgkmcnt(6)
    v_mfma_f32_32x32x16_bf16 v[72:87], v[32:35], v[24:27], v[72:87]
    v_mfma_f32_32x32x16_bf16 v[88:103], v[36:39], v[24:27], v[88:103]
    s_add_u32 m0, s45, 32768
    s_mov_b32 s47, 512
    buffer_load_dwordx4 v2, s[4:7], s47 offen offset:0 lds
    v_mfma_f32_32x32x16_bf16 v[104:119], v[32:35], v[28:31], v[104:119]
    v_mfma_f32_32x32x16_bf16 v[120:135], v[36:39], v[28:31], v[120:135]
    buffer_load_dwordx4 v3, s[4:7], s47 offen offset:1024 lds
    s_waitcnt lgkmcnt(0)
    v_mfma_f32_32x32x16_bf16 v[72:87], v[56:59], v[48:51], v[72:87]
    v_mfma_f32_32x32x16_bf16 v[88:103], v[60:63], v[48:51], v[88:103]
    s_add_u32 m0, s46, 49152
    s_mov_b32 s48, 1835008
    buffer_load_dwordx4 v6, s[12:15], s48 offen lds
    v_mfma_f32_32x32x16_bf16 v[104:119], v[56:59], v[52:55], v[104:119]
    v_mfma_f32_32x32x16_bf16 v[120:135], v[60:63], v[52:55], v[120:135]
    s_waitcnt vmcnt(6)
    s_barrier
    ds_read_b128 v[24:27], v14 offset:0
    ds_read_b128 v[28:31], v14 offset:4096
    ds_read_b64_tr_b16 v[32:33], v16 offset:16384
    ds_read_b64_tr_b16 v[34:35], v16 offset:17408
    ds_read_b64_tr_b16 v[36:37], v17 offset:16384
    ds_read_b64_tr_b16 v[38:39], v17 offset:17408
    ds_read_b128 v[48:51], v15 offset:0
    ds_read_b128 v[52:55], v15 offset:4096
    ds_read_b64_tr_b16 v[56:57], v16 offset:20480
    ds_read_b64_tr_b16 v[58:59], v16 offset:21504
    ds_read_b64_tr_b16 v[60:61], v17 offset:20480
    ds_read_b64_tr_b16 v[62:63], v17 offset:21504
    s_waitcnt lgkmcnt(6)
    v_mfma_f32_32x32x16_bf16 v[72:87], v[32:35], v[24:27], v[72:87]
    v_mfma_f32_32x32x16_bf16 v[88:103], v[36:39], v[24:27], v[88:103]
    s_add_u32 m0, s45, 49152
    s_mov_b32 s47, 147968
    buffer_load_dwordx4 v2, s[4:7], s47 offen offset:0 lds
    v_mfma_f32_32x32x16_bf16 v[104:119], v[32:35], v[28:31], v[104:119]
    v_mfma_f32_32x32x16_bf16 v[120:135], v[36:39], v[28:31], v[120:135]
    buffer_load_dwordx4 v3, s[4:7], s47 offen offset:1024 lds
    s_waitcnt lgkmcnt(0)
    v_mfma_f32_32x32x16_bf16 v[72:87], v[56:59], v[48:51], v[72:87]
    v_mfma_f32_32x32x16_bf16 v[88:103], v[60:63], v[48:51], v[88:103]
    s_add_u32 m0, s46, 0
    s_mov_b32 s48, 2097152
    buffer_load_dwordx4 v6, s[12:15], s48 offen lds
    v_mfma_f32_32x32x16_bf16 v[104:119], v[56:59], v[52:55], v[104:119]
    v_mfma_f32_32x32x16_bf16 v[120:135], v[60:63], v[52:55], v[120:135]
    s_waitcnt vmcnt(7)
    s_waitcnt vmcnt(6)
    s_barrier
    ds_read_b128 v[24:27], v8 offset:0
    ds_read_b128 v[28:31], v8 offset:4096
    ds_read_b64_tr_b16 v[32:33], v16 offset:32768
    ds_read_b64_tr_b16 v[34:35], v16 offset:33792
    ds_read_b64_tr_b16 v[36:37], v17 offset:32768
    ds_read_b64_tr_b16 v[38:39], v17 offset:33792
    ds_read_b128 v[48:51], v9 offset:0
    ds_read_b128 v[52:55], v9 offset:4096
    ds_read_b64_tr_b16 v[56:57], v16 offset:36864
    ds_read_b64_tr_b16 v[58:59], v16 offset:37888
    ds_read_b64_tr_b16 v[60:61], v17 offset:36864
    ds_read_b64_tr_b16 v[62:63], v17 offset:37888
    s_waitcnt lgkmcnt(6)
    v_mfma_f32_32x32x16_bf16 v[72:87], v[32:35], v[24:27], v[72:87]
    v_mfma_f32_32x32x16_bf16 v[88:103], v[36:39], v[24:27], v[88:103]
    s_add_u32 m0, s45, 65536
    s_mov_b32 s47, 640
    buffer_load_dwordx4 v2, s[4:7], s47 offen offset:0 lds
    v_mfma_f32_32x32x16_bf16 v[104:119], v[32:35], v[28:31], v[104:119]
    v_mfma_f32_32x32x16_bf16 v[120:135], v[36:39], v[28:31], v[120:135]
    buffer_load_dwordx4 v3, s[4:7], s47 offen offset:1024 lds
    s_waitcnt lgkmcnt(0)
    v_mfma_f32_32x32x16_bf16 v[72:87], v[56:59], v[48:51], v[72:87]
    v_mfma_f32_32x32x16_bf16 v[88:103], v[60:63], v[48:51], v[88:103]
    s_add_u32 m0, s46, 16384
    s_mov_b32 s48, 2359296
    buffer_load_dwordx4 v6, s[12:15], s48 offen lds
    v_mfma_f32_32x32x16_bf16 v[104:119], v[56:59], v[52:55], v[104:119]
    v_mfma_f32_32x32x16_bf16 v[120:135], v[60:63], v[52:55], v[120:135]
    s_waitcnt vmcnt(6)
    s_barrier
    ds_read_b128 v[24:27], v10 offset:0
    ds_read_b128 v[28:31], v10 offset:4096
    ds_read_b64_tr_b16 v[32:33], v16 offset:49152
    ds_read_b64_tr_b16 v[34:35], v16 offset:50176
    ds_read_b64_tr_b16 v[36:37], v17 offset:49152
    ds_read_b64_tr_b16 v[38:39], v17 offset:50176
    ds_read_b128 v[48:51], v11 offset:0
    ds_read_b128 v[52:55], v11 offset:4096
    ds_read_b64_tr_b16 v[56:57], v16 offset:53248
    ds_read_b64_tr_b16 v[58:59], v16 offset:54272
    ds_read_b64_tr_b16 v[60:61], v17 offset:53248
    ds_read_b64_tr_b16 v[62:63], v17 offset:54272
    s_waitcnt lgkmcnt(6)
    v_mfma_f32_32x32x16_bf16 v[72:87], v[32:35], v[24:27], v[72:87]
    v_mfma_f32_32x32x16_bf16 v[88:103], v[36:39], v[24:27], v[88:103]
    s_add_u32 m0, s45, 81920
    s_mov_b32 s47, 148096
    buffer_load_dwordx4 v2, s[4:7], s47 offen offset:0 lds
    v_mfma_f32_32x32x16_bf16 v[104:119], v[32:35], v[28:31], v[104:119]
    v_mfma_f32_32x32x16_bf16 v[120:135], v[36:39], v[28:31], v[120:135]
    buffer_load_dwordx4 v3, s[4:7], s47 offen offset:1024 lds
    s_waitcnt lgkmcnt(0)
    v_mfma_f32_32x32x16_bf16 v[72:87], v[56:59], v[48:51], v[72:87]
    v_mfma_f32_32x32x16_bf16 v[88:103], v[60:63], v[48:51], v[88:103]
    s_add_u32 m0, s46, 32768
    s_mov_b32 s48, 2621440
    buffer_load_dwordx4 v6, s[12:15], s48 offen lds
    v_mfma_f32_32x32x16_bf16 v[104:119], v[56:59], v[52:55], v[104:119]
    v_mfma_f32_32x32x16_bf16 v[120:135], v[60:63], v[52:55], v[120:135]
    s_waitcnt vmcnt(7)
    s_waitcnt vmcnt(6)
    s_barrier
    ds_read_b128 v[24:27], v8 offset:32768
    ds_read_b128 v[28:31], v8 offset:36864
    ds_read_b64_tr_b16 v[32:33], v16 offset:0
    ds_read_b64_tr_b16 v[34:35], v16 offset:1024
    ds_read_b64_tr_b16 v[36:37], v17 offset:0
    ds_read_b64_tr_b16 v[38:39], v17 offset:1024
    ds_read_b128 v[48:51], v9 offset:32768
    ds_read_b128 v[52:55], v9 offset:36864
    ds_read_b64_tr_b16 v[56:57], v16 offset:4096
    ds_read_b64_tr_b16 v[58:59], v16 offset:5120
    ds_read_b64_tr_b16 v[60:61], v17 offset:4096
    ds_read_b64_tr_b16 v[62:63], v17 offset:5120
    s_waitcnt lgkmcnt(6)
    v_mfma_f32_32x32x16_bf16 v[72:87], v[32:35], v[24:27], v[72:87]
    v_mfma_f32_32x32x16_bf16 v[88:103], v[36:39], v[24:27], v[88:103]
    s_add_u32 m0, s45, 0
    s_mov_b32 s47, 768
    buffer_load_dwordx4 v2, s[4:7], s47 offen offset:0 lds
    v_mfma_f32_32x32x16_bf16 v[104:119], v[32:35], v[28:31], v[104:119]
    v_mfma_f32_32x32x16_bf16 v[120:135], v[36:39], v[28:31], v[120:135]
    buffer_load_dwordx4 v3, s[4:7], s47 offen offset:1024 lds
    s_waitcnt lgkmcnt(0)
    v_mfma_f32_32x32x16_bf16 v[72:87], v[56:59], v[48:51], v[72:87]
    v_mfma_f32_32x32x16_bf16 v[88:103], v[60:63], v[48:51], v[88:103]
    s_add_u32 m0, s46, 49152
    s_mov_b32 s48, 2883584
    buffer_load_dwordx4 v6, s[12:15], s48 offen lds
    v_mfma_f32_32x32x16_bf16 v[104:119], v[56:59], v[52:55], v[104:119]
    v_mfma_f32_32x32x16_bf16 v[120:135], v[60:63], v[52:55], v[120:135]
    s_waitcnt vmcnt(6)
    s_barrier
    ds_read_b128 v[24:27], v10 offset:32768
    ds_read_b128 v[28:31], v10 offset:36864
    ds_read_b64_tr_b16 v[32:33], v16 offset:16384
    ds_read_b64_tr_b16 v[34:35], v16 offset:17408
    ds_read_b64_tr_b16 v[36:37], v17 offset:16384
    ds_read_b64_tr_b16 v[38:39], v17 offset:17408
    ds_read_b128 v[48:51], v11 offset:32768
    ds_read_b128 v[52:55], v11 offset:36864
    ds_read_b64_tr_b16 v[56:57], v16 offset:20480
    ds_read_b64_tr_b16 v[58:59], v16 offset:21504
    ds_read_b64_tr_b16 v[60:61], v17 offset:20480
    ds_read_b64_tr_b16 v[62:63], v17 offset:21504
    s_waitcnt lgkmcnt(6)
    v_mfma_f32_32x32x16_bf16 v[72:87], v[32:35], v[24:27], v[72:87]
    v_mfma_f32_32x32x16_bf16 v[88:103], v[36:39], v[24:27], v[88:103]
    s_add_u32 m0, s45, 16384
    s_mov_b32 s47, 148224
    buffer_load_dwordx4 v2, s[4:7], s47 offen offset:0 lds
    v_mfma_f32_32x32x16_bf16 v[104:119], v[32:35], v[28:31], v[104:119]
    v_mfma_f32_32x32x16_bf16 v[120:135], v[36:39], v[28:31], v[120:135]
    buffer_load_dwordx4 v3, s[4:7], s47 offen offset:1024 lds
    s_waitcnt lgkmcnt(0)
    v_mfma_f32_32x32x16_bf16 v[72:87], v[56:59], v[48:51], v[72:87]
    v_mfma_f32_32x32x16_bf16 v[88:103], v[60:63], v[48:51], v[88:103]
    s_add_u32 m0, s46, 0
    s_mov_b32 s48, 3145728
    buffer_load_dwordx4 v6, s[12:15], s48 offen lds
    v_mfma_f32_32x32x16_bf16 v[104:119], v[56:59], v[52:55], v[104:119]
    v_mfma_f32_32x32x16_bf16 v[120:135], v[60:63], v[52:55], v[120:135]
    s_waitcnt vmcnt(7)
    s_waitcnt vmcnt(6)
    s_barrier
    ds_read_b128 v[24:27], v12 offset:0
    ds_read_b128 v[28:31], v12 offset:4096
    ds_read_b64_tr_b16 v[32:33], v16 offset:32768
    ds_read_b64_tr_b16 v[34:35], v16 offset:33792
    ds_read_b64_tr_b16 v[36:37], v17 offset:32768
    ds_read_b64_tr_b16 v[38:39], v17 offset:33792
    ds_read_b128 v[48:51], v13 offset:0
    ds_read_b128 v[52:55], v13 offset:4096
    ds_read_b64_tr_b16 v[56:57], v16 offset:36864
    ds_read_b64_tr_b16 v[58:59], v16 offset:37888
    ds_read_b64_tr_b16 v[60:61], v17 offset:36864
    ds_read_b64_tr_b16 v[62:63], v17 offset:37888
    s_waitcnt lgkmcnt(6)
    v_mfma_f32_32x32x16_bf16 v[72:87], v[32:35], v[24:27], v[72:87]
    v_mfma_f32_32x32x16_bf16 v[88:103], v[36:39], v[24:27], v[88:103]
    s_add_u32 m0, s45, 32768
    s_mov_b32 s47, 896
    buffer_load_dwordx4 v2, s[4:7], s47 offen offset:0 lds
    v_mfma_f32_32x32x16_bf16 v[104:119], v[32:35], v[28:31], v[104:119]
    v_mfma_f32_32x32x16_bf16 v[120:135], v[36:39], v[28:31], v[120:135]
    buffer_load_dwordx4 v3, s[4:7], s47 offen offset:1024 lds
    s_waitcnt lgkmcnt(0)
    v_mfma_f32_32x32x16_bf16 v[72:87], v[56:59], v[48:51], v[72:87]
    v_mfma_f32_32x32x16_bf16 v[88:103], v[60:63], v[48:51], v[88:103]
    s_add_u32 m0, s46, 16384
    s_mov_b32 s48, 3407872
    buffer_load_dwordx4 v6, s[12:15], s48 offen lds
    v_mfma_f32_32x32x16_bf16 v[104:119], v[56:59], v[52:55], v[104:119]
    v_mfma_f32_32x32x16_bf16 v[120:135], v[60:63], v[52:55], v[120:135]
    s_waitcnt vmcnt(6)
    s_barrier
    ds_read_b128 v[24:27], v14 offset:0
    ds_read_b128 v[28:31], v14 offset:4096
    ds_read_b64_tr_b16 v[32:33], v16 offset:49152
    ds_read_b64_tr_b16 v[34:35], v16 offset:50176
    ds_read_b64_tr_b16 v[36:37], v17 offset:49152
    ds_read_b64_tr_b16 v[38:39], v17 offset:50176
    ds_read_b128 v[48:51], v15 offset:0
    ds_read_b128 v[52:55], v15 offset:4096
    ds_read_b64_tr_b16 v[56:57], v16 offset:53248
    ds_read_b64_tr_b16 v[58:59], v16 offset:54272
    ds_read_b64_tr_b16 v[60:61], v17 offset:53248
    ds_read_b64_tr_b16 v[62:63], v17 offset:54272
    s_waitcnt lgkmcnt(6)
    v_mfma_f32_32x32x16_bf16 v[72:87], v[32:35], v[24:27], v[72:87]
    v_mfma_f32_32x32x16_bf16 v[88:103], v[36:39], v[24:27], v[88:103]
    s_add_u32 m0, s45, 49152
    s_mov_b32 s47, 148352
    buffer_load_dwordx4 v2, s[4:7], s47 offen offset:0 lds
    v_mfma_f32_32x32x16_bf16 v[104:119], v[32:35], v[28:31], v[104:119]
    v_mfma_f32_32x32x16_bf16 v[120:135], v[36:39], v[28:31], v[120:135]
    buffer_load_dwordx4 v3, s[4:7], s47 offen offset:1024 lds
    s_waitcnt lgkmcnt(0)
    v_mfma_f32_32x32x16_bf16 v[72:87], v[56:59], v[48:51], v[72:87]
    v_mfma_f32_32x32x16_bf16 v[88:103], v[60:63], v[48:51], v[88:103]
    s_add_u32 m0, s46, 32768
    s_mov_b32 s48, 3670016
    buffer_load_dwordx4 v6, s[12:15], s48 offen lds
    v_mfma_f32_32x32x16_bf16 v[104:119], v[56:59], v[52:55], v[104:119]
    v_mfma_f32_32x32x16_bf16 v[120:135], v[60:63], v[52:55], v[120:135]
    s_waitcnt vmcnt(7)
    s_waitcnt vmcnt(6)
    s_barrier
    ds_read_b128 v[24:27], v8 offset:0
    ds_read_b128 v[28:31], v8 offset:4096
    ds_read_b64_tr_b16 v[32:33], v16 offset:0
    ds_read_b64_tr_b16 v[34:35], v16 offset:1024
    ds_read_b64_tr_b16 v[36:37], v17 offset:0
    ds_read_b64_tr_b16 v[38:39], v17 offset:1024
    ds_read_b128 v[48:51], v9 offset:0
    ds_read_b128 v[52:55], v9 offset:4096
    ds_read_b64_tr_b16 v[56:57], v16 offset:4096
    ds_read_b64_tr_b16 v[58:59], v16 offset:5120
    ds_read_b64_tr_b16 v[60:61], v17 offset:4096
    ds_read_b64_tr_b16 v[62:63], v17 offset:5120
    s_waitcnt lgkmcnt(6)
    v_mfma_f32_32x32x16_bf16 v[72:87], v[32:35], v[24:27], v[72:87]
    v_mfma_f32_32x32x16_bf16 v[88:103], v[36:39], v[24:27], v[88:103]
    s_add_u32 m0, s45, 65536
    s_mov_b32 s47, 1024
    buffer_load_dwordx4 v2, s[4:7], s47 offen offset:0 lds
    v_mfma_f32_32x32x16_bf16 v[104:119], v[32:35], v[28:31], v[104:119]
    v_mfma_f32_32x32x16_bf16 v[120:135], v[36:39], v[28:31], v[120:135]
    buffer_load_dwordx4 v3, s[4:7], s47 offen offset:1024 lds
    s_waitcnt lgkmcnt(0)
    v_mfma_f32_32x32x16_bf16 v[72:87], v[56:59], v[48:51], v[72:87]
    v_mfma_f32_32x32x16_bf16 v[88:103], v[60:63], v[48:51], v[88:103]
    s_add_u32 m0, s46, 49152
    s_mov_b32 s48, 3932160
    buffer_load_dwordx4 v6, s[12:15], s48 offen lds
    v_mfma_f32_32x32x16_bf16 v[104:119], v[56:59], v[52:55], v[104:119]
    v_mfma_f32_32x32x16_bf16 v[120:135], v[60:63], v[52:55], v[120:135]
    s_waitcnt vmcnt(6)
    s_barrier
    ds_read_b128 v[24:27], v10 offset:0
    ds_read_b128 v[28:31], v10 offset:4096
    ds_read_b64_tr_b16 v[32:33], v16 offset:16384
    ds_read_b64_tr_b16 v[34:35], v16 offset:17408
    ds_read_b64_tr_b16 v[36:37], v17 offset:16384
    ds_read_b64_tr_b16 v[38:39], v17 offset:17408
    ds_read_b128 v[48:51], v11 offset:0
    ds_read_b128 v[52:55], v11 offset:4096
    ds_read_b64_tr_b16 v[56:57], v16 offset:20480
    ds_read_b64_tr_b16 v[58:59], v16 offset:21504
    ds_read_b64_tr_b16 v[60:61], v17 offset:20480
    ds_read_b64_tr_b16 v[62:63], v17 offset:21504
    s_waitcnt lgkmcnt(6)
    v_mfma_f32_32x32x16_bf16 v[72:87], v[32:35], v[24:27], v[72:87]
    v_mfma_f32_32x32x16_bf16 v[88:103], v[36:39], v[24:27], v[88:103]
    s_add_u32 m0, s45, 81920
    s_mov_b32 s47, 148480
    buffer_load_dwordx4 v2, s[4:7], s47 offen offset:0 lds
    v_mfma_f32_32x32x16_bf16 v[104:119], v[32:35], v[28:31], v[104:119]
    v_mfma_f32_32x32x16_bf16 v[120:135], v[36:39], v[28:31], v[120:135]
    buffer_load_dwordx4 v3, s[4:7], s47 offen offset:1024 lds
    s_waitcnt lgkmcnt(0)
    v_mfma_f32_32x32x16_bf16 v[72:87], v[56:59], v[48:51], v[72:87]
    v_mfma_f32_32x32x16_bf16 v[88:103], v[60:63], v[48:51], v[88:103]
    s_add_u32 m0, s46, 0
    s_mov_b32 s48, 4194304
    buffer_load_dwordx4 v6, s[12:15], s48 offen lds
    v_mfma_f32_32x32x16_bf16 v[104:119], v[56:59], v[52:55], v[104:119]
    v_mfma_f32_32x32x16_bf16 v[120:135], v[60:63], v[52:55], v[120:135]
    s_waitcnt vmcnt(7)
    s_waitcnt vmcnt(6)
    s_barrier
    ds_read_b128 v[24:27], v8 offset:32768
    ds_read_b128 v[28:31], v8 offset:36864
    ds_read_b64_tr_b16 v[32:33], v16 offset:32768
    ds_read_b64_tr_b16 v[34:35], v16 offset:33792
    ds_read_b64_tr_b16 v[36:37], v17 offset:32768
    ds_read_b64_tr_b16 v[38:39], v17 offset:33792
    ds_read_b128 v[48:51], v9 offset:32768
    ds_read_b128 v[52:55], v9 offset:36864
    ds_read_b64_tr_b16 v[56:57], v16 offset:36864
    ds_read_b64_tr_b16 v[58:59], v16 offset:37888
    ds_read_b64_tr_b16 v[60:61], v17 offset:36864
    ds_read_b64_tr_b16 v[62:63], v17 offset:37888
    s_waitcnt lgkmcnt(6)
    v_mfma_f32_32x32x16_bf16 v[72:87], v[32:35], v[24:27], v[72:87]
    v_mfma_f32_32x32x16_bf16 v[88:103], v[36:39], v[24:27], v[88:103]
    s_add_u32 m0, s45, 0
    s_mov_b32 s47, 0
    buffer_load_dwordx4 v4, s[8:11], s47 offen offset:0 lds
    v_mfma_f32_32x32x16_bf16 v[104:119], v[32:35], v[28:31], v[104:119]
    v_mfma_f32_32x32x16_bf16 v[120:135], v[36:39], v[28:31], v[120:135]
    buffer_load_dwordx4 v5, s[8:11], s47 offen offset:1024 lds
    s_waitcnt lgkmcnt(0)
    v_mfma_f32_32x32x16_bf16 v[72:87], v[56:59], v[48:51], v[72:87]
    v_mfma_f32_32x32x16_bf16 v[88:103], v[60:63], v[48:51], v[88:103]
    s_add_u32 m0, s46, 16384
    s_mov_b32 s48, 4456448
    buffer_load_dwordx4 v6, s[12:15], s48 offen lds
    v_mfma_f32_32x32x16_bf16 v[104:119], v[56:59], v[52:55], v[104:119]
    v_mfma_f32_32x32x16_bf16 v[120:135], v[60:63], v[52:55], v[120:135]
    s_waitcnt vmcnt(6)
    s_barrier
    ds_read_b128 v[24:27], v10 offset:32768
    ds_read_b128 v[28:31], v10 offset:36864
    ds_read_b64_tr_b16 v[32:33], v16 offset:49152
    ds_read_b64_tr_b16 v[34:35], v16 offset:50176
    ds_read_b64_tr_b16 v[36:37], v17 offset:49152
    ds_read_b64_tr_b16 v[38:39], v17 offset:50176
    ds_read_b128 v[48:51], v11 offset:32768
    ds_read_b128 v[52:55], v11 offset:36864
    ds_read_b64_tr_b16 v[56:57], v16 offset:53248
    ds_read_b64_tr_b16 v[58:59], v16 offset:54272
    ds_read_b64_tr_b16 v[60:61], v17 offset:53248
    ds_read_b64_tr_b16 v[62:63], v17 offset:54272
    s_waitcnt lgkmcnt(6)
    v_mfma_f32_32x32x16_bf16 v[72:87], v[32:35], v[24:27], v[72:87]
    v_mfma_f32_32x32x16_bf16 v[88:103], v[36:39], v[24:27], v[88:103]
    s_add_u32 m0, s45, 16384
    s_mov_b32 s47, 131072
    buffer_load_dwordx4 v4, s[8:11], s47 offen offset:0 lds
    v_mfma_f32_32x32x16_bf16 v[104:119], v[32:35], v[28:31], v[104:119]
    v_mfma_f32_32x32x16_bf16 v[120:135], v[36:39], v[28:31], v[120:135]
    buffer_load_dwordx4 v5, s[8:11], s47 offen offset:1024 lds
    s_waitcnt lgkmcnt(0)
    v_mfma_f32_32x32x16_bf16 v[72:87], v[56:59], v[48:51], v[72:87]
    v_mfma_f32_32x32x16_bf16 v[88:103], v[60:63], v[48:51], v[88:103]
    s_add_u32 m0, s46, 32768
    s_mov_b32 s48, 0
    buffer_load_dwordx4 v6, s[16:19], s48 offen lds
    v_mfma_f32_32x32x16_bf16 v[104:119], v[56:59], v[52:55], v[104:119]
    v_mfma_f32_32x32x16_bf16 v[120:135], v[60:63], v[52:55], v[120:135]
    s_add_u32 m0, s46, 40960
    s_nop 0
    buffer_load_dwordx4 v6, s[20:23], s48 offen lds
    s_waitcnt vmcnt(8)
    s_waitcnt vmcnt(7)
    s_barrier
    ds_read_b128 v[24:27], v12 offset:0
    ds_read_b128 v[28:31], v12 offset:4096
    ds_read_b64_tr_b16 v[32:33], v16 offset:0
    ds_read_b64_tr_b16 v[34:35], v16 offset:1024
    ds_read_b64_tr_b16 v[36:37], v17 offset:0
    ds_read_b64_tr_b16 v[38:39], v17 offset:1024
    ds_read_b128 v[48:51], v13 offset:0
    ds_read_b128 v[52:55], v13 offset:4096
    ds_read_b64_tr_b16 v[56:57], v16 offset:4096
    ds_read_b64_tr_b16 v[58:59], v16 offset:5120
    ds_read_b64_tr_b16 v[60:61], v17 offset:4096
    ds_read_b64_tr_b16 v[62:63], v17 offset:5120
    s_waitcnt lgkmcnt(6)
    v_mfma_f32_32x32x16_bf16 v[72:87], v[32:35], v[24:27], v[72:87]
    v_mfma_f32_32x32x16_bf16 v[88:103], v[36:39], v[24:27], v[88:103]
    s_add_u32 m0, s45, 32768
    s_mov_b32 s47, 128
    buffer_load_dwordx4 v4, s[8:11], s47 offen offset:0 lds
    v_mfma_f32_32x32x16_bf16 v[104:119], v[32:35], v[28:31], v[104:119]
    v_mfma_f32_32x32x16_bf16 v[120:135], v[36:39], v[28:31], v[120:135]
    buffer_load_dwordx4 v5, s[8:11], s47 offen offset:1024 lds
    s_waitcnt lgkmcnt(0)
    v_mfma_f32_32x32x16_bf16 v[72:87], v[56:59], v[48:51], v[72:87]
    v_mfma_f32_32x32x16_bf16 v[88:103], v[60:63], v[48:51], v[88:103]
    s_add_u32 m0, s46, 49152
    s_mov_b32 s48, 262144
    buffer_load_dwordx4 v6, s[16:19], s48 offen lds
    v_mfma_f32_32x32x16_bf16 v[104:119], v[56:59], v[52:55], v[104:119]
    v_mfma_f32_32x32x16_bf16 v[120:135], v[60:63], v[52:55], v[120:135]
    s_add_u32 m0, s46, 57344
    s_nop 0
    buffer_load_dwordx4 v6, s[20:23], s48 offen lds
    s_waitcnt vmcnt(8)
    s_barrier
    ds_read_b128 v[24:27], v14 offset:0
    ds_read_b128 v[28:31], v14 offset:4096
    ds_read_b64_tr_b16 v[32:33], v16 offset:16384
    ds_read_b64_tr_b16 v[34:35], v16 offset:17408
    ds_read_b64_tr_b16 v[36:37], v17 offset:16384
    ds_read_b64_tr_b16 v[38:39], v17 offset:17408
    ds_read_b128 v[48:51], v15 offset:0
    ds_read_b128 v[52:55], v15 offset:4096
    ds_read_b64_tr_b16 v[56:57], v16 offset:20480
    ds_read_b64_tr_b16 v[58:59], v16 offset:21504
    ds_read_b64_tr_b16 v[60:61], v17 offset:20480
    ds_read_b64_tr_b16 v[62:63], v17 offset:21504
    s_waitcnt lgkmcnt(6)
    v_mfma_f32_32x32x16_bf16 v[72:87], v[32:35], v[24:27], v[72:87]
    v_mfma_f32_32x32x16_bf16 v[88:103], v[36:39], v[24:27], v[88:103]
    s_add_u32 m0, s45, 49152
    s_mov_b32 s47, 131200
    buffer_load_dwordx4 v4, s[8:11], s47 offen offset:0 lds
    v_mfma_f32_32x32x16_bf16 v[104:119], v[32:35], v[28:31], v[104:119]
    v_mfma_f32_32x32x16_bf16 v[120:135], v[36:39], v[28:31], v[120:135]
    buffer_load_dwordx4 v5, s[8:11], s47 offen offset:1024 lds
    s_waitcnt lgkmcnt(0)
    v_mfma_f32_32x32x16_bf16 v[72:87], v[56:59], v[48:51], v[72:87]
    v_mfma_f32_32x32x16_bf16 v[88:103], v[60:63], v[48:51], v[88:103]
    s_add_u32 m0, s46, 0
    s_mov_b32 s48, 524288
    buffer_load_dwordx4 v6, s[16:19], s48 offen lds
    v_mfma_f32_32x32x16_bf16 v[104:119], v[56:59], v[52:55], v[104:119]
    v_mfma_f32_32x32x16_bf16 v[120:135], v[60:63], v[52:55], v[120:135]
    s_add_u32 m0, s46, 8192
    s_nop 0
    buffer_load_dwordx4 v6, s[20:23], s48 offen lds
    s_add_u32 s52, s34, 0
    s_addc_u32 s53, s35, 0
    s_and_b32 s53, s53, 0xffff
    s_mov_b32 s54, 16777216
    s_mov_b32 s55, 0x00020000
    s_mov_b32 s51, 0x3e0293ee
    v_and_b32 v18, 0x13, v1
    v_bfe_u32 v19, v1, 2, 1
    v_lshl_or_b32 v18, v19, 3, v18
    v_bfe_u32 v19, v1, 3, 1
    v_lshl_or_b32 v18, v19, 2, v18
    v_lshrrev_b32 v19, 1, v18
    v_and_b32 v19, 7, v19
    s_lshl_b32 s47, s43, 6
    v_add_u32 v18, s47, v18
    v_lshlrev_b32 v18, 7, v18
    v_lshrrev_b32 v20, 5, v1
    v_add_u32 v21, 0, v20
    v_xor_b32 v21, v21, v19
    v_lshl_add_u32 v8, v21, 4, v18
    v_add_u32 v12, 0x10000, v8
    v_add_u32 v21, 2, v20
    v_xor_b32 v21, v21, v19
    v_lshl_add_u32 v9, v21, 4, v18
    v_add_u32 v13, 0x10000, v9
    v_add_u32 v21, 4, v20
    v_xor_b32 v21, v21, v19
    v_lshl_add_u32 v10, v21, 4, v18
    v_add_u32 v14, 0x10000, v10
    v_add_u32 v21, 6, v20
    v_xor_b32 v21, v21, v19
    v_lshl_add_u32 v11, v21, 4, v18
    v_add_u32 v15, 0x10000, v11
    s_lshl_b32 s47, s41, 6
    s_lshl_b32 s48, s42, 3
    s_add_u32 s47, s47, s48
    s_lshl_b32 s48, s43, 1
    s_add_u32 s47, s47, s48
    s_lshl_b32 s47, s47, 13
    s_lshl_b32 s48, s44, 12
    s_add_u32 s47, s47, s48
    v_lshlrev_b32 v24, 4, v1
    v_add_u32 v24, s47, v24
    v_add_u32 v25, 8192, v24
    v_mul_f32 v72, s51, v72
    v_mul_f32 v73, s51, v73
    v_mul_f32 v74, s51, v74
    v_mul_f32 v75, s51, v75
    v_mul_f32 v76, s51, v76
    v_mul_f32 v77, s51, v77
    v_mul_f32 v78, s51, v78
    v_mul_f32 v79, s51, v79
    v_mul_f32 v80, s51, v80
    v_mul_f32 v81, s51, v81
    v_mul_f32 v82, s51, v82
    v_mul_f32 v83, s51, v83
    v_mul_f32 v84, s51, v84
    v_mul_f32 v85, s51, v85
    v_mul_f32 v86, s51, v86
    v_mul_f32 v87, s51, v87
    v_cvt_pk_bf16_f32 v72, v72, v73
    v_cvt_pk_bf16_f32 v73, v74, v75
    v_cvt_pk_bf16_f32 v74, v76, v77
    v_cvt_pk_bf16_f32 v75, v78, v79
    v_cvt_pk_bf16_f32 v80, v80, v81
    v_cvt_pk_bf16_f32 v81, v82, v83
    v_cvt_pk_bf16_f32 v82, v84, v85
    v_cvt_pk_bf16_f32 v83, v86, v87
    s_nop 1
    v_permlane32_swap_b32 v72, v74
    v_permlane32_swap_b32 v73, v75
    v_permlane32_swap_b32 v80, v82
    v_permlane32_swap_b32 v81, v83
    buffer_store_dwordx4 v[72:75], v24, s[52:55], 0 offen offset:0
    buffer_store_dwordx4 v[80:83], v24, s[52:55], 0 offen offset:1024
    v_mul_f32 v88, s51, v88
    v_mul_f32 v89, s51, v89
    v_mul_f32 v90, s51, v90
    v_mul_f32 v91, s51, v91
    v_mul_f32 v92, s51, v92
    v_mul_f32 v93, s51, v93
    v_mul_f32 v94, s51, v94
    v_mul_f32 v95, s51, v95
    v_mul_f32 v96, s51, v96
    v_mul_f32 v97, s51, v97
    v_mul_f32 v98, s51, v98
    v_mul_f32 v99, s51, v99
    v_mul_f32 v100, s51, v100
    v_mul_f32 v101, s51, v101
    v_mul_f32 v102, s51, v102
    v_mul_f32 v103, s51, v103
    v_cvt_pk_bf16_f32 v88, v88, v89
    v_cvt_pk_bf16_f32 v89, v90, v91
    v_cvt_pk_bf16_f32 v90, v92, v93
    v_cvt_pk_bf16_f32 v91, v94, v95
    v_cvt_pk_bf16_f32 v96, v96, v97
    v_cvt_pk_bf16_f32 v97, v98, v99
    v_cvt_pk_bf16_f32 v98, v100, v101
    v_cvt_pk_bf16_f32 v99, v102, v103
    s_nop 1
    v_permlane32_swap_b32 v88, v90
    v_permlane32_swap_b32 v89, v91
    v_permlane32_swap_b32 v96, v98
    v_permlane32_swap_b32 v97, v99
    buffer_store_dwordx4 v[88:91], v24, s[52:55], 0 offen offset:2048
    buffer_store_dwordx4 v[96:99], v24, s[52:55], 0 offen offset:3072
    v_mul_f32 v104, s51, v104
    v_mul_f32 v105, s51, v105
    v_mul_f32 v106, s51, v106
    v_mul_f32 v107, s51, v107
    v_mul_f32 v108, s51, v108
    v_mul_f32 v109, s51, v109
    v_mul_f32 v110, s51, v110
    v_mul_f32 v111, s51, v111
    v_mul_f32 v112, s51, v112
    v_mul_f32 v113, s51, v113
    v_mul_f32 v114, s51, v114
    v_mul_f32 v115, s51, v115
    v_mul_f32 v116, s51, v116
    v_mul_f32 v117, s51, v117
    v_mul_f32 v118, s51, v118
    v_mul_f32 v119, s51, v119
    v_cvt_pk_bf16_f32 v104, v104, v105
    v_cvt_pk_bf16_f32 v105, v106, v107
    v_cvt_pk_bf16_f32 v106, v108, v109
    v_cvt_pk_bf16_f32 v107, v110, v111
    v_cvt_pk_bf16_f32 v112, v112, v113
    v_cvt_pk_bf16_f32 v113, v114, v115
    v_cvt_pk_bf16_f32 v114, v116, v117
    v_cvt_pk_bf16_f32 v115, v118, v119
    s_nop 1
    v_permlane32_swap_b32 v104, v106
    v_permlane32_swap_b32 v105, v107
    v_permlane32_swap_b32 v112, v114
    v_permlane32_swap_b32 v113, v115
    buffer_store_dwordx4 v[104:107], v25, s[52:55], 0 offen offset:0
    buffer_store_dwordx4 v[112:115], v25, s[52:55], 0 offen offset:1024
    v_mul_f32 v120, s51, v120
    v_mul_f32 v121, s51, v121
    v_mul_f32 v122, s51, v122
    v_mul_f32 v123, s51, v123
    v_mul_f32 v124, s51, v124
    v_mul_f32 v125, s51, v125
    v_mul_f32 v126, s51, v126
    v_mul_f32 v127, s51, v127
    v_mul_f32 v128, s51, v128
    v_mul_f32 v129, s51, v129
    v_mul_f32 v130, s51, v130
    v_mul_f32 v131, s51, v131
    v_mul_f32 v132, s51, v132
    v_mul_f32 v133, s51, v133
    v_mul_f32 v134, s51, v134
    v_mul_f32 v135, s51, v135
    v_cvt_pk_bf16_f32 v120, v120, v121
    v_cvt_pk_bf16_f32 v121, v122, v123
    v_cvt_pk_bf16_f32 v122, v124, v125
    v_cvt_pk_bf16_f32 v123, v126, v127
    v_cvt_pk_bf16_f32 v128, v128, v129
    v_cvt_pk_bf16_f32 v129, v130, v131
    v_cvt_pk_bf16_f32 v130, v132, v133
    v_cvt_pk_bf16_f32 v131, v134, v135
    s_nop 1
    v_permlane32_swap_b32 v120, v122
    v_permlane32_swap_b32 v121, v123
    v_permlane32_swap_b32 v128, v130
    v_permlane32_swap_b32 v129, v131
    buffer_store_dwordx4 v[120:123], v25, s[52:55], 0 offen offset:2048
    buffer_store_dwordx4 v[128:131], v25, s[52:55], 0 offen offset:3072
    s_waitcnt vmcnt(18)
    s_waitcnt vmcnt(16)
    s_barrier
    ds_read_b128 v[24:27], v8 offset:0
    ds_read_b128 v[28:31], v8 offset:4096
    ds_read_b64_tr_b16 v[32:33], v16 offset:32768
    ds_read_b64_tr_b16 v[34:35], v16 offset:33792
    ds_read_b64_tr_b16 v[36:37], v17 offset:32768
    ds_read_b64_tr_b16 v[38:39], v17 offset:33792
    ds_read_b64_tr_b16 v[40:41], v16 offset:40960
    ds_read_b64_tr_b16 v[42:43], v16 offset:41984
    ds_read_b64_tr_b16 v[44:45], v17 offset:40960
    ds_read_b64_tr_b16 v[46:47], v17 offset:41984
    ds_read_b128 v[48:51], v9 offset:0
    ds_read_b128 v[52:55], v9 offset:4096
    ds_read_b64_tr_b16 v[56:57], v16 offset:36864
    ds_read_b64_tr_b16 v[58:59], v16 offset:37888
    ds_read_b64_tr_b16 v[60:61], v17 offset:36864
    ds_read_b64_tr_b16 v[62:63], v17 offset:37888
    ds_read_b64_tr_b16 v[64:65], v16 offset:45056
    ds_read_b64_tr_b16 v[66:67], v16 offset:46080
    ds_read_b64_tr_b16 v[68:69], v17 offset:45056
    ds_read_b64_tr_b16 v[70:71], v17 offset:46080
    s_waitcnt lgkmcnt(10)
    v_mfma_f32_32x32x16_bf16 v[72:87], v[32:35], v[24:27], 0
    v_mfma_f32_32x32x16_bf16 v[88:103], v[36:39], v[24:27], 0
    v_mfma_f32_32x32x16_bf16 v[104:119], v[32:35], v[28:31], 0
    v_mfma_f32_32x32x16_bf16 v[120:135], v[36:39], v[28:31], 0
    s_add_u32 m0, s45, 65536
    s_mov_b32 s47, 256
    buffer_load_dwordx4 v4, s[8:11], s47 offen offset:0 lds
    v_mfma_f32_32x32x16_bf16 v[136:151], v[24:27], v[40:43], 0
    v_mfma_f32_32x32x16_bf16 v[152:167], v[24:27], v[44:47], 0
    v_mfma_f32_32x32x16_bf16 v[168:183], v[28:31], v[40:43], 0
    v_mfma_f32_32x32x16_bf16 v[184:199], v[28:31], v[44:47], 0
    buffer_load_dwordx4 v5, s[8:11], s47 offen offset:1024 lds
    s_waitcnt lgkmcnt(0)
    v_mfma_f32_32x32x16_bf16 v[72:87], v[56:59], v[48:51], v[72:87]
    v_mfma_f32_32x32x16_bf16 v[88:103], v[60:63], v[48:51], v[88:103]
    v_mfma_f32_32x32x16_bf16 v[104:119], v[56:59], v[52:55], v[104:119]
    v_mfma_f32_32x32x16_bf16 v[120:135], v[60:63], v[52:55], v[120:135]
    s_add_u32 m0, s46, 16384
    s_mov_b32 s48, 786432
    buffer_load_dwordx4 v6, s[16:19], s48 offen lds
    v_mfma_f32_32x32x16_bf16 v[136:151], v[48:51], v[64:67], v[136:151]
    v_mfma_f32_32x32x16_bf16 v[152:167], v[48:51], v[68:71], v[152:167]
    v_mfma_f32_32x32x16_bf16 v[168:183], v[52:55], v[64:67], v[168:183]
    v_mfma_f32_32x32x16_bf16 v[184:199], v[52:55], v[68:71], v[184:199]
    s_add_u32 m0, s46, 24576
    s_nop 0
    buffer_load_dwordx4 v6, s[20:23], s48 offen lds
    s_waitcnt vmcnt(16)
    s_barrier
    ds_read_b128 v[24:27], v10 offset:0
    ds_read_b128 v[28:31], v10 offset:4096
    ds_read_b64_tr_b16 v[32:33], v16 offset:49152
    ds_read_b64_tr_b16 v[34:35], v16 offset:50176
    ds_read_b64_tr_b16 v[36:37], v17 offset:49152
    ds_read_b64_tr_b16 v[38:39], v17 offset:50176
    ds_read_b64_tr_b16 v[40:41], v16 offset:57344
    ds_read_b64_tr_b16 v[42:43], v16 offset:58368
    ds_read_b64_tr_b16 v[44:45], v17 offset:57344
    ds_read_b64_tr_b16 v[46:47], v17 offset:58368
    ds_read_b128 v[48:51], v11 offset:0
    ds_read_b128 v[52:55], v11 offset:4096
    ds_read_b64_tr_b16 v[56:57], v16 offset:53248
    ds_read_b64_tr_b16 v[58:59], v16 offset:54272
    ds_read_b64_tr_b16 v[60:61], v17 offset:53248
    ds_read_b64_tr_b16 v[62:63], v17 offset:54272
    ds_read_b64_tr_b16 v[64:65], v16 offset:61440
    ds_read_b64_tr_b16 v[66:67], v16 offset:62464
    ds_read_b64_tr_b16 v[68:69], v17 offset:61440
    ds_read_b64_tr_b16 v[70:71], v17 offset:62464
    s_waitcnt lgkmcnt(10)
    v_mfma_f32_32x32x16_bf16 v[72:87], v[32:35], v[24:27], v[72:87]
    v_mfma_f32_32x32x16_bf16 v[88:103], v[36:39], v[24:27], v[88:103]
    v_mfma_f32_32x32x16_bf16 v[104:119], v[32:35], v[28:31], v[104:119]
    v_mfma_f32_32x32x16_bf16 v[120:135], v[36:39], v[28:31], v[120:135]
    s_add_u32 m0, s45, 81920
    s_mov_b32 s47, 131328
    buffer_load_dwordx4 v4, s[8:11], s47 offen offset:0 lds
    v_mfma_f32_32x32x16_bf16 v[136:151], v[24:27], v[40:43], v[136:151]
    v_mfma_f32_32x32x16_bf16 v[152:167], v[24:27], v[44:47], v[152:167]
    v_mfma_f32_32x32x16_bf16 v[168:183], v[28:31], v[40:43], v[168:183]
    v_mfma_f32_32x32x16_bf16 v[184:199], v[28:31], v[44:47], v[184:199]
    buffer_load_dwordx4 v5, s[8:11], s47 offen offset:1024 lds
    s_waitcnt lgkmcnt(0)
    v_mfma_f32_32x32x16_bf16 v[72:87], v[56:59], v[48:51], v[72:87]
    v_mfma_f32_32x32x16_bf16 v[88:103], v[60:63], v[48:51], v[88:103]
    v_mfma_f32_32x32x16_bf16 v[104:119], v[56:59], v[52:55], v[104:119]
    v_mfma_f32_32x32x16_bf16 v[120:135], v[60:63], v[52:55], v[120:135]
    s_add_u32 m0, s46, 32768
    s_mov_b32 s48, 1048576
    buffer_load_dwordx4 v6, s[16:19], s48 offen lds
    v_mfma_f32_32x32x16_bf16 v[136:151], v[48:51], v[64:67], v[136:151]
    v_mfma_f32_32x32x16_bf16 v[152:167], v[48:51], v[68:71], v[152:167]
    v_mfma_f32_32x32x16_bf16 v[168:183], v[52:55], v[64:67], v[168:183]
    v_mfma_f32_32x32x16_bf16 v[184:199], v[52:55], v[68:71], v[184:199]
    s_add_u32 m0, s46, 40960
    s_nop 0
    buffer_load_dwordx4 v6, s[20:23], s48 offen lds
    s_waitcnt vmcnt(18)
    s_waitcnt vmcnt(16)
    s_barrier
    ds_read_b128 v[24:27], v8 offset:32768
    ds_read_b128 v[28:31], v8 offset:36864
    ds_read_b64_tr_b16 v[32:33], v16 offset:0
    ds_read_b64_tr_b16 v[34:35], v16 offset:1024
    ds_read_b64_tr_b16 v[36:37], v17 offset:0
    ds_read_b64_tr_b16 v[38:39], v17 offset:1024
    ds_read_b64_tr_b16 v[40:41], v16 offset:8192
    ds_read_b64_tr_b16 v[42:43], v16 offset:9216
    ds_read_b64_tr_b16 v[44:45], v17 offset:8192
    ds_read_b64_tr_b16 v[46:47], v17 offset:9216
    ds_read_b128 v[48:51], v9 offset:32768
    ds_read_b128 v[52:55], v9 offset:36864
    ds_read_b64_tr_b16 v[56:57], v16 offset:4096
    ds_read_b64_tr_b16 v[58:59], v16 offset:5120
    ds_read_b64_tr_b16 v[60:61], v17 offset:4096
    ds_read_b64_tr_b16 v[62:63], v17 offset:5120
    ds_read_b64_tr_b16 v[64:65], v16 offset:12288
    ds_read_b64_tr_b16 v[66:67], v16 offset:13312
    ds_read_b64_tr_b16 v[68:69], v17 offset:12288
    ds_read_b64_tr_b16 v[70:71], v17 offset:13312
    s_waitcnt lgkmcnt(10)
    v_mfma_f32_32x32x16_bf16 v[72:87], v[32:35], v[24:27], v[72:87]
    v_mfma_f32_32x32x16_bf16 v[88:103], v[36:39], v[24:27], v[88:103]
    v_mfma_f32_32x32x16_bf16 v[104:119], v[32:35], v[28:31], v[104:119]
    v_mfma_f32_32x32x16_bf16 v[120:135], v[36:39], v[28:31], v[120:135]
    s_add_u32 m0, s45, 0
    s_mov_b32 s47, 384
    buffer_load_dwordx4 v4, s[8:11], s47 offen offset:0 lds
    v_mfma_f32_32x32x16_bf16 v[136:151], v[24:27], v[40:43], v[136:151]
    v_mfma_f32_32x32x16_bf16 v[152:167], v[24:27], v[44:47], v[152:167]
    v_mfma_f32_32x32x16_bf16 v[168:183], v[28:31], v[40:43], v[168:183]
    v_mfma_f32_32x32x16_bf16 v[184:199], v[28:31], v[44:47], v[184:199]
    buffer_load_dwordx4 v5, s[8:11], s47 offen offset:1024 lds
    s_waitcnt lgkmcnt(0)
    v_mfma_f32_32x32x16_bf16 v[72:87], v[56:59], v[48:51], v[72:87]
    v_mfma_f32_32x32x16_bf16 v[88:103], v[60:63], v[48:51], v[88:103]
    v_mfma_f32_32x32x16_bf16 v[104:119], v[56:59], v[52:55], v[104:119]
    v_mfma_f32_32x32x16_bf16 v[120:135], v[60:63], v[52:55], v[120:135]
    s_add_u32 m0, s46, 49152
    s_mov_b32 s48, 1310720
    buffer_load_dwordx4 v6, s[16:19], s48 offen lds
    v_mfma_f32_32x32x16_bf16 v[136:151], v[48:51], v[64:67], v[136:151]
    v_mfma_f32_32x32x16_bf16 v[152:167], v[48:51], v[68:71], v[152:167]
    v_mfma_f32_32x32x16_bf16 v[168:183], v[52:55], v[64:67], v[168:183]
    v_mfma_f32_32x32x16_bf16 v[184:199], v[52:55], v[68:71], v[184:199]
    s_add_u32 m0, s46, 57344
    s_nop 0
    buffer_load_dwordx4 v6, s[20:23], s48 offen lds
    s_waitcnt vmcnt(8)
    s_barrier
    ds_read_b128 v[24:27], v10 offset:32768
    ds_read_b128 v[28:31], v10 offset:36864
    ds_read_b64_tr_b16 v[32:33], v16 offset:16384
    ds_read_b64_tr_b16 v[34:35], v16 offset:17408
    ds_read_b64_tr_b16 v[36:37], v17 offset:16384
    ds_read_b64_tr_b16 v[38:39], v17 offset:17408
    ds_read_b64_tr_b16 v[40:41], v16 offset:24576
    ds_read_b64_tr_b16 v[42:43], v16 offset:25600
    ds_read_b64_tr_b16 v[44:45], v17 offset:24576
    ds_read_b64_tr_b16 v[46:47], v17 offset:25600
    ds_read_b128 v[48:51], v11 offset:32768
    ds_read_b128 v[52:55], v11 offset:36864
    ds_read_b64_tr_b16 v[56:57], v16 offset:20480
    ds_read_b64_tr_b16 v[58:59], v16 offset:21504
    ds_read_b64_tr_b16 v[60:61], v17 offset:20480
    ds_read_b64_tr_b16 v[62:63], v17 offset:21504
    ds_read_b64_tr_b16 v[64:65], v16 offset:28672
    ds_read_b64_tr_b16 v[66:67], v16 offset:29696
    ds_read_b64_tr_b16 v[68:69], v17 offset:28672
    ds_read_b64_tr_b16 v[70:71], v17 offset:29696
    s_waitcnt lgkmcnt(10)
    v_mfma_f32_32x32x16_bf16 v[72:87], v[32:35], v[24:27], v[72:87]
    v_mfma_f32_32x32x16_bf16 v[88:103], v[36:39], v[24:27], v[88:103]
    v_mfma_f32_32x32x16_bf16 v[104:119], v[32:35], v[28:31], v[104:119]
    v_mfma_f32_32x32x16_bf16 v[120:135], v[36:39], v[28:31], v[120:135]
    s_add_u32 m0, s45, 16384
    s_mov_b32 s47, 131456
    buffer_load_dwordx4 v4, s[8:11], s47 offen offset:0 lds
    v_mfma_f32_32x32x16_bf16 v[136:151], v[24:27], v[40:43], v[136:151]
    v_mfma_f32_32x32x16_bf16 v[152:167], v[24:27], v[44:47], v[152:167]
    v_mfma_f32_32x32x16_bf16 v[168:183], v[28:31], v[40:43], v[168:183]
    v_mfma_f32_32x32x16_bf16 v[184:199], v[28:31], v[44:47], v[184:199]
    buffer_load_dwordx4 v5, s[8:11], s47 offen offset:1024 lds
    s_waitcnt lgkmcnt(0)
    v_mfma_f32_32x32x16_bf16 v[72:87], v[56:59], v[48:51], v[72:87]
    v_mfma_f32_32x32x16_bf16 v[88:103], v[60:63], v[48:51], v[88:103]
    v_mfma_f32_32x32x16_bf16 v[104:119], v[56:59], v[52:55], v[104:119]
    v_mfma_f32_32x32x16_bf16 v[120:135], v[60:63], v[52:55], v[120:135]
    s_add_u32 m0, s46, 0
    s_mov_b32 s48, 1572864
    buffer_load_dwordx4 v6, s[16:19], s48 offen lds
    v_mfma_f32_32x32x16_bf16 v[136:151], v[48:51], v[64:67], v[136:151]
    v_mfma_f32_32x32x16_bf16 v[152:167], v[48:51], v[68:71], v[152:167]
    v_mfma_f32_32x32x16_bf16 v[168:183], v[52:55], v[64:67], v[168:183]
    v_mfma_f32_32x32x16_bf16 v[184:199], v[52:55], v[68:71], v[184:199]
    s_add_u32 m0, s46, 8192
    s_nop 0
    buffer_load_dwordx4 v6, s[20:23], s48 offen lds
    s_waitcnt vmcnt(10)
    s_waitcnt vmcnt(8)
    s_barrier
    ds_read_b128 v[24:27], v12 offset:0
    ds_read_b128 v[28:31], v12 offset:4096
    ds_read_b64_tr_b16 v[32:33], v16 offset:32768
    ds_read_b64_tr_b16 v[34:35], v16 offset:33792
    ds_read_b64_tr_b16 v[36:37], v17 offset:32768
    ds_read_b64_tr_b16 v[38:39], v17 offset:33792
    ds_read_b64_tr_b16 v[40:41], v16 offset:40960
    ds_read_b64_tr_b16 v[42:43], v16 offset:41984
    ds_read_b64_tr_b16 v[44:45], v17 offset:40960
    ds_read_b64_tr_b16 v[46:47], v17 offset:41984
    ds_read_b128 v[48:51], v13 offset:0
    ds_read_b128 v[52:55], v13 offset:4096
    ds_read_b64_tr_b16 v[56:57], v16 offset:36864
    ds_read_b64_tr_b16 v[58:59], v16 offset:37888
    ds_read_b64_tr_b16 v[60:61], v17 offset:36864
    ds_read_b64_tr_b16 v[62:63], v17 offset:37888
    ds_read_b64_tr_b16 v[64:65], v16 offset:45056
    ds_read_b64_tr_b16 v[66:67], v16 offset:46080
    ds_read_b64_tr_b16 v[68:69], v17 offset:45056
    ds_read_b64_tr_b16 v[70:71], v17 offset:46080
    s_waitcnt lgkmcnt(10)
    v_mfma_f32_32x32x16_bf16 v[72:87], v[32:35], v[24:27], v[72:87]
    v_mfma_f32_32x32x16_bf16 v[88:103], v[36:39], v[24:27], v[88:103]
    v_mfma_f32_32x32x16_bf16 v[104:119], v[32:35], v[28:31], v[104:119]
    v_mfma_f32_32x32x16_bf16 v[120:135], v[36:39], v[28:31], v[120:135]
    s_add_u32 m0, s45, 32768
    s_mov_b32 s47, 512
    buffer_load_dwordx4 v4, s[8:11], s47 offen offset:0 lds
    v_mfma_f32_32x32x16_bf16 v[136:151], v[24:27], v[40:43], v[136:151]
    v_mfma_f32_32x32x16_bf16 v[152:167], v[24:27], v[44:47], v[152:167]
    v_mfma_f32_32x32x16_bf16 v[168:183], v[28:31], v[40:43], v[168:183]
    v_mfma_f32_32x32x16_bf16 v[184:199], v[28:31], v[44:47], v[184:199]
    buffer_load_dwordx4 v5, s[8:11], s47 offen offset:1024 lds
    s_waitcnt lgkmcnt(0)
    v_mfma_f32_32x32x16_bf16 v[72:87], v[56:59], v[48:51], v[72:87]
    v_mfma_f32_32x32x16_bf16 v[88:103], v[60:63], v[48:51], v[88:103]
    v_mfma_f32_32x32x16_bf16 v[104:119], v[56:59], v[52:55], v[104:119]
    v_mfma_f32_32x32x16_bf16 v[120:135], v[60:63], v[52:55], v[120:135]
    s_add_u32 m0, s46, 16384
    s_mov_b32 s48, 1835008
    buffer_load_dwordx4 v6, s[16:19], s48 offen lds
    v_mfma_f32_32x32x16_bf16 v[136:151], v[48:51], v[64:67], v[136:151]
    v_mfma_f32_32x32x16_bf16 v[152:167], v[48:51], v[68:71], v[152:167]
    v_mfma_f32_32x32x16_bf16 v[168:183], v[52:55], v[64:67], v[168:183]
    v_mfma_f32_32x32x16_bf16 v[184:199], v[52:55], v[68:71], v[184:199]
    s_add_u32 m0, s46, 24576
    s_nop 0
    buffer_load_dwordx4 v6, s[20:23], s48 offen lds
    s_waitcnt vmcnt(8)
    s_barrier
    ds_read_b128 v[24:27], v14 offset:0
    ds_read_b128 v[28:31], v14 offset:4096
    ds_read_b64_tr_b16 v[32:33], v16 offset:49152
    ds_read_b64_tr_b16 v[34:35], v16 offset:50176
    ds_read_b64_tr_b16 v[36:37], v17 offset:49152
    ds_read_b64_tr_b16 v[38:39], v17 offset:50176
    ds_read_b64_tr_b16 v[40:41], v16 offset:57344
    ds_read_b64_tr_b16 v[42:43], v16 offset:58368
    ds_read_b64_tr_b16 v[44:45], v17 offset:57344
    ds_read_b64_tr_b16 v[46:47], v17 offset:58368
    ds_read_b128 v[48:51], v15 offset:0
    ds_read_b128 v[52:55], v15 offset:4096
    ds_read_b64_tr_b16 v[56:57], v16 offset:53248
    ds_read_b64_tr_b16 v[58:59], v16 offset:54272
    ds_read_b64_tr_b16 v[60:61], v17 offset:53248
    ds_read_b64_tr_b16 v[62:63], v17 offset:54272
    ds_read_b64_tr_b16 v[64:65], v16 offset:61440
    ds_read_b64_tr_b16 v[66:67], v16 offset:62464
    ds_read_b64_tr_b16 v[68:69], v17 offset:61440
    ds_read_b64_tr_b16 v[70:71], v17 offset:62464
    s_waitcnt lgkmcnt(10)
    v_mfma_f32_32x32x16_bf16 v[72:87], v[32:35], v[24:27], v[72:87]
    v_mfma_f32_32x32x16_bf16 v[88:103], v[36:39], v[24:27], v[88:103]
    v_mfma_f32_32x32x16_bf16 v[104:119], v[32:35], v[28:31], v[104:119]
    v_mfma_f32_32x32x16_bf16 v[120:135], v[36:39], v[28:31], v[120:135]
    s_add_u32 m0, s45, 49152
    s_mov_b32 s47, 131584
    buffer_load_dwordx4 v4, s[8:11], s47 offen offset:0 lds
    v_mfma_f32_32x32x16_bf16 v[136:151], v[24:27], v[40:43], v[136:151]
    v_mfma_f32_32x32x16_bf16 v[152:167], v[24:27], v[44:47], v[152:167]
    v_mfma_f32_32x32x16_bf16 v[168:183], v[28:31], v[40:43], v[168:183]
    v_mfma_f32_32x32x16_bf16 v[184:199], v[28:31], v[44:47], v[184:199]
    buffer_load_dwordx4 v5, s[8:11], s47 offen offset:1024 lds
    s_waitcnt lgkmcnt(0)
    v_mfma_f32_32x32x16_bf16 v[72:87], v[56:59], v[48:51], v[72:87]
    v_mfma_f32_32x32x16_bf16 v[88:103], v[60:63], v[48:51], v[88:103]
    v_mfma_f32_32x32x16_bf16 v[104:119], v[56:59], v[52:55], v[104:119]
    v_mfma_f32_32x32x16_bf16 v[120:135], v[60:63], v[52:55], v[120:135]
    s_add_u32 m0, s46, 32768
    s_mov_b32 s48, 2097152
    buffer_load_dwordx4 v6, s[16:19], s48 offen lds
    v_mfma_f32_32x32x16_bf16 v[136:151], v[48:51], v[64:67], v[136:151]
    v_mfma_f32_32x32x16_bf16 v[152:167], v[48:51], v[68:71], v[152:167]
    v_mfma_f32_32x32x16_bf16 v[168:183], v[52:55], v[64:67], v[168:183]
    v_mfma_f32_32x32x16_bf16 v[184:199], v[52:55], v[68:71], v[184:199]
    s_add_u32 m0, s46, 40960
    s_nop 0
    buffer_load_dwordx4 v6, s[20:23], s48 offen lds
    s_waitcnt vmcnt(10)
    s_waitcnt vmcnt(8)
    s_barrier
    ds_read_b128 v[24:27], v8 offset:0
    ds_read_b128 v[28:31], v8 offset:4096
    ds_read_b64_tr_b16 v[32:33], v16 offset:0
    ds_read_b64_tr_b16 v[34:35], v16 offset:1024
    ds_read_b64_tr_b16 v[36:37], v17 offset:0
    ds_read_b64_tr_b16 v[38:39], v17 offset:1024
    ds_read_b64_tr_b16 v[40:41], v16 offset:8192
    ds_read_b64_tr_b16 v[42:43], v16 offset:9216
    ds_read_b64_tr_b16 v[44:45], v17 offset:8192
    ds_read_b64_tr_b16 v[46:47], v17 offset:9216
    ds_read_b128 v[48:51], v9 offset:0
    ds_read_b128 v[52:55], v9 offset:4096
    ds_read_b64_tr_b16 v[56:57], v16 offset:4096
    ds_read_b64_tr_b16 v[58:59], v16 offset:5120
    ds_read_b64_tr_b16 v[60:61], v17 offset:4096
    ds_read_b64_tr_b16 v[62:63], v17 offset:5120
    ds_read_b64_tr_b16 v[64:65], v16 offset:12288
    ds_read_b64_tr_b16 v[66:67], v16 offset:13312
    ds_read_b64_tr_b16 v[68:69], v17 offset:12288
    ds_read_b64_tr_b16 v[70:71], v17 offset:13312
    s_waitcnt lgkmcnt(10)
    v_mfma_f32_32x32x16_bf16 v[72:87], v[32:35], v[24:27], v[72:87]
    v_mfma_f32_32x32x16_bf16 v[88:103], v[36:39], v[24:27], v[88:103]
    v_mfma_f32_32x32x16_bf16 v[104:119], v[32:35], v[28:31], v[104:119]
    v_mfma_f32_32x32x16_bf16 v[120:135], v[36:39], v[28:31], v[120:135]
    s_add_u32 m0, s45, 65536
    s_mov_b32 s47, 640
    buffer_load_dwordx4 v4, s[8:11], s47 offen offset:0 lds
    v_mfma_f32_32x32x16_bf16 v[136:151], v[24:27], v[40:43], v[136:151]
    v_mfma_f32_32x32x16_bf16 v[152:167], v[24:27], v[44:47], v[152:167]
    v_mfma_f32_32x32x16_bf16 v[168:183], v[28:31], v[40:43], v[168:183]
    v_mfma_f32_32x32x16_bf16 v[184:199], v[28:31], v[44:47], v[184:199]
    buffer_load_dwordx4 v5, s[8:11], s47 offen offset:1024 lds
    s_waitcnt lgkmcnt(0)
    v_mfma_f32_32x32x16_bf16 v[72:87], v[56:59], v[48:51], v[72:87]
    v_mfma_f32_32x32x16_bf16 v[88:103], v[60:63], v[48:51], v[88:103]
    v_mfma_f32_32x32x16_bf16 v[104:119], v[56:59], v[52:55], v[104:119]
    v_mfma_f32_32x32x16_bf16 v[120:135], v[60:63], v[52:55], v[120:135]
    s_add_u32 m0, s46, 49152
    s_mov_b32 s48, 2359296
    buffer_load_dwordx4 v6, s[16:19], s48 offen lds
    v_mfma_f32_32x32x16_bf16 v[136:151], v[48:51], v[64:67], v[136:151]
    v_mfma_f32_32x32x16_bf16 v[152:167], v[48:51], v[68:71], v[152:167]
    v_mfma_f32_32x32x16_bf16 v[168:183], v[52:55], v[64:67], v[168:183]
    v_mfma_f32_32x32x16_bf16 v[184:199], v[52:55], v[68:71], v[184:199]
    s_add_u32 m0, s46, 57344
    s_nop 0
    buffer_load_dwordx4 v6, s[20:23], s48 offen lds
    s_waitcnt vmcnt(8)
    s_barrier
    ds_read_b128 v[24:27], v10 offset:0
    ds_read_b128 v[28:31], v10 offset:4096
    ds_read_b64_tr_b16 v[32:33], v16 offset:16384
    ds_read_b64_tr_b16 v[34:35], v16 offset:17408
    ds_read_b64_tr_b16 v[36:37], v17 offset:16384
    ds_read_b64_tr_b16 v[38:39], v17 offset:17408
    ds_read_b64_tr_b16 v[40:41], v16 offset:24576
    ds_read_b64_tr_b16 v[42:43], v16 offset:25600
    ds_read_b64_tr_b16 v[44:45], v17 offset:24576
    ds_read_b64_tr_b16 v[46:47], v17 offset:25600
    ds_read_b128 v[48:51], v11 offset:0
    ds_read_b128 v[52:55], v11 offset:4096
    ds_read_b64_tr_b16 v[56:57], v16 offset:20480
    ds_read_b64_tr_b16 v[58:59], v16 offset:21504
    ds_read_b64_tr_b16 v[60:61], v17 offset:20480
    ds_read_b64_tr_b16 v[62:63], v17 offset:21504
    ds_read_b64_tr_b16 v[64:65], v16 offset:28672
    ds_read_b64_tr_b16 v[66:67], v16 offset:29696
    ds_read_b64_tr_b16 v[68:69], v17 offset:28672
    ds_read_b64_tr_b16 v[70:71], v17 offset:29696
    s_waitcnt lgkmcnt(10)
    v_mfma_f32_32x32x16_bf16 v[72:87], v[32:35], v[24:27], v[72:87]
    v_mfma_f32_32x32x16_bf16 v[88:103], v[36:39], v[24:27], v[88:103]
    v_mfma_f32_32x32x16_bf16 v[104:119], v[32:35], v[28:31], v[104:119]
    v_mfma_f32_32x32x16_bf16 v[120:135], v[36:39], v[28:31], v[120:135]
    s_add_u32 m0, s45, 81920
    s_mov_b32 s47, 131712
    buffer_load_dwordx4 v4, s[8:11], s47 offen offset:0 lds
    v_mfma_f32_32x32x16_bf16 v[136:151], v[24:27], v[40:43], v[136:151]
    v_mfma_f32_32x32x16_bf16 v[152:167], v[24:27], v[44:47], v[152:167]
    v_mfma_f32_32x32x16_bf16 v[168:183], v[28:31], v[40:43], v[168:183]
    v_mfma_f32_32x32x16_bf16 v[184:199], v[28:31], v[44:47], v[184:199]
    buffer_load_dwordx4 v5, s[8:11], s47 offen offset:1024 lds
    s_waitcnt lgkmcnt(0)
    v_mfma_f32_32x32x16_bf16 v[72:87], v[56:59], v[48:51], v[72:87]
    v_mfma_f32_32x32x16_bf16 v[88:103], v[60:63], v[48:51], v[88:103]
    v_mfma_f32_32x32x16_bf16 v[104:119], v[56:59], v[52:55], v[104:119]
    v_mfma_f32_32x32x16_bf16 v[120:135], v[60:63], v[52:55], v[120:135]
    s_add_u32 m0, s46, 0
    s_mov_b32 s48, 2621440
    buffer_load_dwordx4 v6, s[16:19], s48 offen lds
    v_mfma_f32_32x32x16_bf16 v[136:151], v[48:51], v[64:67], v[136:151]
    v_mfma_f32_32x32x16_bf16 v[152:167], v[48:51], v[68:71], v[152:167]
    v_mfma_f32_32x32x16_bf16 v[168:183], v[52:55], v[64:67], v[168:183]
    v_mfma_f32_32x32x16_bf16 v[184:199], v[52:55], v[68:71], v[184:199]
    s_add_u32 m0, s46, 8192
    s_nop 0
    buffer_load_dwordx4 v6, s[20:23], s48 offen lds
    s_waitcnt vmcnt(10)
    s_waitcnt vmcnt(8)
    s_barrier
    ds_read_b128 v[24:27], v8 offset:32768
    ds_read_b128 v[28:31], v8 offset:36864
    ds_read_b64_tr_b16 v[32:33], v16 offset:32768
    ds_read_b64_tr_b16 v[34:35], v16 offset:33792
    ds_read_b64_tr_b16 v[36:37], v17 offset:32768
    ds_read_b64_tr_b16 v[38:39], v17 offset:33792
    ds_read_b64_tr_b16 v[40:41], v16 offset:40960
    ds_read_b64_tr_b16 v[42:43], v16 offset:41984
    ds_read_b64_tr_b16 v[44:45], v17 offset:40960
    ds_read_b64_tr_b16 v[46:47], v17 offset:41984
    ds_read_b128 v[48:51], v9 offset:32768
    ds_read_b128 v[52:55], v9 offset:36864
    ds_read_b64_tr_b16 v[56:57], v16 offset:36864
    ds_read_b64_tr_b16 v[58:59], v16 offset:37888
    ds_read_b64_tr_b16 v[60:61], v17 offset:36864
    ds_read_b64_tr_b16 v[62:63], v17 offset:37888
    ds_read_b64_tr_b16 v[64:65], v16 offset:45056
    ds_read_b64_tr_b16 v[66:67], v16 offset:46080
    ds_read_b64_tr_b16 v[68:69], v17 offset:45056
    ds_read_b64_tr_b16 v[70:71], v17 offset:46080
    s_waitcnt lgkmcnt(10)
    v_mfma_f32_32x32x16_bf16 v[72:87], v[32:35], v[24:27], v[72:87]
    v_mfma_f32_32x32x16_bf16 v[88:103], v[36:39], v[24:27], v[88:103]
    v_mfma_f32_32x32x16_bf16 v[104:119], v[32:35], v[28:31], v[104:119]
    v_mfma_f32_32x32x16_bf16 v[120:135], v[36:39], v[28:31], v[120:135]
    s_add_u32 m0, s45, 0
    s_mov_b32 s47, 768
    buffer_load_dwordx4 v4, s[8:11], s47 offen offset:0 lds
    v_mfma_f32_32x32x16_bf16 v[136:151], v[24:27], v[40:43], v[136:151]
    v_mfma_f32_32x32x16_bf16 v[152:167], v[24:27], v[44:47], v[152:167]
    v_mfma_f32_32x32x16_bf16 v[168:183], v[28:31], v[40:43], v[168:183]
    v_mfma_f32_32x32x16_bf16 v[184:199], v[28:31], v[44:47], v[184:199]
    buffer_load_dwordx4 v5, s[8:11], s47 offen offset:1024 lds
    s_waitcnt lgkmcnt(0)
    v_mfma_f32_32x32x16_bf16 v[72:87], v[56:59], v[48:51], v[72:87]
    v_mfma_f32_32x32x16_bf16 v[88:103], v[60:63], v[48:51], v[88:103]
    v_mfma_f32_32x32x16_bf16 v[104:119], v[56:59], v[52:55], v[104:119]
    v_mfma_f32_32x32x16_bf16 v[120:135], v[60:63], v[52:55], v[120:135]
    s_add_u32 m0, s46, 16384
    s_mov_b32 s48, 2883584
    buffer_load_dwordx4 v6, s[16:19], s48 offen lds
    v_mfma_f32_32x32x16_bf16 v[136:151], v[48:51], v[64:67], v[136:151]
    v_mfma_f32_32x32x16_bf16 v[152:167], v[48:51], v[68:71], v[152:167]
    v_mfma_f32_32x32x16_bf16 v[168:183], v[52:55], v[64:67], v[168:183]
    v_mfma_f32_32x32x16_bf16 v[184:199], v[52:55], v[68:71], v[184:199]
    s_add_u32 m0, s46, 24576
    s_nop 0
    buffer_load_dwordx4 v6, s[20:23], s48 offen lds
    s_waitcnt vmcnt(8)
    s_barrier
    ds_read_b128 v[24:27], v10 offset:32768
    ds_read_b128 v[28:31], v10 offset:36864
    ds_read_b64_tr_b16 v[32:33], v16 offset:49152
    ds_read_b64_tr_b16 v[34:35], v16 offset:50176
    ds_read_b64_tr_b16 v[36:37], v17 offset:49152
    ds_read_b64_tr_b16 v[38:39], v17 offset:50176
    ds_read_b64_tr_b16 v[40:41], v16 offset:57344
    ds_read_b64_tr_b16 v[42:43], v16 offset:58368
    ds_read_b64_tr_b16 v[44:45], v17 offset:57344
    ds_read_b64_tr_b16 v[46:47], v17 offset:58368
    ds_read_b128 v[48:51], v11 offset:32768
    ds_read_b128 v[52:55], v11 offset:36864
    ds_read_b64_tr_b16 v[56:57], v16 offset:53248
    ds_read_b64_tr_b16 v[58:59], v16 offset:54272
    ds_read_b64_tr_b16 v[60:61], v17 offset:53248
    ds_read_b64_tr_b16 v[62:63], v17 offset:54272
    ds_read_b64_tr_b16 v[64:65], v16 offset:61440
    ds_read_b64_tr_b16 v[66:67], v16 offset:62464
    ds_read_b64_tr_b16 v[68:69], v17 offset:61440
    ds_read_b64_tr_b16 v[70:71], v17 offset:62464
    s_waitcnt lgkmcnt(10)
    v_mfma_f32_32x32x16_bf16 v[72:87], v[32:35], v[24:27], v[72:87]
    v_mfma_f32_32x32x16_bf16 v[88:103], v[36:39], v[24:27], v[88:103]
    v_mfma_f32_32x32x16_bf16 v[104:119], v[32:35], v[28:31], v[104:119]
    v_mfma_f32_32x32x16_bf16 v[120:135], v[36:39], v[28:31], v[120:135]
    s_add_u32 m0, s45, 16384
    s_mov_b32 s47, 131840
    buffer_load_dwordx4 v4, s[8:11], s47 offen offset:0 lds
    v_mfma_f32_32x32x16_bf16 v[136:151], v[24:27], v[40:43], v[136:151]
    v_mfma_f32_32x32x16_bf16 v[152:167], v[24:27], v[44:47], v[152:167]
    v_mfma_f32_32x32x16_bf16 v[168:183], v[28:31], v[40:43], v[168:183]
    v_mfma_f32_32x32x16_bf16 v[184:199], v[28:31], v[44:47], v[184:199]
    buffer_load_dwordx4 v5, s[8:11], s47 offen offset:1024 lds
    s_waitcnt lgkmcnt(0)
    v_mfma_f32_32x32x16_bf16 v[72:87], v[56:59], v[48:51], v[72:87]
    v_mfma_f32_32x32x16_bf16 v[88:103], v[60:63], v[48:51], v[88:103]
    v_mfma_f32_32x32x16_bf16 v[104:119], v[56:59], v[52:55], v[104:119]
    v_mfma_f32_32x32x16_bf16 v[120:135], v[60:63], v[52:55], v[120:135]
    s_add_u32 m0, s46, 32768
    s_mov_b32 s48, 3145728
    buffer_load_dwordx4 v6, s[16:19], s48 offen lds
    v_mfma_f32_32x32x16_bf16 v[136:151], v[48:51], v[64:67], v[136:151]
    v_mfma_f32_32x32x16_bf16 v[152:167], v[48:51], v[68:71], v[152:167]
    v_mfma_f32_32x32x16_bf16 v[168:183], v[52:55], v[64:67], v[168:183]
    v_mfma_f32_32x32x16_bf16 v[184:199], v[52:55], v[68:71], v[184:199]
    s_add_u32 m0, s46, 40960
    s_nop 0
    buffer_load_dwordx4 v6, s[20:23], s48 offen lds
    s_waitcnt vmcnt(10)
    s_waitcnt vmcnt(8)
    s_barrier
    ds_read_b128 v[24:27], v12 offset:0
    ds_read_b128 v[28:31], v12 offset:4096
    ds_read_b64_tr_b16 v[32:33], v16 offset:0
    ds_read_b64_tr_b16 v[34:35], v16 offset:1024
    ds_read_b64_tr_b16 v[36:37], v17 offset:0
    ds_read_b64_tr_b16 v[38:39], v17 offset:1024
    ds_read_b64_tr_b16 v[40:41], v16 offset:8192
    ds_read_b64_tr_b16 v[42:43], v16 offset:9216
    ds_read_b64_tr_b16 v[44:45], v17 offset:8192
    ds_read_b64_tr_b16 v[46:47], v17 offset:9216
    ds_read_b128 v[48:51], v13 offset:0
    ds_read_b128 v[52:55], v13 offset:4096
    ds_read_b64_tr_b16 v[56:57], v16 offset:4096
    ds_read_b64_tr_b16 v[58:59], v16 offset:5120
    ds_read_b64_tr_b16 v[60:61], v17 offset:4096
    ds_read_b64_tr_b16 v[62:63], v17 offset:5120
    ds_read_b64_tr_b16 v[64:65], v16 offset:12288
    ds_read_b64_tr_b16 v[66:67], v16 offset:13312
    ds_read_b64_tr_b16 v[68:69], v17 offset:12288
    ds_read_b64_tr_b16 v[70:71], v17 offset:13312
    s_waitcnt lgkmcnt(10)
    v_mfma_f32_32x32x16_bf16 v[72:87], v[32:35], v[24:27], v[72:87]
    v_mfma_f32_32x32x16_bf16 v[88:103], v[36:39], v[24:27], v[88:103]
    v_mfma_f32_32x32x16_bf16 v[104:119], v[32:35], v[28:31], v[104:119]
    v_mfma_f32_32x32x16_bf16 v[120:135], v[36:39], v[28:31], v[120:135]
    s_add_u32 m0, s45, 32768
    s_mov_b32 s47, 896
    buffer_load_dwordx4 v4, s[8:11], s47 offen offset:0 lds
    v_mfma_f32_32x32x16_bf16 v[136:151], v[24:27], v[40:43], v[136:151]
    v_mfma_f32_32x32x16_bf16 v[152:167], v[24:27], v[44:47], v[152:167]
    v_mfma_f32_32x32x16_bf16 v[168:183], v[28:31], v[40:43], v[168:183]
    v_mfma_f32_32x32x16_bf16 v[184:199], v[28:31], v[44:47], v[184:199]
    buffer_load_dwordx4 v5, s[8:11], s47 offen offset:1024 lds
    s_waitcnt lgkmcnt(0)
    v_mfma_f32_32x32x16_bf16 v[72:87], v[56:59], v[48:51], v[72:87]
    v_mfma_f32_32x32x16_bf16 v[88:103], v[60:63], v[48:51], v[88:103]
    v_mfma_f32_32x32x16_bf16 v[104:119], v[56:59], v[52:55], v[104:119]
    v_mfma_f32_32x32x16_bf16 v[120:135], v[60:63], v[52:55], v[120:135]
    s_add_u32 m0, s46, 49152
    s_mov_b32 s48, 3407872
    buffer_load_dwordx4 v6, s[16:19], s48 offen lds
    v_mfma_f32_32x32x16_bf16 v[136:151], v[48:51], v[64:67], v[136:151]
    v_mfma_f32_32x32x16_bf16 v[152:167], v[48:51], v[68:71], v[152:167]
    v_mfma_f32_32x32x16_bf16 v[168:183], v[52:55], v[64:67], v[168:183]
    v_mfma_f32_32x32x16_bf16 v[184:199], v[52:55], v[68:71], v[184:199]
    s_add_u32 m0, s46, 57344
    s_nop 0
    buffer_load_dwordx4 v6, s[20:23], s48 offen lds
    s_waitcnt vmcnt(8)
    s_barrier
    ds_read_b128 v[24:27], v14 offset:0
    ds_read_b128 v[28:31], v14 offset:4096
    ds_read_b64_tr_b16 v[32:33], v16 offset:16384
    ds_read_b64_tr_b16 v[34:35], v16 offset:17408
    ds_read_b64_tr_b16 v[36:37], v17 offset:16384
    ds_read_b64_tr_b16 v[38:39], v17 offset:17408
    ds_read_b64_tr_b16 v[40:41], v16 offset:24576
    ds_read_b64_tr_b16 v[42:43], v16 offset:25600
    ds_read_b64_tr_b16 v[44:45], v17 offset:24576
    ds_read_b64_tr_b16 v[46:47], v17 offset:25600
    ds_read_b128 v[48:51], v15 offset:0
    ds_read_b128 v[52:55], v15 offset:4096
    ds_read_b64_tr_b16 v[56:57], v16 offset:20480
    ds_read_b64_tr_b16 v[58:59], v16 offset:21504
    ds_read_b64_tr_b16 v[60:61], v17 offset:20480
    ds_read_b64_tr_b16 v[62:63], v17 offset:21504
    ds_read_b64_tr_b16 v[64:65], v16 offset:28672
    ds_read_b64_tr_b16 v[66:67], v16 offset:29696
    ds_read_b64_tr_b16 v[68:69], v17 offset:28672
    ds_read_b64_tr_b16 v[70:71], v17 offset:29696
    s_waitcnt lgkmcnt(10)
    v_mfma_f32_32x32x16_bf16 v[72:87], v[32:35], v[24:27], v[72:87]
    v_mfma_f32_32x32x16_bf16 v[88:103], v[36:39], v[24:27], v[88:103]
    v_mfma_f32_32x32x16_bf16 v[104:119], v[32:35], v[28:31], v[104:119]
    v_mfma_f32_32x32x16_bf16 v[120:135], v[36:39], v[28:31], v[120:135]
    s_add_u32 m0, s45, 49152
    s_mov_b32 s47, 131968
    buffer_load_dwordx4 v4, s[8:11], s47 offen offset:0 lds
    v_mfma_f32_32x32x16_bf16 v[136:151], v[24:27], v[40:43], v[136:151]
    v_mfma_f32_32x32x16_bf16 v[152:167], v[24:27], v[44:47], v[152:167]
    v_mfma_f32_32x32x16_bf16 v[168:183], v[28:31], v[40:43], v[168:183]
    v_mfma_f32_32x32x16_bf16 v[184:199], v[28:31], v[44:47], v[184:199]
    buffer_load_dwordx4 v5, s[8:11], s47 offen offset:1024 lds
    s_waitcnt lgkmcnt(0)
    v_mfma_f32_32x32x16_bf16 v[72:87], v[56:59], v[48:51], v[72:87]
    v_mfma_f32_32x32x16_bf16 v[88:103], v[60:63], v[48:51], v[88:103]
    v_mfma_f32_32x32x16_bf16 v[104:119], v[56:59], v[52:55], v[104:119]
    v_mfma_f32_32x32x16_bf16 v[120:135], v[60:63], v[52:55], v[120:135]
    s_add_u32 m0, s46, 0
    s_mov_b32 s48, 3670016
    buffer_load_dwordx4 v6, s[16:19], s48 offen lds
    v_mfma_f32_32x32x16_bf16 v[136:151], v[48:51], v[64:67], v[136:151]
    v_mfma_f32_32x32x16_bf16 v[152:167], v[48:51], v[68:71], v[152:167]
    v_mfma_f32_32x32x16_bf16 v[168:183], v[52:55], v[64:67], v[168:183]
    v_mfma_f32_32x32x16_bf16 v[184:199], v[52:55], v[68:71], v[184:199]
    s_add_u32 m0, s46, 8192
    s_nop 0
    buffer_load_dwordx4 v6, s[20:23], s48 offen lds
    s_waitcnt vmcnt(10)
    s_waitcnt vmcnt(8)
    s_barrier
    ds_read_b128 v[24:27], v8 offset:0
    ds_read_b128 v[28:31], v8 offset:4096
    ds_read_b64_tr_b16 v[32:33], v16 offset:32768
    ds_read_b64_tr_b16 v[34:35], v16 offset:33792
    ds_read_b64_tr_b16 v[36:37], v17 offset:32768
    ds_read_b64_tr_b16 v[38:39], v17 offset:33792
    ds_read_b64_tr_b16 v[40:41], v16 offset:40960
    ds_read_b64_tr_b16 v[42:43], v16 offset:41984
    ds_read_b64_tr_b16 v[44:45], v17 offset:40960
    ds_read_b64_tr_b16 v[46:47], v17 offset:41984
    ds_read_b128 v[48:51], v9 offset:0
    ds_read_b128 v[52:55], v9 offset:4096
    ds_read_b64_tr_b16 v[56:57], v16 offset:36864
    ds_read_b64_tr_b16 v[58:59], v16 offset:37888
    ds_read_b64_tr_b16 v[60:61], v17 offset:36864
    ds_read_b64_tr_b16 v[62:63], v17 offset:37888
    ds_read_b64_tr_b16 v[64:65], v16 offset:45056
    ds_read_b64_tr_b16 v[66:67], v16 offset:46080
    ds_read_b64_tr_b16 v[68:69], v17 offset:45056
    ds_read_b64_tr_b16 v[70:71], v17 offset:46080
    s_waitcnt lgkmcnt(10)
    v_mfma_f32_32x32x16_bf16 v[72:87], v[32:35], v[24:27], v[72:87]
    v_mfma_f32_32x32x16_bf16 v[88:103], v[36:39], v[24:27], v[88:103]
    v_mfma_f32_32x32x16_bf16 v[104:119], v[32:35], v[28:31], v[104:119]
    v_mfma_f32_32x32x16_bf16 v[120:135], v[36:39], v[28:31], v[120:135]
    v_mfma_f32_32x32x16_bf16 v[136:151], v[24:27], v[40:43], v[136:151]
    v_mfma_f32_32x32x16_bf16 v[152:167], v[24:27], v[44:47], v[152:167]
    v_mfma_f32_32x32x16_bf16 v[168:183], v[28:31], v[40:43], v[168:183]
    v_mfma_f32_32x32x16_bf16 v[184:199], v[28:31], v[44:47], v[184:199]
    s_add_u32 m0, s46, 16384
    s_mov_b32 s48, 3932160
    buffer_load_dwordx4 v6, s[16:19], s48 offen lds
    s_waitcnt lgkmcnt(0)
    v_mfma_f32_32x32x16_bf16 v[72:87], v[56:59], v[48:51], v[72:87]
    v_mfma_f32_32x32x16_bf16 v[88:103], v[60:63], v[48:51], v[88:103]
    v_mfma_f32_32x32x16_bf16 v[104:119], v[56:59], v[52:55], v[104:119]
    v_mfma_f32_32x32x16_bf16 v[120:135], v[60:63], v[52:55], v[120:135]
    v_mfma_f32_32x32x16_bf16 v[136:151], v[48:51], v[64:67], v[136:151]
    v_mfma_f32_32x32x16_bf16 v[152:167], v[48:51], v[68:71], v[152:167]
    v_mfma_f32_32x32x16_bf16 v[168:183], v[52:55], v[64:67], v[168:183]
    v_mfma_f32_32x32x16_bf16 v[184:199], v[52:55], v[68:71], v[184:199]
    s_add_u32 m0, s46, 24576
    s_nop 0
    buffer_load_dwordx4 v6, s[20:23], s48 offen lds
    s_waitcnt vmcnt(6)
    s_barrier
    ds_read_b128 v[24:27], v10 offset:0
    ds_read_b128 v[28:31], v10 offset:4096
    ds_read_b64_tr_b16 v[32:33], v16 offset:49152
    ds_read_b64_tr_b16 v[34:35], v16 offset:50176
    ds_read_b64_tr_b16 v[36:37], v17 offset:49152
    ds_read_b64_tr_b16 v[38:39], v17 offset:50176
    ds_read_b64_tr_b16 v[40:41], v16 offset:57344
    ds_read_b64_tr_b16 v[42:43], v16 offset:58368
    ds_read_b64_tr_b16 v[44:45], v17 offset:57344
    ds_read_b64_tr_b16 v[46:47], v17 offset:58368
    ds_read_b128 v[48:51], v11 offset:0
    ds_read_b128 v[52:55], v11 offset:4096
    ds_read_b64_tr_b16 v[56:57], v16 offset:53248
    ds_read_b64_tr_b16 v[58:59], v16 offset:54272
    ds_read_b64_tr_b16 v[60:61], v17 offset:53248
    ds_read_b64_tr_b16 v[62:63], v17 offset:54272
    ds_read_b64_tr_b16 v[64:65], v16 offset:61440
    ds_read_b64_tr_b16 v[66:67], v16 offset:62464
    ds_read_b64_tr_b16 v[68:69], v17 offset:61440
    ds_read_b64_tr_b16 v[70:71], v17 offset:62464
    s_waitcnt lgkmcnt(10)
    v_mfma_f32_32x32x16_bf16 v[72:87], v[32:35], v[24:27], v[72:87]
    v_mfma_f32_32x32x16_bf16 v[88:103], v[36:39], v[24:27], v[88:103]
    v_mfma_f32_32x32x16_bf16 v[104:119], v[32:35], v[28:31], v[104:119]
    v_mfma_f32_32x32x16_bf16 v[120:135], v[36:39], v[28:31], v[120:135]
    v_mfma_f32_32x32x16_bf16 v[136:151], v[24:27], v[40:43], v[136:151]
    v_mfma_f32_32x32x16_bf16 v[152:167], v[24:27], v[44:47], v[152:167]
    v_mfma_f32_32x32x16_bf16 v[168:183], v[28:31], v[40:43], v[168:183]
    v_mfma_f32_32x32x16_bf16 v[184:199], v[28:31], v[44:47], v[184:199]
    s_waitcnt lgkmcnt(0)
    v_mfma_f32_32x32x16_bf16 v[72:87], v[56:59], v[48:51], v[72:87]
    v_mfma_f32_32x32x16_bf16 v[88:103], v[60:63], v[48:51], v[88:103]
    v_mfma_f32_32x32x16_bf16 v[104:119], v[56:59], v[52:55], v[104:119]
    v_mfma_f32_32x32x16_bf16 v[120:135], v[60:63], v[52:55], v[120:135]
    v_mfma_f32_32x32x16_bf16 v[136:151], v[48:51], v[64:67], v[136:151]
    v_mfma_f32_32x32x16_bf16 v[152:167], v[48:51], v[68:71], v[152:167]
    v_mfma_f32_32x32x16_bf16 v[168:183], v[52:55], v[64:67], v[168:183]
    v_mfma_f32_32x32x16_bf16 v[184:199], v[52:55], v[68:71], v[184:199]
    s_waitcnt vmcnt(4)
    s_waitcnt vmcnt(2)
    s_barrier
    ds_read_b128 v[24:27], v8 offset:32768
    ds_read_b128 v[28:31], v8 offset:36864
    ds_read_b64_tr_b16 v[32:33], v16 offset:0
    ds_read_b64_tr_b16 v[34:35], v16 offset:1024
    ds_read_b64_tr_b16 v[36:37], v17 offset:0
    ds_read_b64_tr_b16 v[38:39], v17 offset:1024
    ds_read_b64_tr_b16 v[40:41], v16 offset:8192
    ds_read_b64_tr_b16 v[42:43], v16 offset:9216
    ds_read_b64_tr_b16 v[44:45], v17 offset:8192
    ds_read_b64_tr_b16 v[46:47], v17 offset:9216
    ds_read_b128 v[48:51], v9 offset:32768
    ds_read_b128 v[52:55], v9 offset:36864
    ds_read_b64_tr_b16 v[56:57], v16 offset:4096
    ds_read_b64_tr_b16 v[58:59], v16 offset:5120
    ds_read_b64_tr_b16 v[60:61], v17 offset:4096
    ds_read_b64_tr_b16 v[62:63], v17 offset:5120
    ds_read_b64_tr_b16 v[64:65], v16 offset:12288
    ds_read_b64_tr_b16 v[66:67], v16 offset:13312
    ds_read_b64_tr_b16 v[68:69], v17 offset:12288
    ds_read_b64_tr_b16 v[70:71], v17 offset:13312
    s_waitcnt lgkmcnt(10)
    v_mfma_f32_32x32x16_bf16 v[72:87], v[32:35], v[24:27], v[72:87]
    v_mfma_f32_32x32x16_bf16 v[88:103], v[36:39], v[24:27], v[88:103]
    v_mfma_f32_32x32x16_bf16 v[104:119], v[32:35], v[28:31], v[104:119]
    v_mfma_f32_32x32x16_bf16 v[120:135], v[36:39], v[28:31], v[120:135]
    v_mfma_f32_32x32x16_bf16 v[136:151], v[24:27], v[40:43], v[136:151]
    v_mfma_f32_32x32x16_bf16 v[152:167], v[24:27], v[44:47], v[152:167]
    v_mfma_f32_32x32x16_bf16 v[168:183], v[28:31], v[40:43], v[168:183]
    v_mfma_f32_32x32x16_bf16 v[184:199], v[28:31], v[44:47], v[184:199]
    s_waitcnt lgkmcnt(0)
    v_mfma_f32_32x32x16_bf16 v[72:87], v[56:59], v[48:51], v[72:87]
    v_mfma_f32_32x32x16_bf16 v[88:103], v[60:63], v[48:51], v[88:103]
    v_mfma_f32_32x32x16_bf16 v[104:119], v[56:59], v[52:55], v[104:119]
    v_mfma_f32_32x32x16_bf16 v[120:135], v[60:63], v[52:55], v[120:135]
    v_mfma_f32_32x32x16_bf16 v[136:151], v[48:51], v[64:67], v[136:151]
    v_mfma_f32_32x32x16_bf16 v[152:167], v[48:51], v[68:71], v[152:167]
    v_mfma_f32_32x32x16_bf16 v[168:183], v[52:55], v[64:67], v[168:183]
    v_mfma_f32_32x32x16_bf16 v[184:199], v[52:55], v[68:71], v[184:199]
    s_waitcnt vmcnt(0)
    s_barrier
    ds_read_b128 v[24:27], v10 offset:32768
    ds_read_b128 v[28:31], v10 offset:36864
    ds_read_b64_tr_b16 v[32:33], v16 offset:16384
    ds_read_b64_tr_b16 v[34:35], v16 offset:17408
    ds_read_b64_tr_b16 v[36:37], v17 offset:16384
    ds_read_b64_tr_b16 v[38:39], v17 offset:17408
    ds_read_b64_tr_b16 v[40:41], v16 offset:24576
    ds_read_b64_tr_b16 v[42:43], v16 offset:25600
    ds_read_b64_tr_b16 v[44:45], v17 offset:24576
    ds_read_b64_tr_b16 v[46:47], v17 offset:25600
    ds_read_b128 v[48:51], v11 offset:32768
    ds_read_b128 v[52:55], v11 offset:36864
    ds_read_b64_tr_b16 v[56:57], v16 offset:20480
    ds_read_b64_tr_b16 v[58:59], v16 offset:21504
    ds_read_b64_tr_b16 v[60:61], v17 offset:20480
    ds_read_b64_tr_b16 v[62:63], v17 offset:21504
    ds_read_b64_tr_b16 v[64:65], v16 offset:28672
    ds_read_b64_tr_b16 v[66:67], v16 offset:29696
    ds_read_b64_tr_b16 v[68:69], v17 offset:28672
    ds_read_b64_tr_b16 v[70:71], v17 offset:29696
    s_waitcnt lgkmcnt(10)
    v_mfma_f32_32x32x16_bf16 v[72:87], v[32:35], v[24:27], v[72:87]
    v_mfma_f32_32x32x16_bf16 v[88:103], v[36:39], v[24:27], v[88:103]
    v_mfma_f32_32x32x16_bf16 v[104:119], v[32:35], v[28:31], v[104:119]
    v_mfma_f32_32x32x16_bf16 v[120:135], v[36:39], v[28:31], v[120:135]
    v_mfma_f32_32x32x16_bf16 v[136:151], v[24:27], v[40:43], v[136:151]
    v_mfma_f32_32x32x16_bf16 v[152:167], v[24:27], v[44:47], v[152:167]
    v_mfma_f32_32x32x16_bf16 v[168:183], v[28:31], v[40:43], v[168:183]
    v_mfma_f32_32x32x16_bf16 v[184:199], v[28:31], v[44:47], v[184:199]
    s_waitcnt lgkmcnt(0)
    v_mfma_f32_32x32x16_bf16 v[72:87], v[56:59], v[48:51], v[72:87]
    v_mfma_f32_32x32x16_bf16 v[88:103], v[60:63], v[48:51], v[88:103]
    v_mfma_f32_32x32x16_bf16 v[104:119], v[56:59], v[52:55], v[104:119]
    v_mfma_f32_32x32x16_bf16 v[120:135], v[60:63], v[52:55], v[120:135]
    v_mfma_f32_32x32x16_bf16 v[136:151], v[48:51], v[64:67], v[136:151]
    v_mfma_f32_32x32x16_bf16 v[152:167], v[48:51], v[68:71], v[152:167]
    v_mfma_f32_32x32x16_bf16 v[168:183], v[52:55], v[64:67], v[168:183]
    v_mfma_f32_32x32x16_bf16 v[184:199], v[52:55], v[68:71], v[184:199]
    s_add_u32 s52, s34, 16777216
    s_addc_u32 s53, s35, 0
    s_and_b32 s53, s53, 0xffff
    s_mov_b32 s54, 16777216
    s_mov_b32 s55, 0x00020000
    s_add_u32 s56, s34, 33554432
    s_addc_u32 s57, s35, 0
    s_and_b32 s57, s57, 0xffff
    s_mov_b32 s58, 16777216
    s_mov_b32 s59, 0x00020000
    s_lshl_b32 s47, s41, 6
    s_lshl_b32 s48, s42, 3
    s_add_u32 s47, s47, s48
    s_lshl_b32 s48, s43, 1
    s_add_u32 s47, s47, s48
    s_lshl_b32 s47, s47, 13
    s_lshl_b32 s48, s44, 12
    s_add_u32 s47, s47, s48
    v_lshlrev_b32 v24, 4, v1
    v_add_u32 v24, s47, v24
    v_add_u32 v25, 8192, v24
    v_cvt_pk_bf16_f32 v72, v72, v73
    v_cvt_pk_bf16_f32 v73, v74, v75
    v_cvt_pk_bf16_f32 v74, v76, v77
    v_cvt_pk_bf16_f32 v75, v78, v79
    v_cvt_pk_bf16_f32 v80, v80, v81
    v_cvt_pk_bf16_f32 v81, v82, v83
    v_cvt_pk_bf16_f32 v82, v84, v85
    v_cvt_pk_bf16_f32 v83, v86, v87
    s_nop 1
    v_permlane32_swap_b32 v72, v74
    v_permlane32_swap_b32 v73, v75
    v_permlane32_swap_b32 v80, v82
    v_permlane32_swap_b32 v81, v83
    buffer_store_dwordx4 v[72:75], v24, s[52:55], 0 offen offset:0
    buffer_store_dwordx4 v[80:83], v24, s[52:55], 0 offen offset:1024
    v_cvt_pk_bf16_f32 v88, v88, v89
    v_cvt_pk_bf16_f32 v89, v90, v91
    v_cvt_pk_bf16_f32 v90, v92, v93
    v_cvt_pk_bf16_f32 v91, v94, v95
    v_cvt_pk_bf16_f32 v96, v96, v97
    v_cvt_pk_bf16_f32 v97, v98, v99
    v_cvt_pk_bf16_f32 v98, v100, v101
    v_cvt_pk_bf16_f32 v99, v102, v103
    s_nop 1
    v_permlane32_swap_b32 v88, v90
    v_permlane32_swap_b32 v89, v91
    v_permlane32_swap_b32 v96, v98
    v_permlane32_swap_b32 v97, v99
    buffer_store_dwordx4 v[88:91], v24, s[52:55], 0 offen offset:2048
    buffer_store_dwordx4 v[96:99], v24, s[52:55], 0 offen offset:3072
    v_cvt_pk_bf16_f32 v104, v104, v105
    v_cvt_pk_bf16_f32 v105, v106, v107
    v_cvt_pk_bf16_f32 v106, v108, v109
    v_cvt_pk_bf16_f32 v107, v110, v111
    v_cvt_pk_bf16_f32 v112, v112, v113
    v_cvt_pk_bf16_f32 v113, v114, v115
    v_cvt_pk_bf16_f32 v114, v116, v117
    v_cvt_pk_bf16_f32 v115, v118, v119
    s_nop 1
    v_permlane32_swap_b32 v104, v106
    v_permlane32_swap_b32 v105, v107
    v_permlane32_swap_b32 v112, v114
    v_permlane32_swap_b32 v113, v115
    buffer_store_dwordx4 v[104:107], v25, s[52:55], 0 offen offset:0
    buffer_store_dwordx4 v[112:115], v25, s[52:55], 0 offen offset:1024
    v_cvt_pk_bf16_f32 v120, v120, v121
    v_cvt_pk_bf16_f32 v121, v122, v123
    v_cvt_pk_bf16_f32 v122, v124, v125
    v_cvt_pk_bf16_f32 v123, v126, v127
    v_cvt_pk_bf16_f32 v128, v128, v129
    v_cvt_pk_bf16_f32 v129, v130, v131
    v_cvt_pk_bf16_f32 v130, v132, v133
    v_cvt_pk_bf16_f32 v131, v134, v135
    s_nop 1
    v_permlane32_swap_b32 v120, v122
    v_permlane32_swap_b32 v121, v123
    v_permlane32_swap_b32 v128, v130
    v_permlane32_swap_b32 v129, v131
    buffer_store_dwordx4 v[120:123], v25, s[52:55], 0 offen offset:2048
    buffer_store_dwordx4 v[128:131], v25, s[52:55], 0 offen offset:3072
    s_lshl_b32 s47, s41, 7
    s_lshl_b32 s48, s42, 4
    s_add_u32 s47, s47, s48
    s_lshl_b32 s48, s43, 2
    s_add_u32 s47, s47, s48
    s_lshl_b32 s47, s47, 12
    s_lshl_b32 s48, s44, 11
    s_add_u32 s47, s47, s48
    v_lshlrev_b32 v24, 4, v1
    v_add_u32 v24, s47, v24
    v_add_u32 v25, 8192, v24
    s_mov_b32 s50, 4096
    v_cvt_pk_bf16_f32 v136, v136, v137
    v_cvt_pk_bf16_f32 v137, v138, v139
    v_cvt_pk_bf16_f32 v138, v140, v141
    v_cvt_pk_bf16_f32 v139, v142, v143
    buffer_store_dwordx4 v[136:139], v24, s[56:59], 0 offen offset:0
    v_cvt_pk_bf16_f32 v144, v144, v145
    v_cvt_pk_bf16_f32 v145, v146, v147
    v_cvt_pk_bf16_f32 v146, v148, v149
    v_cvt_pk_bf16_f32 v147, v150, v151
    buffer_store_dwordx4 v[144:147], v24, s[56:59], s50 offen offset:0
    v_cvt_pk_bf16_f32 v152, v152, v153
    v_cvt_pk_bf16_f32 v153, v154, v155
    v_cvt_pk_bf16_f32 v154, v156, v157
    v_cvt_pk_bf16_f32 v155, v158, v159
    buffer_store_dwordx4 v[152:155], v24, s[56:59], 0 offen offset:1024
    v_cvt_pk_bf16_f32 v160, v160, v161
    v_cvt_pk_bf16_f32 v161, v162, v163
    v_cvt_pk_bf16_f32 v162, v164, v165
    v_cvt_pk_bf16_f32 v163, v166, v167
    buffer_store_dwordx4 v[160:163], v24, s[56:59], s50 offen offset:1024
    v_cvt_pk_bf16_f32 v168, v168, v169
    v_cvt_pk_bf16_f32 v169, v170, v171
    v_cvt_pk_bf16_f32 v170, v172, v173
    v_cvt_pk_bf16_f32 v171, v174, v175
    buffer_store_dwordx4 v[168:171], v25, s[56:59], 0 offen offset:0
    v_cvt_pk_bf16_f32 v176, v176, v177
    v_cvt_pk_bf16_f32 v177, v178, v179
    v_cvt_pk_bf16_f32 v178, v180, v181
    v_cvt_pk_bf16_f32 v179, v182, v183
    buffer_store_dwordx4 v[176:179], v25, s[56:59], s50 offen offset:0
    v_cvt_pk_bf16_f32 v184, v184, v185
    v_cvt_pk_bf16_f32 v185, v186, v187
    v_cvt_pk_bf16_f32 v186, v188, v189
    v_cvt_pk_bf16_f32 v187, v190, v191
    buffer_store_dwordx4 v[184:187], v25, s[56:59], 0 offen offset:1024
    v_cvt_pk_bf16_f32 v192, v192, v193
    v_cvt_pk_bf16_f32 v193, v194, v195
    v_cvt_pk_bf16_f32 v194, v196, v197
    v_cvt_pk_bf16_f32 v195, v198, v199
    buffer_store_dwordx4 v[192:195], v25, s[56:59], s50 offen offset:1024
L_qkv_end:
    s_endpgm
.section .rodata,"a"
.p2align 6
.amdhsa_kernel qkv_kernel
  .amdhsa_next_free_vgpr 252
  .amdhsa_next_free_sgpr 100
  .amdhsa_accum_offset 252
  .amdhsa_group_segment_fixed_size 0
  .amdhsa_kernarg_size 96
  .amdhsa_user_sgpr_count 2
  .amdhsa_user_sgpr_kernarg_segment_ptr 1
  .amdhsa_system_sgpr_workgroup_id_x 1
.end_amdhsa_kernel
.text

.globl attn_kernel
.p2align 8
.type attn_kernel,@function
attn_kernel:
    s_cmp_ge_u32 s2, 256
    s_cbranch_scc1 L_attn_end
    s_load_dwordx2 s[24:25], s[0:1], 88
    v_and_b32 v1, 63, v0
    v_lshrrev_b32 v26, 6, v0
    s_nop 1
    v_readfirstlane_b32 s40, v26
    s_and_b32 s41, s2, 7
    s_lshl_b32 s41, s41, 2
    s_lshr_b32 s50, s2, 3
    s_and_b32 s50, s50, 3
    s_add_u32 s41, s41, s50
    s_lshr_b32 s42, s2, 5
    s_lshr_b32 s43, s40, 2
    s_and_b32 s44, s40, 3
    s_waitcnt lgkmcnt(0)
    s_add_u32 s4, s24, 0
    s_addc_u32 s5, s25, 0
    s_and_b32 s5, s5, 0xffff
    s_mov_b32 s6, 16777216
    s_mov_b32 s7, 0x00020000
    s_add_u32 s8, s24, 16777216
    s_addc_u32 s9, s25, 0
    s_and_b32 s9, s9, 0xffff
    s_mov_b32 s10, 16777216
    s_mov_b32 s11, 0x00020000
    s_add_u32 s12, s24, 33554432
    s_addc_u32 s13, s25, 0
    s_and_b32 s13, s13, 0xffff
    s_mov_b32 s14, 16777216
    s_mov_b32 s15, 0x00020000
    s_add_u32 s16, s24, 50331648
    s_addc_u32 s17, s25, 0
    s_and_b32 s17, s17, 0xffff
    s_mov_b32 s18, 16777216
    s_mov_b32 s19, 0x00020000
    v_lshlrev_b32 v4, 4, v1
    s_lshl_b32 s50, s43, 16
    v_add_u32 v3, s50, v4
    s_lshl_b32 s50, s44, 12
    v_add_u32 v2, s50, v4
    v_and_b32 v26, 31, v1
    s_lshl_b32 s50, s44, 5
    s_lshl_b32 s51, s43, 6
    s_sub_u32 s50, s50, s51
    v_add_u32 v26, s50, v26
    v_lshrrev_b32 v27, 5, v1
    v_lshlrev_b32 v27, 3, v27
    v_sub_u32 v25, v26, v27
    s_sub_u32 s32, 15, s42
    s_mov_b32 s33, 0
    s_lshl_b32 s56, s41, 6
    s_lshl_b32 s50, s32, 2
    s_add_u32 s56, s56, s50
    s_add_u32 s56, s56, s44
    s_lshl_b32 s57, s32, 2
    s_add_u32 s57, s57, s44
    s_lshl_b32 s56, s56, 13
    s_lshl_b32 s45, s41, 19
    s_lshl_b32 s50, s43, 14
    s_add_u32 s45, s45, s50
    s_mov_b32 s46, s45
    s_lshl_b32 s48, s43, 16
    s_lshl_b32 s50, s44, 12
    s_add_u32 s48, s48, s50
    s_add_u32 s49, s48, 32768
    s_mov_b32 m0, s48
    s_nop 0
    buffer_load_dwordx4 v2, s[8:11], s45 offen offset:0 lds
    buffer_load_dwordx4 v2, s[8:11], s45 offen offset:1024 lds
    buffer_load_dwordx4 v2, s[8:11], s45 offen offset:2048 lds
    buffer_load_dwordx4 v2, s[8:11], s45 offen offset:3072 lds
    s_add_u32 s45, s45, 32768
    s_xor_b32 s48, s48, 0x4000
    buffer_load_dwordx4 v[32:35], v4, s[4:7], s56 offen offset:0
    buffer_load_dwordx4 v[36:39], v4, s[4:7], s56 offen offset:1024
    buffer_load_dwordx4 v[40:43], v4, s[4:7], s56 offen offset:2048
    buffer_load_dwordx4 v[44:47], v4, s[4:7], s56 offen offset:3072
    s_add_u32 s50, s56, 4096
    buffer_load_dwordx4 v[48:51], v4, s[4:7], s50 offen offset:0
    buffer_load_dwordx4 v[52:55], v4, s[4:7], s50 offen offset:1024
    buffer_load_dwordx4 v[56:59], v4, s[4:7], s50 offen offset:2048
    buffer_load_dwordx4 v[60:63], v4, s[4:7], s50 offen offset:3072
    s_mov_b32 m0, s49
    s_nop 0
    buffer_load_dwordx4 v2, s[12:15], s46 offen offset:0 lds
    buffer_load_dwordx4 v2, s[12:15], s46 offen offset:1024 lds
    buffer_load_dwordx4 v2, s[12:15], s46 offen offset:2048 lds
    buffer_load_dwordx4 v2, s[12:15], s46 offen offset:3072 lds
    s_add_u32 s46, s46, 32768
    s_xor_b32 s49, s49, 0x4000
    s_mov_b32 m0, s48
    s_nop 0
    buffer_load_dwordx4 v2, s[8:11], s45 offen offset:0 lds
    buffer_load_dwordx4 v2, s[8:11], s45 offen offset:1024 lds
    buffer_load_dwordx4 v2, s[8:11], s45 offen offset:2048 lds
    buffer_load_dwordx4 v2, s[8:11], s45 offen offset:3072 lds
    s_add_u32 s45, s45, 32768
    s_xor_b32 s48, s48, 0x4000
    s_load_dwordx2 s[64:65], s[0:1], 88
    v_and_b32 v64, 63, v0
    s_and_b32 s99, s40, 1
    s_lshr_b32 s92, s40, 1
    s_lshl_b32 s92, s92, 8
    s_add_u32 s92, s92, s2
    s_mul_i32 s66, s92, 6554
    s_lshr_b32 s66, s66, 16
    s_mul_i32 s93, s66, 10
    s_sub_u32 s67, s92, s93
    s_waitcnt lgkmcnt(0)
    s_add_u32 s68, s64, 67108864
    s_addc_u32 s69, s65, 0
    s_and_b32 s69, s69, 0xffff
    s_mov_b32 s70, 4718592
    s_mov_b32 s71, 0x00020000
    s_add_u32 s80, s64, 88080384
    s_addc_u32 s81, s65, 0
    s_and_b32 s81, s81, 0xffff
    s_mov_b32 s82, 2621440
    s_mov_b32 s83, 0x00020000
    s_add_u32 s88, s64, 75497472
    s_addc_u32 s89, s65, 0
    s_and_b32 s89, s89, 0xffff
    s_mov_b32 s90, 2621440
    s_mov_b32 s91, 0x00020000
    v_lshlrev_b32 v69, 4, v64
    s_cmp_ge_u32 s92, 640
    s_cbranch_scc1 L_b2_notask_attn_kernel_3
    v_and_b32 v66, 31, v64
    v_lshrrev_b32 v67, 5, v64
    v_lshlrev_b32 v180, 4, v64
    s_cmp_ge_u32 s67, 5
    s_cselect_b32 s94, 1, 0
    s_mul_i32 s95, s94, 5
    s_sub_u32 s95, s67, s95
    s_lshl_b32 s92, s95, 5
    v_add_u32 v68, s92, v66
    v_lshlrev_b32 v68, 1, v68
    v_add_u32 v68, s94, v68
    s_lshl_b32 s92, s67, 5
    v_add_u32 v75, s92, v66
    s_mul_i32 s96, s66, 73728
    s_mul_i32 s97, s94, 18432
    s_add_u32 s96, s96, s97
    s_mul_i32 s97, s99, 9216
    s_add_u32 s96, s96, s97
    s_add_u32 s97, s96, 36864
    buffer_load_dwordx4 v[208:211], v180, s[68:71], s96 offen
    buffer_load_dwordx4 v[212:215], v180, s[68:71], s97 offen
    s_add_u32 s96, s96, 1024
    s_add_u32 s97, s97, 1024
    buffer_load_dwordx4 v[216:219], v180, s[68:71], s96 offen
    buffer_load_dwordx4 v[220:223], v180, s[68:71], s97 offen
    s_add_u32 s96, s96, 1024
    s_add_u32 s97, s97, 1024
    buffer_load_dwordx4 v[224:227], v180, s[68:71], s96 offen
    buffer_load_dwordx4 v[228:231], v180, s[68:71], s97 offen
    s_add_u32 s96, s96, 1024
    s_add_u32 s97, s97, 1024
    buffer_load_dwordx4 v[232:235], v180, s[68:71], s96 offen
    buffer_load_dwordx4 v[236:239], v180, s[68:71], s97 offen
    s_add_u32 s96, s96, 1024
    s_add_u32 s97, s97, 1024
    buffer_load_dwordx4 v[240:243], v180, s[68:71], s96 offen
    buffer_load_dwordx4 v[244:247], v180, s[68:71], s97 offen
    s_add_u32 s96, s96, 1024
    s_add_u32 s97, s97, 1024
    buffer_load_dwordx4 v[248:251], v180, s[68:71], s96 offen
    buffer_load_dwordx4 v[252:255], v180, s[68:71], s97 offen
    s_add_u32 s96, s96, 1024
    s_add_u32 s97, s97, 1024
    v_lshlrev_b32 v65, 8, v67
    v_add_u32 v65, s66, v65
    v_mul_u32_u24 v65, 578, v65
    v_lshl_add_u32 v65, v68, 1, v65
    s_mul_i32 s92, s66, 10
    s_add_u32 s92, s92, s67
    s_lshl_b32 s92, s92, 12
    v_lshlrev_b32 v69, 5, v64
    buffer_load_dwordx4 v[192:195], v69, s[80:83], s92 offen offset:0
    buffer_load_dwordx4 v[196:199], v69, s[80:83], s92 offen offset:16
    buffer_load_dwordx4 v[200:203], v69, s[80:83], s92 offen offset:2048
    buffer_load_dwordx4 v[204:207], v69, s[80:83], s92 offen offset:2064
    s_branch L_b2_cont_attn_kernel_4
L_b2_notask_attn_kernel_3:
    s_branch L_b2_bar_attn_kernel_2
L_b2_cont_attn_kernel_4:
    v_lshl_add_u32 v69, v67, 2, 0
    v_mul_u32_u24 v69, v69, v66
    v_and_b32 v69, 31, v69
    v_cvt_f32_u32 v69, v69
    v_mul_f32 v69, 0x3d000000, v69
    v_lshl_add_u32 v70, v67, 2, 1
    v_mul_u32_u24 v70, v70, v66
    v_and_b32 v70, 31, v70
    v_cvt_f32_u32 v70, v70
    v_mul_f32 v70, 0x3d000000, v70
    v_cos_f32 v71, v69
    v_cos_f32 v72, v70
    v_sin_f32 v73, v69
    v_sin_f32 v74, v70
    s_nop 0
    v_cvt_pk_bf16_f32 v80, v71, v72
    v_cvt_pk_bf16_f32 v88, v73, v74
    v_cvt_pk_bf16_f32 v96, -v73, -v74
    v_lshl_add_u32 v69, v67, 2, 2
    v_mul_u32_u24 v69, v69, v66
    v_and_b32 v69, 31, v69
    v_cvt_f32_u32 v69, v69
    v_mul_f32 v69, 0x3d000000, v69
    v_lshl_add_u32 v70, v67, 2, 3
    v_mul_u32_u24 v70, v70, v66
    v_and_b32 v70, 31, v70
    v_cvt_f32_u32 v70, v70
    v_mul_f32 v70, 0x3d000000, v70
    v_cos_f32 v71, v69
    v_cos_f32 v72, v70
    v_sin_f32 v73, v69
    v_sin_f32 v74, v70
    s_nop 0
    v_cvt_pk_bf16_f32 v81, v71, v72
    v_cvt_pk_bf16_f32 v89, v73, v74
    v_cvt_pk_bf16_f32 v97, -v73, -v74
    v_lshl_add_u32 v69, v67, 2, 8
    v_mul_u32_u24 v69, v69, v66
    v_and_b32 v69, 31, v69
    v_cvt_f32_u32 v69, v69
    v_mul_f32 v69, 0x3d000000, v69
    v_lshl_add_u32 v70, v67, 2, 9
    v_mul_u32_u24 v70, v70, v66
    v_and_b32 v70, 31, v70
    v_cvt_f32_u32 v70, v70
    v_mul_f32 v70, 0x3d000000, v70
    v_cos_f32 v71, v69
    v_cos_f32 v72, v70
    v_sin_f32 v73, v69
    v_sin_f32 v74, v70
    s_nop 0
    v_cvt_pk_bf16_f32 v82, v71, v72
    v_cvt_pk_bf16_f32 v90, v73, v74
    v_cvt_pk_bf16_f32 v98, -v73, -v74
    v_lshl_add_u32 v69, v67, 2, 10
    v_mul_u32_u24 v69, v69, v66
    v_and_b32 v69, 31, v69
    v_cvt_f32_u32 v69, v69
    v_mul_f32 v69, 0x3d000000, v69
    v_lshl_add_u32 v70, v67, 2, 11
    v_mul_u32_u24 v70, v70, v66
    v_and_b32 v70, 31, v70
    v_cvt_f32_u32 v70, v70
    v_mul_f32 v70, 0x3d000000, v70
    v_cos_f32 v71, v69
    v_cos_f32 v72, v70
    v_sin_f32 v73, v69
    v_sin_f32 v74, v70
    s_nop 0
    v_cvt_pk_bf16_f32 v83, v71, v72
    v_cvt_pk_bf16_f32 v91, v73, v74
    v_cvt_pk_bf16_f32 v99, -v73, -v74
    v_lshl_add_u32 v69, v67, 2, 16
    v_mul_u32_u24 v69, v69, v66
    v_and_b32 v69, 31, v69
    v_cvt_f32_u32 v69, v69
    v_mul_f32 v69, 0x3d000000, v69
    v_lshl_add_u32 v70, v67, 2, 17
    v_mul_u32_u24 v70, v70, v66
    v_and_b32 v70, 31, v70
    v_cvt_f32_u32 v70, v70
    v_mul_f32 v70, 0x3d000000, v70
    v_cos_f32 v71, v69
    v_cos_f32 v72, v70
    v_sin_f32 v73, v69
    v_sin_f32 v74, v70
    s_nop 0
    v_cvt_pk_bf16_f32 v84, v71, v72
    v_cvt_pk_bf16_f32 v92, v73, v74
    v_cvt_pk_bf16_f32 v100, -v73, -v74
    v_lshl_add_u32 v69, v67, 2, 18
    v_mul_u32_u24 v69, v69, v66
    v_and_b32 v69, 31, v69
    v_cvt_f32_u32 v69, v69
    v_mul_f32 v69, 0x3d000000, v69
    v_lshl_add_u32 v70, v67, 2, 19
    v_mul_u32_u24 v70, v70, v66
    v_and_b32 v70, 31, v70
    v_cvt_f32_u32 v70, v70
    v_mul_f32 v70, 0x3d000000, v70
    v_cos_f32 v71, v69
    v_cos_f32 v72, v70
    v_sin_f32 v73, v69
    v_sin_f32 v74, v70
    s_nop 0
    v_cvt_pk_bf16_f32 v85, v71, v72
    v_cvt_pk_bf16_f32 v93, v73, v74
    v_cvt_pk_bf16_f32 v101, -v73, -v74
    v_lshl_add_u32 v69, v67, 2, 24
    v_mul_u32_u24 v69, v69, v66
    v_and_b32 v69, 31, v69
    v_cvt_f32_u32 v69, v69
    v_mul_f32 v69, 0x3d000000, v69
    v_lshl_add_u32 v70, v67, 2, 25
    v_mul_u32_u24 v70, v70, v66
    v_and_b32 v70, 31, v70
    v_cvt_f32_u32 v70, v70
    v_mul_f32 v70, 0x3d000000, v70
    v_cos_f32 v71, v69
    v_cos_f32 v72, v70
    v_sin_f32 v73, v69
    v_sin_f32 v74, v70
    s_nop 0
    v_cvt_pk_bf16_f32 v86, v71, v72
    v_cvt_pk_bf16_f32 v94, v73, v74
    v_cvt_pk_bf16_f32 v102, -v73, -v74
    v_lshl_add_u32 v69, v67, 2, 26
    v_mul_u32_u24 v69, v69, v66
    v_and_b32 v69, 31, v69
    v_cvt_f32_u32 v69, v69
    v_mul_f32 v69, 0x3d000000, v69
    v_lshl_add_u32 v70, v67, 2, 27
    v_mul_u32_u24 v70, v70, v66
    v_and_b32 v70, 31, v70
    v_cvt_f32_u32 v70, v70
    v_mul_f32 v70, 0x3d000000, v70
    v_cos_f32 v71, v69
    v_cos_f32 v72, v70
    v_sin_f32 v73, v69
    v_sin_f32 v74, v70
    s_nop 0
    v_cvt_pk_bf16_f32 v87, v71, v72
    v_cvt_pk_bf16_f32 v95, v73, v74
    v_cvt_pk_bf16_f32 v103, -v73, -v74
    s_mov_b32 s92, 7456541
    s_mov_b32 s93, 0x3ae38e39
    s_mul_i32 s95, s99, 144
    v_cmp_gt_u32 vcc, 289, v68
    v_mov_b32 v73, 0
    v_mov_b32 v74, 1.0
    v_cndmask_b32 v74, v73, v74, vcc
    v_lshl_add_u32 v69, v67, 3, 0
    v_add_u32 v69, s95, v69
    v_mul_u32_u24 v70, v68, v69
    v_mul_hi_u32 v71, v70, s92
    v_mul_u32_u24 v71, 576, v71
    v_sub_u32 v70, v70, v71
    v_cvt_f32_u32 v70, v70
    v_mul_f32 v70, s93, v70
    v_cos_f32 v136, v70
    v_sin_f32 v144, v70
    s_nop 0
    v_mul_f32 v136, v136, v74
    v_mul_f32 v144, v144, v74
    v_lshl_add_u32 v69, v67, 3, 1
    v_add_u32 v69, s95, v69
    v_mul_u32_u24 v70, v68, v69
    v_mul_hi_u32 v71, v70, s92
    v_mul_u32_u24 v71, 576, v71
    v_sub_u32 v70, v70, v71
    v_cvt_f32_u32 v70, v70
    v_mul_f32 v70, s93, v70
    v_cos_f32 v137, v70
    v_sin_f32 v145, v70
    s_nop 0
    v_mul_f32 v137, v137, v74
    v_mul_f32 v145, v145, v74
    v_lshl_add_u32 v69, v67, 3, 2
    v_add_u32 v69, s95, v69
    v_mul_u32_u24 v70, v68, v69
    v_mul_hi_u32 v71, v70, s92
    v_mul_u32_u24 v71, 576, v71
    v_sub_u32 v70, v70, v71
    v_cvt_f32_u32 v70, v70
    v_mul_f32 v70, s93, v70
    v_cos_f32 v138, v70
    v_sin_f32 v146, v70
    s_nop 0
    v_mul_f32 v138, v138, v74
    v_mul_f32 v146, v146, v74
    v_lshl_add_u32 v69, v67, 3, 3
    v_add_u32 v69, s95, v69
    v_mul_u32_u24 v70, v68, v69
    v_mul_hi_u32 v71, v70, s92
    v_mul_u32_u24 v71, 576, v71
    v_sub_u32 v70, v70, v71
    v_cvt_f32_u32 v70, v70
    v_mul_f32 v70, s93, v70
    v_cos_f32 v139, v70
    v_sin_f32 v147, v70
    s_nop 0
    v_mul_f32 v139, v139, v74
    v_mul_f32 v147, v147, v74
    v_lshl_add_u32 v69, v67, 3, 4
    v_add_u32 v69, s95, v69
    v_mul_u32_u24 v70, v68, v69
    v_mul_hi_u32 v71, v70, s92
    v_mul_u32_u24 v71, 576, v71
    v_sub_u32 v70, v70, v71
    v_cvt_f32_u32 v70, v70
    v_mul_f32 v70, s93, v70
    v_cos_f32 v140, v70
    v_sin_f32 v148, v70
    s_nop 0
    v_mul_f32 v140, v140, v74
    v_mul_f32 v148, v148, v74
    v_lshl_add_u32 v69, v67, 3, 5
    v_add_u32 v69, s95, v69
    v_mul_u32_u24 v70, v68, v69
    v_mul_hi_u32 v71, v70, s92
    v_mul_u32_u24 v71, 576, v71
    v_sub_u32 v70, v70, v71
    v_cvt_f32_u32 v70, v70
    v_mul_f32 v70, s93, v70
    v_cos_f32 v141, v70
    v_sin_f32 v149, v70
    s_nop 0
    v_mul_f32 v141, v141, v74
    v_mul_f32 v149, v149, v74
    v_lshl_add_u32 v69, v67, 3, 6
    v_add_u32 v69, s95, v69
    v_mul_u32_u24 v70, v68, v69
    v_mul_hi_u32 v71, v70, s92
    v_mul_u32_u24 v71, 576, v71
    v_sub_u32 v70, v70, v71
    v_cvt_f32_u32 v70, v70
    v_mul_f32 v70, s93, v70
    v_cos_f32 v142, v70
    v_sin_f32 v150, v70
    s_nop 0
    v_mul_f32 v142, v142, v74
    v_mul_f32 v150, v150, v74
    v_lshl_add_u32 v69, v67, 3, 7
    v_add_u32 v69, s95, v69
    v_mul_u32_u24 v70, v68, v69
    v_mul_hi_u32 v71, v70, s92
    v_mul_u32_u24 v71, 576, v71
    v_sub_u32 v70, v70, v71
    v_cvt_f32_u32 v70, v70
    v_mul_f32 v70, s93, v70
    v_cos_f32 v143, v70
    v_sin_f32 v151, v70
    s_nop 0
    v_mul_f32 v143, v143, v74
    v_mul_f32 v151, v151, v74
    v_mov_b32 v69, 16
    v_mul_u32_u24 v70, v68, v69
    v_mul_hi_u32 v71, v70, s92
    v_mul_u32_u24 v71, 576, v71
    v_sub_u32 v70, v70, v71
    v_cvt_f32_u32 v70, v70
    v_mul_f32 v70, s93, v70
    v_cos_f32 v152, v70
    v_sin_f32 v153, v70
    v_mov_b32 v104, 0
    v_mov_b32 v105, 0
    v_mov_b32 v106, 0
    v_mov_b32 v107, 0
    v_mov_b32 v108, 0
    v_mov_b32 v109, 0
    v_mov_b32 v110, 0
    v_mov_b32 v111, 0
    v_mov_b32 v112, 0
    v_mov_b32 v113, 0
    v_mov_b32 v114, 0
    v_mov_b32 v115, 0
    v_mov_b32 v116, 0
    v_mov_b32 v117, 0
    v_mov_b32 v118, 0
    v_mov_b32 v119, 0
    v_mov_b32 v120, 0
    v_mov_b32 v121, 0
    v_mov_b32 v122, 0
    v_mov_b32 v123, 0
    v_mov_b32 v124, 0
    v_mov_b32 v125, 0
    v_mov_b32 v126, 0
    v_mov_b32 v127, 0
    v_mov_b32 v128, 0
    v_mov_b32 v129, 0
    v_mov_b32 v130, 0
    v_mov_b32 v131, 0
    v_mov_b32 v132, 0
    v_mov_b32 v133, 0
    v_mov_b32 v134, 0
    v_mov_b32 v135, 0
    v_cvt_pk_bf16_f32 v156, v136, v137
    v_cvt_pk_bf16_f32 v160, v144, v145
    v_cvt_pk_bf16_f32 v157, v138, v139
    v_cvt_pk_bf16_f32 v161, v146, v147
    v_cvt_pk_bf16_f32 v158, v140, v141
    v_cvt_pk_bf16_f32 v162, v148, v149
    v_cvt_pk_bf16_f32 v159, v142, v143
    v_cvt_pk_bf16_f32 v163, v150, v151
    s_waitcnt vmcnt(10)
    v_xor_b32 v172, 0x80008000, v208
    v_xor_b32 v173, 0x80008000, v209
    v_xor_b32 v174, 0x80008000, v210
    v_xor_b32 v175, 0x80008000, v211
    s_nop 0
    v_mfma_f32_32x32x16_bf16 v[104:119], v[208:211], v[156:159], v[104:119]
    v_mul_f32 v184, v136, v153
    v_mul_f32 v185, v137, v153
    v_mul_f32 v186, v138, v153
    v_mul_f32 v187, v139, v153
    v_mul_f32 v188, v144, v153
    v_mul_f32 v189, v145, v153
    v_mul_f32 v190, v146, v153
    v_mul_f32 v191, v147, v153
    v_mfma_f32_32x32x16_bf16 v[120:135], v[212:215], v[156:159], v[120:135]
    v_fma_f32 v136, v136, v152, -v188
    v_fma_f32 v137, v137, v152, -v189
    v_fma_f32 v138, v138, v152, -v190
    v_fma_f32 v139, v139, v152, -v191
    v_fma_f32 v144, v144, v152, v184
    v_fma_f32 v145, v145, v152, v185
    v_fma_f32 v146, v146, v152, v186
    v_fma_f32 v147, v147, v152, v187
    v_mfma_f32_32x32x16_bf16 v[104:119], v[212:215], v[160:163], v[104:119]
    v_mul_f32 v184, v140, v153
    v_mul_f32 v185, v141, v153
    v_mul_f32 v186, v142, v153
    v_mul_f32 v187, v143, v153
    v_mul_f32 v188, v148, v153
    v_mul_f32 v189, v149, v153
    v_mul_f32 v190, v150, v153
    v_mul_f32 v191, v151, v153
    v_mfma_f32_32x32x16_bf16 v[120:135], v[172:175], v[160:163], v[120:135]
    v_fma_f32 v140, v140, v152, -v188
    v_fma_f32 v141, v141, v152, -v189
    v_fma_f32 v142, v142, v152, -v190
    v_fma_f32 v143, v143, v152, -v191
    v_fma_f32 v148, v148, v152, v184
    v_fma_f32 v149, v149, v152, v185
    v_fma_f32 v150, v150, v152, v186
    v_fma_f32 v151, v151, v152, v187
    buffer_load_dwordx4 v[208:211], v180, s[68:71], s96 offen
    buffer_load_dwordx4 v[212:215], v180, s[68:71], s97 offen
    s_add_u32 s96, s96, 1024
    s_add_u32 s97, s97, 1024
    v_cvt_pk_bf16_f32 v164, v136, v137
    v_cvt_pk_bf16_f32 v168, v144, v145
    v_cvt_pk_bf16_f32 v165, v138, v139
    v_cvt_pk_bf16_f32 v169, v146, v147
    v_cvt_pk_bf16_f32 v166, v140, v141
    v_cvt_pk_bf16_f32 v170, v148, v149
    v_cvt_pk_bf16_f32 v167, v142, v143
    v_cvt_pk_bf16_f32 v171, v150, v151
    s_waitcnt vmcnt(10)
    v_xor_b32 v176, 0x80008000, v216
    v_xor_b32 v177, 0x80008000, v217
    v_xor_b32 v178, 0x80008000, v218
    v_xor_b32 v179, 0x80008000, v219
    s_nop 0
    v_mfma_f32_32x32x16_bf16 v[104:119], v[216:219], v[164:167], v[104:119]
    v_mul_f32 v184, v136, v153
    v_mul_f32 v185, v137, v153
    v_mul_f32 v186, v138, v153
    v_mul_f32 v187, v139, v153
    v_mul_f32 v188, v144, v153
    v_mul_f32 v189, v145, v153
    v_mul_f32 v190, v146, v153
    v_mul_f32 v191, v147, v153
    v_mfma_f32_32x32x16_bf16 v[120:135], v[220:223], v[164:167], v[120:135]
    v_fma_f32 v136, v136, v152, -v188
    v_fma_f32 v137, v137, v152, -v189
    v_fma_f32 v138, v138, v152, -v190
    v_fma_f32 v139, v139, v152, -v191
    v_fma_f32 v144, v144, v152, v184
    v_fma_f32 v145, v145, v152, v185
    v_fma_f32 v146, v146, v152, v186
    v_fma_f32 v147, v147, v152, v187
    v_mfma_f32_32x32x16_bf16 v[104:119], v[220:223], v[168:171], v[104:119]
    v_mul_f32 v184, v140, v153
    v_mul_f32 v185, v141, v153
    v_mul_f32 v186, v142, v153
    v_mul_f32 v187, v143, v153
    v_mul_f32 v188, v148, v153
    v_mul_f32 v189, v149, v153
    v_mul_f32 v190, v150, v153
    v_mul_f32 v191, v151, v153
    v_mfma_f32_32x32x16_bf16 v[120:135], v[176:179], v[168:171], v[120:135]
    v_fma_f32 v140, v140, v152, -v188
    v_fma_f32 v141, v141, v152, -v189
    v_fma_f32 v142, v142, v152, -v190
    v_fma_f32 v143, v143, v152, -v191
    v_fma_f32 v148, v148, v152, v184
    v_fma_f32 v149, v149, v152, v185
    v_fma_f32 v150, v150, v152, v186
    v_fma_f32 v151, v151, v152, v187
    buffer_load_dwordx4 v[216:219], v180, s[68:71], s96 offen
    buffer_load_dwordx4 v[220:223], v180, s[68:71], s97 offen
    s_add_u32 s96, s96, 1024
    s_add_u32 s97, s97, 1024
    v_cvt_pk_bf16_f32 v156, v136, v137
    v_cvt_pk_bf16_f32 v160, v144, v145
    v_cvt_pk_bf16_f32 v157, v138, v139
    v_cvt_pk_bf16_f32 v161, v146, v147
    v_cvt_pk_bf16_f32 v158, v140, v141
    v_cvt_pk_bf16_f32 v162, v148, v149
    v_cvt_pk_bf16_f32 v159, v142, v143
    v_cvt_pk_bf16_f32 v163, v150, v151
    s_waitcnt vmcnt(10)
    v_xor_b32 v172, 0x80008000, v224
    v_xor_b32 v173, 0x80008000, v225
    v_xor_b32 v174, 0x80008000, v226
    v_xor_b32 v175, 0x80008000, v227
    s_nop 0
    v_mfma_f32_32x32x16_bf16 v[104:119], v[224:227], v[156:159], v[104:119]
    v_mul_f32 v184, v136, v153
    v_mul_f32 v185, v137, v153
    v_mul_f32 v186, v138, v153
    v_mul_f32 v187, v139, v153
    v_mul_f32 v188, v144, v153
    v_mul_f32 v189, v145, v153
    v_mul_f32 v190, v146, v153
    v_mul_f32 v191, v147, v153
    v_mfma_f32_32x32x16_bf16 v[120:135], v[228:231], v[156:159], v[120:135]
    v_fma_f32 v136, v136, v152, -v188
    v_fma_f32 v137, v137, v152, -v189
    v_fma_f32 v138, v138, v152, -v190
    v_fma_f32 v139, v139, v152, -v191
    v_fma_f32 v144, v144, v152, v184
    v_fma_f32 v145, v145, v152, v185
    v_fma_f32 v146, v146, v152, v186
    v_fma_f32 v147, v147, v152, v187
    v_mfma_f32_32x32x16_bf16 v[104:119], v[228:231], v[160:163], v[104:119]
    v_mul_f32 v184, v140, v153
    v_mul_f32 v185, v141, v153
    v_mul_f32 v186, v142, v153
    v_mul_f32 v187, v143, v153
    v_mul_f32 v188, v148, v153
    v_mul_f32 v189, v149, v153
    v_mul_f32 v190, v150, v153
    v_mul_f32 v191, v151, v153
    v_mfma_f32_32x32x16_bf16 v[120:135], v[172:175], v[160:163], v[120:135]
    v_fma_f32 v140, v140, v152, -v188
    v_fma_f32 v141, v141, v152, -v189
    v_fma_f32 v142, v142, v152, -v190
    v_fma_f32 v143, v143, v152, -v191
    v_fma_f32 v148, v148, v152, v184
    v_fma_f32 v149, v149, v152, v185
    v_fma_f32 v150, v150, v152, v186
    v_fma_f32 v151, v151, v152, v187
    buffer_load_dwordx4 v[224:227], v180, s[68:71], s96 offen
    buffer_load_dwordx4 v[228:231], v180, s[68:71], s97 offen
    s_add_u32 s96, s96, 1024
    s_add_u32 s97, s97, 1024
    v_cvt_pk_bf16_f32 v164, v136, v137
    v_cvt_pk_bf16_f32 v168, v144, v145
    v_cvt_pk_bf16_f32 v165, v138, v139
    v_cvt_pk_bf16_f32 v169, v146, v147
    v_cvt_pk_bf16_f32 v166, v140, v141
    v_cvt_pk_bf16_f32 v170, v148, v149
    v_cvt_pk_bf16_f32 v167, v142, v143
    v_cvt_pk_bf16_f32 v171, v150, v151
    s_waitcnt vmcnt(10)
    v_xor_b32 v176, 0x80008000, v232
    v_xor_b32 v177, 0x80008000, v233
    v_xor_b32 v178, 0x80008000, v234
    v_xor_b32 v179, 0x80008000, v235
    s_nop 0
    v_mfma_f32_32x32x16_bf16 v[104:119], v[232:235], v[164:167], v[104:119]
    v_mul_f32 v184, v136, v153
    v_mul_f32 v185, v137, v153
    v_mul_f32 v186, v138, v153
    v_mul_f32 v187, v139, v153
    v_mul_f32 v188, v144, v153
    v_mul_f32 v189, v145, v153
    v_mul_f32 v190, v146, v153
    v_mul_f32 v191, v147, v153
    v_mfma_f32_32x32x16_bf16 v[120:135], v[236:239], v[164:167], v[120:135]
    v_fma_f32 v136, v136, v152, -v188
    v_fma_f32 v137, v137, v152, -v189
    v_fma_f32 v138, v138, v152, -v190
    v_fma_f32 v139, v139, v152, -v191
    v_fma_f32 v144, v144, v152, v184
    v_fma_f32 v145, v145, v152, v185
    v_fma_f32 v146, v146, v152, v186
    v_fma_f32 v147, v147, v152, v187
    v_mfma_f32_32x32x16_bf16 v[104:119], v[236:239], v[168:171], v[104:119]
    v_mul_f32 v184, v140, v153
    v_mul_f32 v185, v141, v153
    v_mul_f32 v186, v142, v153
    v_mul_f32 v187, v143, v153
    v_mul_f32 v188, v148, v153
    v_mul_f32 v189, v149, v153
    v_mul_f32 v190, v150, v153
    v_mul_f32 v191, v151, v153
    v_mfma_f32_32x32x16_bf16 v[120:135], v[176:179], v[168:171], v[120:135]
    v_fma_f32 v140, v140, v152, -v188
    v_fma_f32 v141, v141, v152, -v189
    v_fma_f32 v142, v142, v152, -v190
    v_fma_f32 v143, v143, v152, -v191
    v_fma_f32 v148, v148, v152, v184
    v_fma_f32 v149, v149, v152, v185
    v_fma_f32 v150, v150, v152, v186
    v_fma_f32 v151, v151, v152, v187
    v_cvt_pk_bf16_f32 v156, v136, v137
    v_cvt_pk_bf16_f32 v160, v144, v145
    v_cvt_pk_bf16_f32 v157, v138, v139
    v_cvt_pk_bf16_f32 v161, v146, v147
    v_cvt_pk_bf16_f32 v158, v140, v141
    v_cvt_pk_bf16_f32 v162, v148, v149
    v_cvt_pk_bf16_f32 v159, v142, v143
    v_cvt_pk_bf16_f32 v163, v150, v151
    s_waitcnt vmcnt(8)
    v_xor_b32 v172, 0x80008000, v240
    v_xor_b32 v173, 0x80008000, v241
    v_xor_b32 v174, 0x80008000, v242
    v_xor_b32 v175, 0x80008000, v243
    s_nop 0
    v_mfma_f32_32x32x16_bf16 v[104:119], v[240:243], v[156:159], v[104:119]
    v_mul_f32 v184, v136, v153
    v_mul_f32 v185, v137, v153
    v_mul_f32 v186, v138, v153
    v_mul_f32 v187, v139, v153
    v_mul_f32 v188, v144, v153
    v_mul_f32 v189, v145, v153
    v_mul_f32 v190, v146, v153
    v_mul_f32 v191, v147, v153
    v_mfma_f32_32x32x16_bf16 v[120:135], v[244:247], v[156:159], v[120:135]
    v_fma_f32 v136, v136, v152, -v188
    v_fma_f32 v137, v137, v152, -v189
    v_fma_f32 v138, v138, v152, -v190
    v_fma_f32 v139, v139, v152, -v191
    v_fma_f32 v144, v144, v152, v184
    v_fma_f32 v145, v145, v152, v185
    v_fma_f32 v146, v146, v152, v186
    v_fma_f32 v147, v147, v152, v187
    v_mfma_f32_32x32x16_bf16 v[104:119], v[244:247], v[160:163], v[104:119]
    v_mul_f32 v184, v140, v153
    v_mul_f32 v185, v141, v153
    v_mul_f32 v186, v142, v153
    v_mul_f32 v187, v143, v153
    v_mul_f32 v188, v148, v153
    v_mul_f32 v189, v149, v153
    v_mul_f32 v190, v150, v153
    v_mul_f32 v191, v151, v153
    v_mfma_f32_32x32x16_bf16 v[120:135], v[172:175], v[160:163], v[120:135]
    v_fma_f32 v140, v140, v152, -v188
    v_fma_f32 v141, v141, v152, -v189
    v_fma_f32 v142, v142, v152, -v190
    v_fma_f32 v143, v143, v152, -v191
    v_fma_f32 v148, v148, v152, v184
    v_fma_f32 v149, v149, v152, v185
    v_fma_f32 v150, v150, v152, v186
    v_fma_f32 v151, v151, v152, v187
    v_cvt_pk_bf16_f32 v164, v136, v137
    v_cvt_pk_bf16_f32 v168, v144, v145
    v_cvt_pk_bf16_f32 v165, v138, v139
    v_cvt_pk_bf16_f32 v169, v146, v147
    v_cvt_pk_bf16_f32 v166, v140, v141
    v_cvt_pk_bf16_f32 v170, v148, v149
    v_cvt_pk_bf16_f32 v167, v142, v143
    v_cvt_pk_bf16_f32 v171, v150, v151
    s_waitcnt vmcnt(6)
    v_xor_b32 v176, 0x80008000, v248
    v_xor_b32 v177, 0x80008000, v249
    v_xor_b32 v178, 0x80008000, v250
    v_xor_b32 v179, 0x80008000, v251
    s_nop 0
    v_mfma_f32_32x32x16_bf16 v[104:119], v[248:251], v[164:167], v[104:119]
    v_mul_f32 v184, v136, v153
    v_mul_f32 v185, v137, v153
    v_mul_f32 v186, v138, v153
    v_mul_f32 v187, v139, v153
    v_mul_f32 v188, v144, v153
    v_mul_f32 v189, v145, v153
    v_mul_f32 v190, v146, v153
    v_mul_f32 v191, v147, v153
    v_mfma_f32_32x32x16_bf16 v[120:135], v[252:255], v[164:167], v[120:135]
    v_fma_f32 v136, v136, v152, -v188
    v_fma_f32 v137, v137, v152, -v189
    v_fma_f32 v138, v138, v152, -v190
    v_fma_f32 v139, v139, v152, -v191
    v_fma_f32 v144, v144, v152, v184
    v_fma_f32 v145, v145, v152, v185
    v_fma_f32 v146, v146, v152, v186
    v_fma_f32 v147, v147, v152, v187
    v_mfma_f32_32x32x16_bf16 v[104:119], v[252:255], v[168:171], v[104:119]
    v_mul_f32 v184, v140, v153
    v_mul_f32 v185, v141, v153
    v_mul_f32 v186, v142, v153
    v_mul_f32 v187, v143, v153
    v_mul_f32 v188, v148, v153
    v_mul_f32 v189, v149, v153
    v_mul_f32 v190, v150, v153
    v_mul_f32 v191, v151, v153
    v_mfma_f32_32x32x16_bf16 v[120:135], v[176:179], v[168:171], v[120:135]
    v_fma_f32 v140, v140, v152, -v188
    v_fma_f32 v141, v141, v152, -v189
    v_fma_f32 v142, v142, v152, -v190
    v_fma_f32 v143, v143, v152, -v191
    v_fma_f32 v148, v148, v152, v184
    v_fma_f32 v149, v149, v152, v185
    v_fma_f32 v150, v150, v152, v186
    v_fma_f32 v151, v151, v152, v187
    v_cvt_pk_bf16_f32 v156, v136, v137
    v_cvt_pk_bf16_f32 v160, v144, v145
    v_cvt_pk_bf16_f32 v157, v138, v139
    v_cvt_pk_bf16_f32 v161, v146, v147
    v_cvt_pk_bf16_f32 v158, v140, v141
    v_cvt_pk_bf16_f32 v162, v148, v149
    v_cvt_pk_bf16_f32 v159, v142, v143
    v_cvt_pk_bf16_f32 v163, v150, v151
    s_waitcnt vmcnt(4)
    v_xor_b32 v172, 0x80008000, v208
    v_xor_b32 v173, 0x80008000, v209
    v_xor_b32 v174, 0x80008000, v210
    v_xor_b32 v175, 0x80008000, v211
    s_nop 0
    v_mfma_f32_32x32x16_bf16 v[104:119], v[208:211], v[156:159], v[104:119]
    v_mul_f32 v184, v136, v153
    v_mul_f32 v185, v137, v153
    v_mul_f32 v186, v138, v153
    v_mul_f32 v187, v139, v153
    v_mul_f32 v188, v144, v153
    v_mul_f32 v189, v145, v153
    v_mul_f32 v190, v146, v153
    v_mul_f32 v191, v147, v153
    v_mfma_f32_32x32x16_bf16 v[120:135], v[212:215], v[156:159], v[120:135]
    v_fma_f32 v136, v136, v152, -v188
    v_fma_f32 v137, v137, v152, -v189
    v_fma_f32 v138, v138, v152, -v190
    v_fma_f32 v139, v139, v152, -v191
    v_fma_f32 v144, v144, v152, v184
    v_fma_f32 v145, v145, v152, v185
    v_fma_f32 v146, v146, v152, v186
    v_fma_f32 v147, v147, v152, v187
    v_mfma_f32_32x32x16_bf16 v[104:119], v[212:215], v[160:163], v[104:119]
    v_mul_f32 v184, v140, v153
    v_mul_f32 v185, v141, v153
    v_mul_f32 v186, v142, v153
    v_mul_f32 v187, v143, v153
    v_mul_f32 v188, v148, v153
    v_mul_f32 v189, v149, v153
    v_mul_f32 v190, v150, v153
    v_mul_f32 v191, v151, v153
    v_mfma_f32_32x32x16_bf16 v[120:135], v[172:175], v[160:163], v[120:135]
    v_fma_f32 v140, v140, v152, -v188
    v_fma_f32 v141, v141, v152, -v189
    v_fma_f32 v142, v142, v152, -v190
    v_fma_f32 v143, v143, v152, -v191
    v_fma_f32 v148, v148, v152, v184
    v_fma_f32 v149, v149, v152, v185
    v_fma_f32 v150, v150, v152, v186
    v_fma_f32 v151, v151, v152, v187
    v_cvt_pk_bf16_f32 v164, v136, v137
    v_cvt_pk_bf16_f32 v168, v144, v145
    v_cvt_pk_bf16_f32 v165, v138, v139
    v_cvt_pk_bf16_f32 v169, v146, v147
    v_cvt_pk_bf16_f32 v166, v140, v141
    v_cvt_pk_bf16_f32 v170, v148, v149
    v_cvt_pk_bf16_f32 v167, v142, v143
    v_cvt_pk_bf16_f32 v171, v150, v151
    s_waitcnt vmcnt(2)
    v_xor_b32 v176, 0x80008000, v216
    v_xor_b32 v177, 0x80008000, v217
    v_xor_b32 v178, 0x80008000, v218
    v_xor_b32 v179, 0x80008000, v219
    s_nop 0
    v_mfma_f32_32x32x16_bf16 v[104:119], v[216:219], v[164:167], v[104:119]
    v_mul_f32 v184, v136, v153
    v_mul_f32 v185, v137, v153
    v_mul_f32 v186, v138, v153
    v_mul_f32 v187, v139, v153
    v_mul_f32 v188, v144, v153
    v_mul_f32 v189, v145, v153
    v_mul_f32 v190, v146, v153
    v_mul_f32 v191, v147, v153
    v_mfma_f32_32x32x16_bf16 v[120:135], v[220:223], v[164:167], v[120:135]
    v_fma_f32 v136, v136, v152, -v188
    v_fma_f32 v137, v137, v152, -v189
    v_fma_f32 v138, v138, v152, -v190
    v_fma_f32 v139, v139, v152, -v191
    v_fma_f32 v144, v144, v152, v184
    v_fma_f32 v145, v145, v152, v185
    v_fma_f32 v146, v146, v152, v186
    v_fma_f32 v147, v147, v152, v187
    v_mfma_f32_32x32x16_bf16 v[104:119], v[220:223], v[168:171], v[104:119]
    v_mul_f32 v184, v140, v153
    v_mul_f32 v185, v141, v153
    v_mul_f32 v186, v142, v153
    v_mul_f32 v187, v143, v153
    v_mul_f32 v188, v148, v153
    v_mul_f32 v189, v149, v153
    v_mul_f32 v190, v150, v153
    v_mul_f32 v191, v151, v153
    v_mfma_f32_32x32x16_bf16 v[120:135], v[176:179], v[168:171], v[120:135]
    v_fma_f32 v140, v140, v152, -v188
    v_fma_f32 v141, v141, v152, -v189
    v_fma_f32 v142, v142, v152, -v190
    v_fma_f32 v143, v143, v152, -v191
    v_fma_f32 v148, v148, v152, v184
    v_fma_f32 v149, v149, v152, v185
    v_fma_f32 v150, v150, v152, v186
    v_fma_f32 v151, v151, v152, v187
    v_cvt_pk_bf16_f32 v156, v136, v137
    v_cvt_pk_bf16_f32 v160, v144, v145
    v_cvt_pk_bf16_f32 v157, v138, v139
    v_cvt_pk_bf16_f32 v161, v146, v147
    v_cvt_pk_bf16_f32 v158, v140, v141
    v_cvt_pk_bf16_f32 v162, v148, v149
    v_cvt_pk_bf16_f32 v159, v142, v143
    v_cvt_pk_bf16_f32 v163, v150, v151
    s_waitcnt vmcnt(0)
    v_xor_b32 v172, 0x80008000, v224
    v_xor_b32 v173, 0x80008000, v225
    v_xor_b32 v174, 0x80008000, v226
    v_xor_b32 v175, 0x80008000, v227
    s_nop 0
    v_mfma_f32_32x32x16_bf16 v[104:119], v[224:227], v[156:159], v[104:119]
    v_mul_f32 v184, v136, v153
    v_mul_f32 v185, v137, v153
    v_mul_f32 v186, v138, v153
    v_mul_f32 v187, v139, v153
    v_mul_f32 v188, v144, v153
    v_mul_f32 v189, v145, v153
    v_mul_f32 v190, v146, v153
    v_mul_f32 v191, v147, v153
    v_mfma_f32_32x32x16_bf16 v[120:135], v[228:231], v[156:159], v[120:135]
    v_fma_f32 v136, v136, v152, -v188
    v_fma_f32 v137, v137, v152, -v189
    v_fma_f32 v138, v138, v152, -v190
    v_fma_f32 v139, v139, v152, -v191
    v_fma_f32 v144, v144, v152, v184
    v_fma_f32 v145, v145, v152, v185
    v_fma_f32 v146, v146, v152, v186
    v_fma_f32 v147, v147, v152, v187
    v_mfma_f32_32x32x16_bf16 v[104:119], v[228:231], v[160:163], v[104:119]
    v_mul_f32 v184, v140, v153
    v_mul_f32 v185, v141, v153
    v_mul_f32 v186, v142, v153
    v_mul_f32 v187, v143, v153
    v_mul_f32 v188, v148, v153
    v_mul_f32 v189, v149, v153
    v_mul_f32 v190, v150, v153
    v_mul_f32 v191, v151, v153
    v_mfma_f32_32x32x16_bf16 v[120:135], v[172:175], v[160:163], v[120:135]
    v_fma_f32 v140, v140, v152, -v188
    v_fma_f32 v141, v141, v152, -v189
    v_fma_f32 v142, v142, v152, -v190
    v_fma_f32 v143, v143, v152, -v191
    v_fma_f32 v148, v148, v152, v184
    v_fma_f32 v149, v149, v152, v185
    v_fma_f32 v150, v150, v152, v186
    v_fma_f32 v151, v151, v152, v187
    v_cvt_pk_bf16_f32 v164, v136, v137
    v_cvt_pk_bf16_f32 v168, v144, v145
    v_cvt_pk_bf16_f32 v165, v138, v139
    v_cvt_pk_bf16_f32 v169, v146, v147
    v_cvt_pk_bf16_f32 v166, v140, v141
    v_cvt_pk_bf16_f32 v170, v148, v149
    v_cvt_pk_bf16_f32 v167, v142, v143
    v_cvt_pk_bf16_f32 v171, v150, v151
    s_nop 15
    s_lshr_b32 s92, s40, 1
    s_lshl_b32 s92, s92, 13
    s_add_u32 s92, s92, 131072
    v_lshlrev_b32 v69, 4, v64
    v_add_u32 v69, s92, v69
    s_cmp_eq_u32 s99, 0
    s_cbranch_scc1 L_b2_bar_attn_kernel_2
    ds_write_b128 v69, v[104:107] offset:0
    ds_write_b128 v69, v[108:111] offset:1024
    ds_write_b128 v69, v[112:115] offset:2048
    ds_write_b128 v69, v[116:119] offset:3072
    ds_write_b128 v69, v[120:123] offset:4096
    ds_write_b128 v69, v[124:127] offset:5120
    ds_write_b128 v69, v[128:131] offset:6144
    ds_write_b128 v69, v[132:135] offset:7168
    s_waitcnt lgkmcnt(0)
L_b2_bar_attn_kernel_2:
    s_barrier
    s_lshr_b32 s92, s40, 1
    s_lshl_b32 s92, s92, 8
    s_add_u32 s92, s92, s2
    s_cmp_ge_u32 s92, 640
    s_cbranch_scc1 L_b2_end_attn_kernel_1
    s_cmp_lg_u32 s99, 0
    s_cbranch_scc1 L_b2_end_attn_kernel_1
    ds_read_b128 v[208:211], v69 offset:0
    ds_read_b128 v[212:215], v69 offset:1024
    ds_read_b128 v[216:219], v69 offset:2048
    ds_read_b128 v[220:223], v69 offset:3072
    ds_read_b128 v[224:227], v69 offset:4096
    ds_read_b128 v[228:231], v69 offset:5120
    ds_read_b128 v[232:235], v69 offset:6144
    ds_read_b128 v[236:239], v69 offset:7168
    s_waitcnt lgkmcnt(0)
    v_add_f32 v104, v104, v208
    v_add_f32 v105, v105, v209
    v_add_f32 v106, v106, v210
    v_add_f32 v107, v107, v211
    v_add_f32 v108, v108, v212
    v_add_f32 v109, v109, v213
    v_add_f32 v110, v110, v214
    v_add_f32 v111, v111, v215
    v_add_f32 v112, v112, v216
    v_add_f32 v113, v113, v217
    v_add_f32 v114, v114, v218
    v_add_f32 v115, v115, v219
    v_add_f32 v116, v116, v220
    v_add_f32 v117, v117, v221
    v_add_f32 v118, v118, v222
    v_add_f32 v119, v119, v223
    v_add_f32 v120, v120, v224
    v_add_f32 v121, v121, v225
    v_add_f32 v122, v122, v226
    v_add_f32 v123, v123, v227
    v_add_f32 v124, v124, v228
    v_add_f32 v125, v125, v229
    v_add_f32 v126, v126, v230
    v_add_f32 v127, v127, v231
    v_add_f32 v128, v128, v232
    v_add_f32 v129, v129, v233
    v_add_f32 v130, v130, v234
    v_add_f32 v131, v131, v235
    v_add_f32 v132, v132, v236
    v_add_f32 v133, v133, v237
    v_add_f32 v134, v134, v238
    v_add_f32 v135, v135, v239
    s_nop 15
    v_cvt_pk_bf16_f32 v104, v104, v105
    v_cvt_pk_bf16_f32 v105, v106, v107
    v_cvt_pk_bf16_f32 v106, v108, v109
    v_cvt_pk_bf16_f32 v107, v110, v111
    v_cvt_pk_bf16_f32 v112, v112, v113
    v_cvt_pk_bf16_f32 v113, v114, v115
    v_cvt_pk_bf16_f32 v114, v116, v117
    v_cvt_pk_bf16_f32 v115, v118, v119
    v_cvt_pk_bf16_f32 v120, v120, v121
    v_cvt_pk_bf16_f32 v121, v122, v123
    v_cvt_pk_bf16_f32 v122, v124, v125
    v_cvt_pk_bf16_f32 v123, v126, v127
    v_cvt_pk_bf16_f32 v128, v128, v129
    v_cvt_pk_bf16_f32 v129, v130, v131
    v_cvt_pk_bf16_f32 v130, v132, v133
    v_cvt_pk_bf16_f32 v131, v134, v135
    s_nop 1
    v_mfma_f32_32x32x16_bf16 v[208:223], v[80:83], v[104:107], 0
    v_mfma_f32_32x32x16_bf16 v[224:239], v[96:99], v[104:107], 0
    v_mfma_f32_32x32x16_bf16 v[208:223], v[84:87], v[112:115], v[208:223]
    v_mfma_f32_32x32x16_bf16 v[224:239], v[100:103], v[112:115], v[224:239]
    v_mfma_f32_32x32x16_bf16 v[208:223], v[88:91], v[120:123], v[208:223]
    v_mfma_f32_32x32x16_bf16 v[224:239], v[80:83], v[120:123], v[224:239]
    v_mfma_f32_32x32x16_bf16 v[208:223], v[92:95], v[128:131], v[208:223]
    v_mfma_f32_32x32x16_bf16 v[224:239], v[84:87], v[128:131], v[224:239]
    s_waitcnt vmcnt(0)
    s_nop 15
    v_lshlrev_b32 v71, 16, v192
    v_lshlrev_b32 v72, 16, v200
    v_mul_f32 v69, v224, v72
    v_mul_f32 v70, v224, v71
    v_fma_f32 v224, v208, v72, v70
    v_fma_f32 v208, v208, v71, -v69
    v_and_b32 v71, 0xffff0000, v192
    v_and_b32 v72, 0xffff0000, v200
    v_mul_f32 v69, v225, v72
    v_mul_f32 v70, v225, v71
    v_fma_f32 v225, v209, v72, v70
    v_fma_f32 v209, v209, v71, -v69
    v_lshlrev_b32 v71, 16, v193
    v_lshlrev_b32 v72, 16, v201
    v_mul_f32 v69, v226, v72
    v_mul_f32 v70, v226, v71
    v_fma_f32 v226, v210, v72, v70
    v_fma_f32 v210, v210, v71, -v69
    v_and_b32 v71, 0xffff0000, v193
    v_and_b32 v72, 0xffff0000, v201
    v_mul_f32 v69, v227, v72
    v_mul_f32 v70, v227, v71
    v_fma_f32 v227, v211, v72, v70
    v_fma_f32 v211, v211, v71, -v69
    v_lshlrev_b32 v71, 16, v194
    v_lshlrev_b32 v72, 16, v202
    v_mul_f32 v69, v228, v72
    v_mul_f32 v70, v228, v71
    v_fma_f32 v228, v212, v72, v70
    v_fma_f32 v212, v212, v71, -v69
    v_and_b32 v71, 0xffff0000, v194
    v_and_b32 v72, 0xffff0000, v202
    v_mul_f32 v69, v229, v72
    v_mul_f32 v70, v229, v71
    v_fma_f32 v229, v213, v72, v70
    v_fma_f32 v213, v213, v71, -v69
    v_lshlrev_b32 v71, 16, v195
    v_lshlrev_b32 v72, 16, v203
    v_mul_f32 v69, v230, v72
    v_mul_f32 v70, v230, v71
    v_fma_f32 v230, v214, v72, v70
    v_fma_f32 v214, v214, v71, -v69
    v_and_b32 v71, 0xffff0000, v195
    v_and_b32 v72, 0xffff0000, v203
    v_mul_f32 v69, v231, v72
    v_mul_f32 v70, v231, v71
    v_fma_f32 v231, v215, v72, v70
    v_fma_f32 v215, v215, v71, -v69
    v_lshlrev_b32 v71, 16, v196
    v_lshlrev_b32 v72, 16, v204
    v_mul_f32 v69, v232, v72
    v_mul_f32 v70, v232, v71
    v_fma_f32 v232, v216, v72, v70
    v_fma_f32 v216, v216, v71, -v69
    v_and_b32 v71, 0xffff0000, v196
    v_and_b32 v72, 0xffff0000, v204
    v_mul_f32 v69, v233, v72
    v_mul_f32 v70, v233, v71
    v_fma_f32 v233, v217, v72, v70
    v_fma_f32 v217, v217, v71, -v69
    v_lshlrev_b32 v71, 16, v197
    v_lshlrev_b32 v72, 16, v205
    v_mul_f32 v69, v234, v72
    v_mul_f32 v70, v234, v71
    v_fma_f32 v234, v218, v72, v70
    v_fma_f32 v218, v218, v71, -v69
    v_and_b32 v71, 0xffff0000, v197
    v_and_b32 v72, 0xffff0000, v205
    v_mul_f32 v69, v235, v72
    v_mul_f32 v70, v235, v71
    v_fma_f32 v235, v219, v72, v70
    v_fma_f32 v219, v219, v71, -v69
    v_lshlrev_b32 v71, 16, v198
    v_lshlrev_b32 v72, 16, v206
    v_mul_f32 v69, v236, v72
    v_mul_f32 v70, v236, v71
    v_fma_f32 v236, v220, v72, v70
    v_fma_f32 v220, v220, v71, -v69
    v_and_b32 v71, 0xffff0000, v198
    v_and_b32 v72, 0xffff0000, v206
    v_mul_f32 v69, v237, v72
    v_mul_f32 v70, v237, v71
    v_fma_f32 v237, v221, v72, v70
    v_fma_f32 v221, v221, v71, -v69
    v_lshlrev_b32 v71, 16, v199
    v_lshlrev_b32 v72, 16, v207
    v_mul_f32 v69, v238, v72
    v_mul_f32 v70, v238, v71
    v_fma_f32 v238, v222, v72, v70
    v_fma_f32 v222, v222, v71, -v69
    v_and_b32 v71, 0xffff0000, v199
    v_and_b32 v72, 0xffff0000, v207
    v_mul_f32 v69, v239, v72
    v_mul_f32 v70, v239, v71
    v_fma_f32 v239, v223, v72, v70
    v_fma_f32 v223, v223, v71, -v69
    v_cvt_pk_bf16_f32 v208, v208, v209
    v_cvt_pk_bf16_f32 v209, v210, v211
    v_cvt_pk_bf16_f32 v210, v212, v213
    v_cvt_pk_bf16_f32 v211, v214, v215
    v_cvt_pk_bf16_f32 v216, v216, v217
    v_cvt_pk_bf16_f32 v217, v218, v219
    v_cvt_pk_bf16_f32 v218, v220, v221
    v_cvt_pk_bf16_f32 v219, v222, v223
    v_cvt_pk_bf16_f32 v224, v224, v225
    v_cvt_pk_bf16_f32 v225, v226, v227
    v_cvt_pk_bf16_f32 v226, v228, v229
    v_cvt_pk_bf16_f32 v227, v230, v231
    v_cvt_pk_bf16_f32 v232, v232, v233
    v_cvt_pk_bf16_f32 v233, v234, v235
    v_cvt_pk_bf16_f32 v234, v236, v237
    v_cvt_pk_bf16_f32 v235, v238, v239
    s_nop 1
    v_mfma_f32_32x32x16_bf16 v[104:119], v[80:83], v[208:211], 0
    v_mfma_f32_32x32x16_bf16 v[120:135], v[88:91], v[208:211], 0
    v_mfma_f32_32x32x16_bf16 v[104:119], v[84:87], v[216:219], v[104:119]
    v_mfma_f32_32x32x16_bf16 v[120:135], v[92:95], v[216:219], v[120:135]
    v_mfma_f32_32x32x16_bf16 v[104:119], v[96:99], v[224:227], v[104:119]
    v_mfma_f32_32x32x16_bf16 v[120:135], v[80:83], v[224:227], v[120:135]
    v_mfma_f32_32x32x16_bf16 v[104:119], v[100:103], v[232:235], v[104:119]
    v_mfma_f32_32x32x16_bf16 v[120:135], v[84:87], v[232:235], v[120:135]
    s_nop 15
    s_nop 3
    s_lshl_b32 s92, s66, 5
    v_lshlrev_b32 v65, 2, v67
    v_add_u32 v65, s92, v65
    v_mul_u32_u24 v65, 1280, v65
    v_lshl_add_u32 v65, v75, 1, v65
    v_cvt_pk_bf16_f32 v104, v104, v120
    v_lshrrev_b32 v120, 16, v104
    s_mov_b32 s92, 0
    buffer_store_short v104, v65, s[88:91], s92 offen
    buffer_store_short v120, v65, s[88:91], s92 offen offset:640
    v_cvt_pk_bf16_f32 v105, v105, v121
    v_lshrrev_b32 v121, 16, v105
    s_mov_b32 s92, 1280
    buffer_store_short v105, v65, s[88:91], s92 offen
    buffer_store_short v121, v65, s[88:91], s92 offen offset:640
    v_cvt_pk_bf16_f32 v106, v106, v122
    v_lshrrev_b32 v122, 16, v106
    s_mov_b32 s92, 2560
    buffer_store_short v106, v65, s[88:91], s92 offen
    buffer_store_short v122, v65, s[88:91], s92 offen offset:640
    v_cvt_pk_bf16_f32 v107, v107, v123
    v_lshrrev_b32 v123, 16, v107
    s_mov_b32 s92, 3840
    buffer_store_short v107, v65, s[88:91], s92 offen
    buffer_store_short v123, v65, s[88:91], s92 offen offset:640
    v_cvt_pk_bf16_f32 v108, v108, v124
    v_lshrrev_b32 v124, 16, v108
    s_mov_b32 s92, 10240
    buffer_store_short v108, v65, s[88:91], s92 offen
    buffer_store_short v124, v65, s[88:91], s92 offen offset:640
    v_cvt_pk_bf16_f32 v109, v109, v125
    v_lshrrev_b32 v125, 16, v109
    s_mov_b32 s92, 11520
    buffer_store_short v109, v65, s[88:91], s92 offen
    buffer_store_short v125, v65, s[88:91], s92 offen offset:640
    v_cvt_pk_bf16_f32 v110, v110, v126
    v_lshrrev_b32 v126, 16, v110
    s_mov_b32 s92, 12800
    buffer_store_short v110, v65, s[88:91], s92 offen
    buffer_store_short v126, v65, s[88:91], s92 offen offset:640
    v_cvt_pk_bf16_f32 v111, v111, v127
    v_lshrrev_b32 v127, 16, v111
    s_mov_b32 s92, 14080
    buffer_store_short v111, v65, s[88:91], s92 offen
    buffer_store_short v127, v65, s[88:91], s92 offen offset:640
    v_cvt_pk_bf16_f32 v112, v112, v128
    v_lshrrev_b32 v128, 16, v112
    s_mov_b32 s92, 20480
    buffer_store_short v112, v65, s[88:91], s92 offen
    buffer_store_short v128, v65, s[88:91], s92 offen offset:640
    v_cvt_pk_bf16_f32 v113, v113, v129
    v_lshrrev_b32 v129, 16, v113
    s_mov_b32 s92, 21760
    buffer_store_short v113, v65, s[88:91], s92 offen
    buffer_store_short v129, v65, s[88:91], s92 offen offset:640
    v_cvt_pk_bf16_f32 v114, v114, v130
    v_lshrrev_b32 v130, 16, v114
    s_mov_b32 s92, 23040
    buffer_store_short v114, v65, s[88:91], s92 offen
    buffer_store_short v130, v65, s[88:91], s92 offen offset:640
    v_cvt_pk_bf16_f32 v115, v115, v131
    v_lshrrev_b32 v131, 16, v115
    s_mov_b32 s92, 24320
    buffer_store_short v115, v65, s[88:91], s92 offen
    buffer_store_short v131, v65, s[88:91], s92 offen offset:640
    v_cvt_pk_bf16_f32 v116, v116, v132
    v_lshrrev_b32 v132, 16, v116
    s_mov_b32 s92, 30720
    buffer_store_short v116, v65, s[88:91], s92 offen
    buffer_store_short v132, v65, s[88:91], s92 offen offset:640
    v_cvt_pk_bf16_f32 v117, v117, v133
    v_lshrrev_b32 v133, 16, v117
    s_mov_b32 s92, 32000
    buffer_store_short v117, v65, s[88:91], s92 offen
    buffer_store_short v133, v65, s[88:91], s92 offen offset:640
    v_cvt_pk_bf16_f32 v118, v118, v134
    v_lshrrev_b32 v134, 16, v118
    s_mov_b32 s92, 33280
    buffer_store_short v118, v65, s[88:91], s92 offen
    buffer_store_short v134, v65, s[88:91], s92 offen offset:640
    v_cvt_pk_bf16_f32 v119, v119, v135
    v_lshrrev_b32 v135, 16, v119
    s_mov_b32 s92, 34560
    buffer_store_short v119, v65, s[88:91], s92 offen
    buffer_store_short v135, v65, s[88:91], s92 offen offset:640
L_b2_end_attn_kernel_1:
L_attn_qblock:
    s_mov_b32 s58, s57
    s_add_u32 s47, s32, 1
    v_mov_b32 v128, 0
    v_mov_b32 v129, 0
    v_mov_b32 v130, 0
    v_mov_b32 v131, 0
    v_mov_b32 v132, 0
    v_mov_b32 v133, 0
    v_mov_b32 v134, 0
    v_mov_b32 v135, 0
    v_mov_b32 v136, 0
    v_mov_b32 v137, 0
    v_mov_b32 v138, 0
    v_mov_b32 v139, 0
    v_mov_b32 v140, 0
    v_mov_b32 v141, 0
    v_mov_b32 v142, 0
    v_mov_b32 v143, 0
    v_mov_b32 v144, 0
    v_mov_b32 v145, 0
    v_mov_b32 v146, 0
    v_mov_b32 v147, 0
    v_mov_b32 v148, 0
    v_mov_b32 v149, 0
    v_mov_b32 v150, 0
    v_mov_b32 v151, 0
    v_mov_b32 v152, 0
    v_mov_b32 v153, 0
    v_mov_b32 v154, 0
    v_mov_b32 v155, 0
    v_mov_b32 v156, 0
    v_mov_b32 v157, 0
    v_mov_b32 v158, 0
    v_mov_b32 v159, 0
    v_mov_b32 v160, 0
    v_mov_b32 v161, 0
    v_mov_b32 v162, 0
    v_mov_b32 v163, 0
    v_mov_b32 v164, 0
    v_mov_b32 v165, 0
    v_mov_b32 v166, 0
    v_mov_b32 v167, 0
    v_mov_b32 v168, 0
    v_mov_b32 v169, 0
    v_mov_b32 v170, 0
    v_mov_b32 v171, 0
    v_mov_b32 v172, 0
    v_mov_b32 v173, 0
    v_mov_b32 v174, 0
    v_mov_b32 v175, 0
    v_mov_b32 v176, 0
    v_mov_b32 v177, 0
    v_mov_b32 v178, 0
    v_mov_b32 v179, 0
    v_mov_b32 v180, 0
    v_mov_b32 v181, 0
    v_mov_b32 v182, 0
    v_mov_b32 v183, 0
    v_mov_b32 v184, 0
    v_mov_b32 v185, 0
    v_mov_b32 v186, 0
    v_mov_b32 v187, 0
    v_mov_b32 v188, 0
    v_mov_b32 v189, 0
    v_mov_b32 v190, 0
    v_mov_b32 v191, 0
    v_mov_b32 v228, 0
    v_mov_b32 v229, 0
    v_mov_b32 v230, 0
    v_mov_b32 v231, 0
    v_mov_b32 v232, 0
    v_mov_b32 v233, 0
    v_mov_b32 v234, 0
    v_mov_b32 v235, 0
    v_mov_b32 v236, 0
    v_mov_b32 v237, 0
    v_mov_b32 v238, 0
    v_mov_b32 v239, 0
    v_mov_b32 v240, 0
    v_mov_b32 v241, 0
    v_mov_b32 v242, 0
    v_mov_b32 v243, 0
    v_mov_b32 v23, 0
    v_mov_b32 v225, 0
    s_waitcnt vmcnt(8)
    s_barrier
    ds_read_b128 v[192:195], v3 offset:0
    ds_read_b128 v[196:199], v3 offset:8192
    ds_read_b128 v[200:203], v3 offset:1024
    ds_read_b128 v[204:207], v3 offset:9216
    ds_read_b128 v[208:211], v3 offset:2048
    s_waitcnt lgkmcnt(4)
    v_mfma_f32_32x32x16_bf16 v[64:79], v[192:195], v[32:35], v[228:243]
    ds_read_b128 v[212:215], v3 offset:10240
    s_waitcnt lgkmcnt(4)
    v_mfma_f32_32x32x16_bf16 v[80:95], v[196:199], v[32:35], v[228:243]
    ds_read_b128 v[216:219], v3 offset:3072
    s_waitcnt lgkmcnt(4)
    v_mfma_f32_32x32x16_bf16 v[64:79], v[200:203], v[36:39], v[64:79]
    ds_read_b128 v[220:223], v3 offset:11264
    s_waitcnt lgkmcnt(4)
    v_mfma_f32_32x32x16_bf16 v[80:95], v[204:207], v[36:39], v[80:95]
    ds_read_b128 v[192:195], v3 offset:4096
    s_waitcnt lgkmcnt(4)
    v_mfma_f32_32x32x16_bf16 v[64:79], v[208:211], v[40:43], v[64:79]
    ds_read_b128 v[196:199], v3 offset:12288
    s_waitcnt lgkmcnt(4)
    v_mfma_f32_32x32x16_bf16 v[80:95], v[212:215], v[40:43], v[80:95]
    ds_read_b128 v[200:203], v3 offset:5120
    s_waitcnt lgkmcnt(4)
    v_mfma_f32_32x32x16_bf16 v[64:79], v[216:219], v[44:47], v[64:79]
    ds_read_b128 v[204:207], v3 offset:13312
    s_waitcnt lgkmcnt(4)
    v_mfma_f32_32x32x16_bf16 v[80:95], v[220:223], v[44:47], v[80:95]
    ds_read_b128 v[208:211], v3 offset:6144
    s_waitcnt lgkmcnt(4)
    v_mfma_f32_32x32x16_bf16 v[64:79], v[192:195], v[48:51], v[64:79]
    ds_read_b128 v[212:215], v3 offset:14336
    s_waitcnt lgkmcnt(4)
    v_mfma_f32_32x32x16_bf16 v[80:95], v[196:199], v[48:51], v[80:95]
    ds_read_b128 v[216:219], v3 offset:7168
    s_waitcnt lgkmcnt(4)
    v_mfma_f32_32x32x16_bf16 v[64:79], v[200:203], v[52:55], v[64:79]
    ds_read_b128 v[220:223], v3 offset:15360
    s_waitcnt lgkmcnt(4)
    v_mfma_f32_32x32x16_bf16 v[80:95], v[204:207], v[52:55], v[80:95]
    s_waitcnt lgkmcnt(3)
    v_mfma_f32_32x32x16_bf16 v[64:79], v[208:211], v[56:59], v[64:79]
    s_waitcnt lgkmcnt(2)
    v_mfma_f32_32x32x16_bf16 v[80:95], v[212:215], v[56:59], v[80:95]
    s_waitcnt lgkmcnt(1)
    v_mfma_f32_32x32x16_bf16 v[64:79], v[216:219], v[60:63], v[64:79]
    s_waitcnt lgkmcnt(0)
    v_mfma_f32_32x32x16_bf16 v[80:95], v[220:223], v[60:63], v[80:95]
    s_nop 7
    s_nop 7
    s_cmp_lg_u32 s47, 1
    s_cbranch_scc1 L_nomask_attn_kernel_5
    v_mov_b32 v26, 0xff61b1e6
    v_cmp_le_i32 s[64:65], 0, v25
    v_cmp_le_i32 s[66:67], 1, v25
    v_cmp_le_i32 s[68:69], 2, v25
    v_cmp_le_i32 s[70:71], 3, v25
    s_nop 0
    v_cndmask_b32 v64, v26, v64, s[64:65]
    v_cndmask_b32 v65, v26, v65, s[66:67]
    v_cndmask_b32 v66, v26, v66, s[68:69]
    v_cndmask_b32 v67, v26, v67, s[70:71]
    v_cmp_le_i32 s[64:65], 4, v25
    v_cmp_le_i32 s[66:67], 5, v25
    v_cmp_le_i32 s[68:69], 6, v25
    v_cmp_le_i32 s[70:71], 7, v25
    s_nop 0
    v_cndmask_b32 v68, v26, v68, s[64:65]
    v_cndmask_b32 v69, v26, v69, s[66:67]
    v_cndmask_b32 v70, v26, v70, s[68:69]
    v_cndmask_b32 v71, v26, v71, s[70:71]
    v_cmp_le_i32 s[64:65], 16, v25
    v_cmp_le_i32 s[66:67], 17, v25
    v_cmp_le_i32 s[68:69], 18, v25
    v_cmp_le_i32 s[70:71], 19, v25
    s_nop 0
    v_cndmask_b32 v72, v26, v72, s[64:65]
    v_cndmask_b32 v73, v26, v73, s[66:67]
    v_cndmask_b32 v74, v26, v74, s[68:69]
    v_cndmask_b32 v75, v26, v75, s[70:71]
    v_cmp_le_i32 s[64:65], 20, v25
    v_cmp_le_i32 s[66:67], 21, v25
    v_cmp_le_i32 s[68:69], 22, v25
    v_cmp_le_i32 s[70:71], 23, v25
    s_nop 0
    v_cndmask_b32 v76, v26, v76, s[64:65]
    v_cndmask_b32 v77, v26, v77, s[66:67]
    v_cndmask_b32 v78, v26, v78, s[68:69]
    v_cndmask_b32 v79, v26, v79, s[70:71]
    v_cmp_le_i32 s[64:65], 32, v25
    v_cmp_le_i32 s[66:67], 33, v25
    v_cmp_le_i32 s[68:69], 34, v25
    v_cmp_le_i32 s[70:71], 35, v25
    s_nop 0
    v_cndmask_b32 v80, v26, v80, s[64:65]
    v_cndmask_b32 v81, v26, v81, s[66:67]
    v_cndmask_b32 v82, v26, v82, s[68:69]
    v_cndmask_b32 v83, v26, v83, s[70:71]
    v_cmp_le_i32 s[64:65], 36, v25
    v_cmp_le_i32 s[66:67], 37, v25
    v_cmp_le_i32 s[68:69], 38, v25
    v_cmp_le_i32 s[70:71], 39, v25
    s_nop 0
    v_cndmask_b32 v84, v26, v84, s[64:65]
    v_cndmask_b32 v85, v26, v85, s[66:67]
    v_cndmask_b32 v86, v26, v86, s[68:69]
    v_cndmask_b32 v87, v26, v87, s[70:71]
    v_cmp_le_i32 s[64:65], 48, v25
    v_cmp_le_i32 s[66:67], 49, v25
    v_cmp_le_i32 s[68:69], 50, v25
    v_cmp_le_i32 s[70:71], 51, v25
    s_nop 0
    v_cndmask_b32 v88, v26, v88, s[64:65]
    v_cndmask_b32 v89, v26, v89, s[66:67]
    v_cndmask_b32 v90, v26, v90, s[68:69]
    v_cndmask_b32 v91, v26, v91, s[70:71]
    v_cmp_le_i32 s[64:65], 52, v25
    v_cmp_le_i32 s[66:67], 53, v25
    v_cmp_le_i32 s[68:69], 54, v25
    v_cmp_le_i32 s[70:71], 55, v25
    s_nop 0
    v_cndmask_b32 v92, v26, v92, s[64:65]
    v_cndmask_b32 v93, v26, v93, s[66:67]
    v_cndmask_b32 v94, v26, v94, s[68:69]
    v_cndmask_b32 v95, v26, v95, s[70:71]
L_nomask_attn_kernel_5:
    v_max3_f32 v31, v64, v65, v66
    v_max3_f32 v31, v31, v67, v68
    v_max3_f32 v31, v31, v69, v70
    v_max3_f32 v31, v31, v71, v72
    v_max3_f32 v31, v31, v73, v74
    v_max3_f32 v31, v31, v75, v76
    v_max3_f32 v31, v31, v77, v78
    v_max3_f32 v31, v31, v79, v80
    v_max3_f32 v31, v31, v81, v82
    v_max3_f32 v31, v31, v83, v84
    v_max3_f32 v31, v31, v85, v86
    v_max3_f32 v31, v31, v87, v88
    v_max3_f32 v31, v31, v89, v90
    v_max3_f32 v31, v31, v91, v92
    v_max3_f32 v31, v31, v93, v94
    v_max_f32 v31, v31, v95
    v_mov_b32 v27, v31
    s_nop 1
    v_permlane32_swap_b32 v31, v27
    v_max_f32 v31, v31, v27
    v_max_f32 v22, 0xf149f2ca, v31
    v_sub_f32 v64, v64, v22
    v_sub_f32 v65, v65, v22
    v_sub_f32 v66, v66, v22
    v_sub_f32 v67, v67, v22
    v_sub_f32 v68, v68, v22
    v_sub_f32 v69, v69, v22
    v_sub_f32 v70, v70, v22
    v_sub_f32 v71, v71, v22
    v_sub_f32 v72, v72, v22
    v_sub_f32 v73, v73, v22
    v_sub_f32 v74, v74, v22
    v_sub_f32 v75, v75, v22
    v_sub_f32 v76, v76, v22
    v_sub_f32 v77, v77, v22
    v_sub_f32 v78, v78, v22
    v_sub_f32 v79, v79, v22
    v_sub_f32 v80, v80, v22
    v_sub_f32 v81, v81, v22
    v_sub_f32 v82, v82, v22
    v_sub_f32 v83, v83, v22
    v_sub_f32 v84, v84, v22
    v_sub_f32 v85, v85, v22
    v_sub_f32 v86, v86, v22
    v_sub_f32 v87, v87, v22
    v_sub_f32 v88, v88, v22
    v_sub_f32 v89, v89, v22
    v_sub_f32 v90, v90, v22
    v_sub_f32 v91, v91, v22
    v_sub_f32 v92, v92, v22
    v_sub_f32 v93, v93, v22
    v_sub_f32 v94, v94, v22
    v_sub_f32 v95, v95, v22
    v_sub_f32 v228, 0, v22
    v_sub_f32 v229, 0, v22
    v_sub_f32 v230, 0, v22
    v_sub_f32 v231, 0, v22
    v_sub_f32 v232, 0, v22
    v_sub_f32 v233, 0, v22
    v_sub_f32 v234, 0, v22
    v_sub_f32 v235, 0, v22
    v_sub_f32 v236, 0, v22
    v_sub_f32 v237, 0, v22
    v_sub_f32 v238, 0, v22
    v_sub_f32 v239, 0, v22
    v_sub_f32 v240, 0, v22
    v_sub_f32 v241, 0, v22
    v_sub_f32 v242, 0, v22
    v_sub_f32 v243, 0, v22
    s_mov_b64 vcc, 0
L_attn_loop:
    s_cmp_eq_u32 s47, 1
    s_cbranch_scc1 L_attn_tail0
    s_waitcnt vmcnt(0)
    s_barrier
    s_cbranch_vccz L_nors_attn_kernel_6
    s_nop 7
    s_nop 7
    v_max_f32 v31, 0, v31
    v_sub_f32 v24, 0, v31
    v_exp_f32 v24, v24
    v_add_f32 v22, v22, v31
    v_sub_f32 v64, v64, v31
    v_sub_f32 v65, v65, v31
    v_sub_f32 v66, v66, v31
    v_sub_f32 v67, v67, v31
    v_sub_f32 v68, v68, v31
    v_sub_f32 v69, v69, v31
    v_sub_f32 v70, v70, v31
    v_sub_f32 v71, v71, v31
    v_sub_f32 v72, v72, v31
    v_sub_f32 v73, v73, v31
    v_sub_f32 v74, v74, v31
    v_sub_f32 v75, v75, v31
    v_sub_f32 v76, v76, v31
    v_sub_f32 v77, v77, v31
    v_sub_f32 v78, v78, v31
    v_sub_f32 v79, v79, v31
    v_sub_f32 v80, v80, v31
    v_sub_f32 v81, v81, v31
    v_sub_f32 v82, v82, v31
    v_sub_f32 v83, v83, v31
    v_sub_f32 v84, v84, v31
    v_sub_f32 v85, v85, v31
    v_sub_f32 v86, v86, v31
    v_sub_f32 v87, v87, v31
    v_sub_f32 v88, v88, v31
    v_sub_f32 v89, v89, v31
    v_sub_f32 v90, v90, v31
    v_sub_f32 v91, v91, v31
    v_sub_f32 v92, v92, v31
    v_sub_f32 v93, v93, v31
    v_sub_f32 v94, v94, v31
    v_sub_f32 v95, v95, v31
    v_sub_f32 v228, v228, v31
    v_sub_f32 v229, v229, v31
    v_sub_f32 v230, v230, v31
    v_sub_f32 v231, v231, v31
    v_sub_f32 v232, v232, v31
    v_sub_f32 v233, v233, v31
    v_sub_f32 v234, v234, v31
    v_sub_f32 v235, v235, v31
    v_sub_f32 v236, v236, v31
    v_sub_f32 v237, v237, v31
    v_sub_f32 v238, v238, v31
    v_sub_f32 v239, v239, v31
    v_sub_f32 v240, v240, v31
    v_sub_f32 v241, v241, v31
    v_sub_f32 v242, v242, v31
    v_sub_f32 v243, v243, v31
    v_mul_f32 v23, v23, v24
    v_mul_f32 v225, v225, v24
    v_mul_f32 v128, v128, v24
    v_mul_f32 v129, v129, v24
    v_mul_f32 v130, v130, v24
    v_mul_f32 v131, v131, v24
    v_mul_f32 v132, v132, v24
    v_mul_f32 v133, v133, v24
    v_mul_f32 v134, v134, v24
    v_mul_f32 v135, v135, v24
    v_mul_f32 v136, v136, v24
    v_mul_f32 v137, v137, v24
    v_mul_f32 v138, v138, v24
    v_mul_f32 v139, v139, v24
    v_mul_f32 v140, v140, v24
    v_mul_f32 v141, v141, v24
    v_mul_f32 v142, v142, v24
    v_mul_f32 v143, v143, v24
    v_mul_f32 v144, v144, v24
    v_mul_f32 v145, v145, v24
    v_mul_f32 v146, v146, v24
    v_mul_f32 v147, v147, v24
    v_mul_f32 v148, v148, v24
    v_mul_f32 v149, v149, v24
    v_mul_f32 v150, v150, v24
    v_mul_f32 v151, v151, v24
    v_mul_f32 v152, v152, v24
    v_mul_f32 v153, v153, v24
    v_mul_f32 v154, v154, v24
    v_mul_f32 v155, v155, v24
    v_mul_f32 v156, v156, v24
    v_mul_f32 v157, v157, v24
    v_mul_f32 v158, v158, v24
    v_mul_f32 v159, v159, v24
    v_mul_f32 v160, v160, v24
    v_mul_f32 v161, v161, v24
    v_mul_f32 v162, v162, v24
    v_mul_f32 v163, v163, v24
    v_mul_f32 v164, v164, v24
    v_mul_f32 v165, v165, v24
    v_mul_f32 v166, v166, v24
    v_mul_f32 v167, v167, v24
    v_mul_f32 v168, v168, v24
    v_mul_f32 v169, v169, v24
    v_mul_f32 v170, v170, v24
    v_mul_f32 v171, v171, v24
    v_mul_f32 v172, v172, v24
    v_mul_f32 v173, v173, v24
    v_mul_f32 v174, v174, v24
    v_mul_f32 v175, v175, v24
    v_mul_f32 v176, v176, v24
    v_mul_f32 v177, v177, v24
    v_mul_f32 v178, v178, v24
    v_mul_f32 v179, v179, v24
    v_mul_f32 v180, v180, v24
    v_mul_f32 v181, v181, v24
    v_mul_f32 v182, v182, v24
    v_mul_f32 v183, v183, v24
    v_mul_f32 v184, v184, v24
    v_mul_f32 v185, v185, v24
    v_mul_f32 v186, v186, v24
    v_mul_f32 v187, v187, v24
    v_mul_f32 v188, v188, v24
    v_mul_f32 v189, v189, v24
    v_mul_f32 v190, v190, v24
    v_mul_f32 v191, v191, v24
L_nors_attn_kernel_6:
    ds_read_b128 v[192:195], v3 offset:16384
    ds_read_b128 v[196:199], v3 offset:24576
    ds_read_b128 v[200:203], v3 offset:17408
    ds_read_b128 v[204:207], v3 offset:25600
    ds_read_b128 v[208:211], v3 offset:18432
    s_waitcnt lgkmcnt(4)
    v_mfma_f32_32x32x16_bf16 v[96:111], v[192:195], v[32:35], v[228:243]
    s_mov_b32 m0, s48
    v_exp_f32 v64, v64
    v_exp_f32 v65, v65
    ds_read_b128 v[212:215], v3 offset:26624
    s_waitcnt lgkmcnt(4)
    v_mfma_f32_32x32x16_bf16 v[112:127], v[196:199], v[32:35], v[228:243]
    buffer_load_dwordx4 v2, s[8:11], s45 offen offset:0 lds
    v_exp_f32 v66, v66
    v_exp_f32 v67, v67
    v_exp_f32 v68, v68
    ds_read_b128 v[216:219], v3 offset:19456
    s_waitcnt lgkmcnt(4)
    v_mfma_f32_32x32x16_bf16 v[96:111], v[200:203], v[36:39], v[96:111]
    v_exp_f32 v69, v69
    v_exp_f32 v70, v70
    ds_read_b128 v[220:223], v3 offset:27648
    s_waitcnt lgkmcnt(4)
    v_mfma_f32_32x32x16_bf16 v[112:127], v[204:207], v[36:39], v[112:127]
    buffer_load_dwordx4 v2, s[8:11], s45 offen offset:1024 lds
    v_exp_f32 v71, v71
    v_add_f32 v23, v23, v64
    v_add_f32 v23, v23, v65
    ds_read_b128 v[192:195], v3 offset:20480
    s_waitcnt lgkmcnt(4)
    v_mfma_f32_32x32x16_bf16 v[96:111], v[208:211], v[40:43], v[96:111]
    v_add_f32 v23, v23, v66
    v_add_f32 v23, v23, v67
    ds_read_b128 v[196:199], v3 offset:28672
    s_waitcnt lgkmcnt(4)
    v_mfma_f32_32x32x16_bf16 v[112:127], v[212:215], v[40:43], v[112:127]
    buffer_load_dwordx4 v2, s[8:11], s45 offen offset:2048 lds
    v_add_f32 v23, v23, v68
    v_add_f32 v23, v23, v69
    v_add_f32 v23, v23, v70
    ds_read_b128 v[200:203], v3 offset:21504
    s_waitcnt lgkmcnt(4)
    v_mfma_f32_32x32x16_bf16 v[96:111], v[216:219], v[44:47], v[96:111]
    v_add_f32 v23, v23, v71
    v_cvt_pk_bf16_f32 v64, v64, v65
    ds_read_b128 v[204:207], v3 offset:29696
    s_waitcnt lgkmcnt(4)
    v_mfma_f32_32x32x16_bf16 v[112:127], v[220:223], v[44:47], v[112:127]
    buffer_load_dwordx4 v2, s[8:11], s45 offen offset:3072 lds
    v_cvt_pk_bf16_f32 v65, v66, v67
    v_cvt_pk_bf16_f32 v66, v68, v69
    v_cvt_pk_bf16_f32 v67, v70, v71
    ds_read_b128 v[208:211], v3 offset:22528
    s_waitcnt lgkmcnt(4)
    v_mfma_f32_32x32x16_bf16 v[96:111], v[192:195], v[48:51], v[96:111]
    s_mov_b32 m0, s49
    v_exp_f32 v72, v72
    v_exp_f32 v73, v73
    ds_read_b128 v[212:215], v3 offset:30720
    s_waitcnt lgkmcnt(4)
    v_mfma_f32_32x32x16_bf16 v[112:127], v[196:199], v[48:51], v[112:127]
    buffer_load_dwordx4 v2, s[12:15], s46 offen offset:0 lds
    v_exp_f32 v74, v74
    v_exp_f32 v75, v75
    v_exp_f32 v76, v76
    ds_read_b128 v[216:219], v3 offset:23552
    s_waitcnt lgkmcnt(4)
    v_mfma_f32_32x32x16_bf16 v[96:111], v[200:203], v[52:55], v[96:111]
    v_exp_f32 v77, v77
    v_exp_f32 v78, v78
    ds_read_b128 v[220:223], v3 offset:31744
    s_waitcnt lgkmcnt(4)
    v_mfma_f32_32x32x16_bf16 v[112:127], v[204:207], v[52:55], v[112:127]
    buffer_load_dwordx4 v2, s[12:15], s46 offen offset:1024 lds
    v_exp_f32 v79, v79
    v_add_f32 v225, v225, v72
    v_add_f32 v225, v225, v73
    ds_read_b128 v[192:195], v3 offset:32768
    s_waitcnt lgkmcnt(4)
    v_mfma_f32_32x32x16_bf16 v[96:111], v[208:211], v[56:59], v[96:111]
    v_add_f32 v225, v225, v74
    v_add_f32 v225, v225, v75
    ds_read_b128 v[196:199], v3 offset:33792
    s_waitcnt lgkmcnt(4)
    v_mfma_f32_32x32x16_bf16 v[112:127], v[212:215], v[56:59], v[112:127]
    buffer_load_dwordx4 v2, s[12:15], s46 offen offset:2048 lds
    v_add_f32 v225, v225, v76
    v_add_f32 v225, v225, v77
    v_add_f32 v225, v225, v78
    ds_read_b128 v[200:203], v3 offset:34816
    s_waitcnt lgkmcnt(4)
    v_mfma_f32_32x32x16_bf16 v[96:111], v[216:219], v[60:63], v[96:111]
    v_add_f32 v225, v225, v79
    v_cvt_pk_bf16_f32 v72, v72, v73
    ds_read_b128 v[204:207], v3 offset:35840
    s_waitcnt lgkmcnt(4)
    v_mfma_f32_32x32x16_bf16 v[112:127], v[220:223], v[60:63], v[112:127]
    buffer_load_dwordx4 v2, s[12:15], s46 offen offset:3072 lds
    v_cvt_pk_bf16_f32 v73, v74, v75
    v_cvt_pk_bf16_f32 v74, v76, v77
    v_cvt_pk_bf16_f32 v75, v78, v79
    s_add_u32 s45, s45, 32768
    s_xor_b32 s48, s48, 0x4000
    s_add_u32 s46, s46, 32768
    s_xor_b32 s49, s49, 0x4000
    ds_read_b128 v[208:211], v3 offset:36864
    s_waitcnt lgkmcnt(4)
    v_mfma_f32_32x32x16_bf16 v[128:143], v[192:195], v[64:67], v[128:143]
    v_exp_f32 v80, v80
    v_exp_f32 v81, v81
    ds_read_b128 v[212:215], v3 offset:37888
    s_waitcnt lgkmcnt(4)
    v_mfma_f32_32x32x16_bf16 v[144:159], v[196:199], v[64:67], v[144:159]
    v_exp_f32 v82, v82
    v_exp_f32 v83, v83
    v_exp_f32 v84, v84
    ds_read_b128 v[216:219], v3 offset:38912
    s_waitcnt lgkmcnt(4)
    v_mfma_f32_32x32x16_bf16 v[160:175], v[200:203], v[64:67], v[160:175]
    v_exp_f32 v85, v85
    v_exp_f32 v86, v86
    v_exp_f32 v87, v87
    ds_read_b128 v[220:223], v3 offset:39936
    s_waitcnt lgkmcnt(4)
    v_mfma_f32_32x32x16_bf16 v[176:191], v[204:207], v[64:67], v[176:191]
    v_add_f32 v23, v23, v80
    v_add_f32 v23, v23, v81
    v_add_f32 v23, v23, v82
    ds_read_b128 v[192:195], v3 offset:40960
    s_waitcnt lgkmcnt(4)
    v_mfma_f32_32x32x16_bf16 v[128:143], v[208:211], v[72:75], v[128:143]
    v_add_f32 v23, v23, v83
    v_add_f32 v23, v23, v84
    v_add_f32 v23, v23, v85
    ds_read_b128 v[196:199], v3 offset:41984
    s_waitcnt lgkmcnt(4)
    v_mfma_f32_32x32x16_bf16 v[144:159], v[212:215], v[72:75], v[144:159]
    v_add_f32 v23, v23, v86
    v_add_f32 v23, v23, v87
    v_cvt_pk_bf16_f32 v80, v80, v81
    ds_read_b128 v[200:203], v3 offset:43008
    s_waitcnt lgkmcnt(4)
    v_mfma_f32_32x32x16_bf16 v[160:175], v[216:219], v[72:75], v[160:175]
    v_cvt_pk_bf16_f32 v81, v82, v83
    v_cvt_pk_bf16_f32 v82, v84, v85
    v_cvt_pk_bf16_f32 v83, v86, v87
    s_nop 0
    ds_read_b128 v[204:207], v3 offset:44032
    s_waitcnt lgkmcnt(4)
    v_mfma_f32_32x32x16_bf16 v[176:191], v[220:223], v[72:75], v[176:191]
    v_exp_f32 v88, v88
    v_exp_f32 v89, v89
    v_exp_f32 v90, v90
    v_exp_f32 v91, v91
    v_exp_f32 v92, v92
    ds_read_b128 v[208:211], v3 offset:45056
    s_waitcnt lgkmcnt(4)
    v_mfma_f32_32x32x16_bf16 v[128:143], v[192:195], v[80:83], v[128:143]
    v_exp_f32 v93, v93
    v_exp_f32 v94, v94
    v_exp_f32 v95, v95
    v_add_f32 v225, v225, v88
    v_add_f32 v225, v225, v89
    ds_read_b128 v[212:215], v3 offset:46080
    s_waitcnt lgkmcnt(4)
    v_mfma_f32_32x32x16_bf16 v[144:159], v[196:199], v[80:83], v[144:159]
    v_add_f32 v225, v225, v90
    v_add_f32 v225, v225, v91
    v_add_f32 v225, v225, v92
    v_add_f32 v225, v225, v93
    v_add_f32 v225, v225, v94
    ds_read_b128 v[216:219], v3 offset:47104
    s_waitcnt lgkmcnt(4)
    v_mfma_f32_32x32x16_bf16 v[160:175], v[200:203], v[80:83], v[160:175]
    v_add_f32 v225, v225, v95
    v_cvt_pk_bf16_f32 v88, v88, v89
    v_cvt_pk_bf16_f32 v89, v90, v91
    v_cvt_pk_bf16_f32 v90, v92, v93
    v_cvt_pk_bf16_f32 v91, v94, v95
    s_nop 0
    s_cmp_lg_u32 s47, 2
    s_cbranch_scc1 L_nomask_attn_kernel_7
    v_mov_b32 v26, 0xff61b1e6
    v_cmp_le_i32 s[64:65], 0, v25
    v_cmp_le_i32 s[66:67], 1, v25
    v_cmp_le_i32 s[68:69], 2, v25
    v_cmp_le_i32 s[70:71], 3, v25
    s_nop 0
    v_cndmask_b32 v96, v26, v96, s[64:65]
    v_cndmask_b32 v97, v26, v97, s[66:67]
    v_cndmask_b32 v98, v26, v98, s[68:69]
    v_cndmask_b32 v99, v26, v99, s[70:71]
    v_cmp_le_i32 s[64:65], 4, v25
    v_cmp_le_i32 s[66:67], 5, v25
    v_cmp_le_i32 s[68:69], 6, v25
    v_cmp_le_i32 s[70:71], 7, v25
    s_nop 0
    v_cndmask_b32 v100, v26, v100, s[64:65]
    v_cndmask_b32 v101, v26, v101, s[66:67]
    v_cndmask_b32 v102, v26, v102, s[68:69]
    v_cndmask_b32 v103, v26, v103, s[70:71]
    v_cmp_le_i32 s[64:65], 16, v25
    v_cmp_le_i32 s[66:67], 17, v25
    v_cmp_le_i32 s[68:69], 18, v25
    v_cmp_le_i32 s[70:71], 19, v25
    s_nop 0
    v_cndmask_b32 v104, v26, v104, s[64:65]
    v_cndmask_b32 v105, v26, v105, s[66:67]
    v_cndmask_b32 v106, v26, v106, s[68:69]
    v_cndmask_b32 v107, v26, v107, s[70:71]
    v_cmp_le_i32 s[64:65], 20, v25
    v_cmp_le_i32 s[66:67], 21, v25
    v_cmp_le_i32 s[68:69], 22, v25
    v_cmp_le_i32 s[70:71], 23, v25
    s_nop 0
    v_cndmask_b32 v108, v26, v108, s[64:65]
    v_cndmask_b32 v109, v26, v109, s[66:67]
    v_cndmask_b32 v110, v26, v110, s[68:69]
    v_cndmask_b32 v111, v26, v111, s[70:71]
    v_cmp_le_i32 s[64:65], 32, v25
    v_cmp_le_i32 s[66:67], 33, v25
    v_cmp_le_i32 s[68:69], 34, v25
    v_cmp_le_i32 s[70:71], 35, v25
    s_nop 0
    v_cndmask_b32 v112, v26, v112, s[64:65]
    v_cndmask_b32 v113, v26, v113, s[66:67]
    v_cndmask_b32 v114, v26, v114, s[68:69]
    v_cndmask_b32 v115, v26, v115, s[70:71]
    v_cmp_le_i32 s[64:65], 36, v25
    v_cmp_le_i32 s[66:67], 37, v25
    v_cmp_le_i32 s[68:69], 38, v25
    v_cmp_le_i32 s[70:71], 39, v25
    s_nop 0
    v_cndmask_b32 v116, v26, v116, s[64:65]
    v_cndmask_b32 v117, v26, v117, s[66:67]
    v_cndmask_b32 v118, v26, v118, s[68:69]
    v_cndmask_b32 v119, v26, v119, s[70:71]
    v_cmp_le_i32 s[64:65], 48, v25
    v_cmp_le_i32 s[66:67], 49, v25
    v_cmp_le_i32 s[68:69], 50, v25
    v_cmp_le_i32 s[70:71], 51, v25
    s_nop 0
    v_cndmask_b32 v120, v26, v120, s[64:65]
    v_cndmask_b32 v121, v26, v121, s[66:67]
    v_cndmask_b32 v122, v26, v122, s[68:69]
    v_cndmask_b32 v123, v26, v123, s[70:71]
    v_cmp_le_i32 s[64:65], 52, v25
    v_cmp_le_i32 s[66:67], 53, v25
    v_cmp_le_i32 s[68:69], 54, v25
    v_cmp_le_i32 s[70:71], 55, v25
    s_nop 0
    v_cndmask_b32 v124, v26, v124, s[64:65]
    v_cndmask_b32 v125, v26, v125, s[66:67]
    v_cndmask_b32 v126, v26, v126, s[68:69]
    v_cndmask_b32 v127, v26, v127, s[70:71]
L_nomask_attn_kernel_7:
    ds_read_b128 v[220:223], v3 offset:48128
    s_waitcnt lgkmcnt(4)
    v_mfma_f32_32x32x16_bf16 v[176:191], v[204:207], v[80:83], v[176:191]
    v_max3_f32 v31, v96, v97, v98
    v_max3_f32 v31, v31, v99, v100
    v_max3_f32 v31, v31, v101, v102
    s_waitcnt lgkmcnt(3)
    v_mfma_f32_32x32x16_bf16 v[128:143], v[208:211], v[88:91], v[128:143]
    v_max3_f32 v31, v31, v103, v104
    v_max3_f32 v31, v31, v105, v106
    v_max3_f32 v31, v31, v107, v108
    s_waitcnt lgkmcnt(2)
    v_mfma_f32_32x32x16_bf16 v[144:159], v[212:215], v[88:91], v[144:159]
    v_max3_f32 v31, v31, v109, v110
    v_max3_f32 v31, v31, v111, v112
    v_max3_f32 v31, v31, v113, v114
    s_waitcnt lgkmcnt(1)
    v_mfma_f32_32x32x16_bf16 v[160:175], v[216:219], v[88:91], v[160:175]
    v_max3_f32 v31, v31, v115, v116
    v_max3_f32 v31, v31, v117, v118
    v_max3_f32 v31, v31, v119, v120
    s_waitcnt lgkmcnt(0)
    v_mfma_f32_32x32x16_bf16 v[176:191], v[220:223], v[88:91], v[176:191]
    v_max3_f32 v31, v31, v121, v122
    v_max3_f32 v31, v31, v123, v124
    v_max3_f32 v31, v31, v125, v126
    v_max_f32 v31, v31, v127
    v_mov_b32 v27, v31
    s_nop 1
    v_permlane32_swap_b32 v31, v27
    v_max_f32 v31, v31, v27
    v_cmp_lt_f32 vcc, 0x41000000, v31
    s_sub_u32 s47, s47, 1
    s_cmp_eq_u32 s47, 1
    s_cbranch_scc1 L_attn_tail1
    s_waitcnt vmcnt(0)
    s_barrier
    s_cbranch_vccz L_nors_attn_kernel_8
    s_nop 7
    s_nop 7
    v_max_f32 v31, 0, v31
    v_sub_f32 v24, 0, v31
    v_exp_f32 v24, v24
    v_add_f32 v22, v22, v31
    v_sub_f32 v96, v96, v31
    v_sub_f32 v97, v97, v31
    v_sub_f32 v98, v98, v31
    v_sub_f32 v99, v99, v31
    v_sub_f32 v100, v100, v31
    v_sub_f32 v101, v101, v31
    v_sub_f32 v102, v102, v31
    v_sub_f32 v103, v103, v31
    v_sub_f32 v104, v104, v31
    v_sub_f32 v105, v105, v31
    v_sub_f32 v106, v106, v31
    v_sub_f32 v107, v107, v31
    v_sub_f32 v108, v108, v31
    v_sub_f32 v109, v109, v31
    v_sub_f32 v110, v110, v31
    v_sub_f32 v111, v111, v31
    v_sub_f32 v112, v112, v31
    v_sub_f32 v113, v113, v31
    v_sub_f32 v114, v114, v31
    v_sub_f32 v115, v115, v31
    v_sub_f32 v116, v116, v31
    v_sub_f32 v117, v117, v31
    v_sub_f32 v118, v118, v31
    v_sub_f32 v119, v119, v31
    v_sub_f32 v120, v120, v31
    v_sub_f32 v121, v121, v31
    v_sub_f32 v122, v122, v31
    v_sub_f32 v123, v123, v31
    v_sub_f32 v124, v124, v31
    v_sub_f32 v125, v125, v31
    v_sub_f32 v126, v126, v31
    v_sub_f32 v127, v127, v31
    v_sub_f32 v228, v228, v31
    v_sub_f32 v229, v229, v31
    v_sub_f32 v230, v230, v31
    v_sub_f32 v231, v231, v31
    v_sub_f32 v232, v232, v31
    v_sub_f32 v233, v233, v31
    v_sub_f32 v234, v234, v31
    v_sub_f32 v235, v235, v31
    v_sub_f32 v236, v236, v31
    v_sub_f32 v237, v237, v31
    v_sub_f32 v238, v238, v31
    v_sub_f32 v239, v239, v31
    v_sub_f32 v240, v240, v31
    v_sub_f32 v241, v241, v31
    v_sub_f32 v242, v242, v31
    v_sub_f32 v243, v243, v31
    v_mul_f32 v23, v23, v24
    v_mul_f32 v225, v225, v24
    v_mul_f32 v128, v128, v24
    v_mul_f32 v129, v129, v24
    v_mul_f32 v130, v130, v24
    v_mul_f32 v131, v131, v24
    v_mul_f32 v132, v132, v24
    v_mul_f32 v133, v133, v24
    v_mul_f32 v134, v134, v24
    v_mul_f32 v135, v135, v24
    v_mul_f32 v136, v136, v24
    v_mul_f32 v137, v137, v24
    v_mul_f32 v138, v138, v24
    v_mul_f32 v139, v139, v24
    v_mul_f32 v140, v140, v24
    v_mul_f32 v141, v141, v24
    v_mul_f32 v142, v142, v24
    v_mul_f32 v143, v143, v24
    v_mul_f32 v144, v144, v24
    v_mul_f32 v145, v145, v24
    v_mul_f32 v146, v146, v24
    v_mul_f32 v147, v147, v24
    v_mul_f32 v148, v148, v24
    v_mul_f32 v149, v149, v24
    v_mul_f32 v150, v150, v24
    v_mul_f32 v151, v151, v24
    v_mul_f32 v152, v152, v24
    v_mul_f32 v153, v153, v24
    v_mul_f32 v154, v154, v24
    v_mul_f32 v155, v155, v24
    v_mul_f32 v156, v156, v24
    v_mul_f32 v157, v157, v24
    v_mul_f32 v158, v158, v24
    v_mul_f32 v159, v159, v24
    v_mul_f32 v160, v160, v24
    v_mul_f32 v161, v161, v24
    v_mul_f32 v162, v162, v24
    v_mul_f32 v163, v163, v24
    v_mul_f32 v164, v164, v24
    v_mul_f32 v165, v165, v24
    v_mul_f32 v166, v166, v24
    v_mul_f32 v167, v167, v24
    v_mul_f32 v168, v168, v24
    v_mul_f32 v169, v169, v24
    v_mul_f32 v170, v170, v24
    v_mul_f32 v171, v171, v24
    v_mul_f32 v172, v172, v24
    v_mul_f32 v173, v173, v24
    v_mul_f32 v174, v174, v24
    v_mul_f32 v175, v175, v24
    v_mul_f32 v176, v176, v24
    v_mul_f32 v177, v177, v24
    v_mul_f32 v178, v178, v24
    v_mul_f32 v179, v179, v24
    v_mul_f32 v180, v180, v24
    v_mul_f32 v181, v181, v24
    v_mul_f32 v182, v182, v24
    v_mul_f32 v183, v183, v24
    v_mul_f32 v184, v184, v24
    v_mul_f32 v185, v185, v24
    v_mul_f32 v186, v186, v24
    v_mul_f32 v187, v187, v24
    v_mul_f32 v188, v188, v24
    v_mul_f32 v189, v189, v24
    v_mul_f32 v190, v190, v24
    v_mul_f32 v191, v191, v24
L_nors_attn_kernel_8:
    ds_read_b128 v[192:195], v3 offset:0
    ds_read_b128 v[196:199], v3 offset:8192
    ds_read_b128 v[200:203], v3 offset:1024
    ds_read_b128 v[204:207], v3 offset:9216
    ds_read_b128 v[208:211], v3 offset:2048
    s_waitcnt lgkmcnt(4)
    v_mfma_f32_32x32x16_bf16 v[64:79], v[192:195], v[32:35], v[228:243]
    s_mov_b32 m0, s48
    v_exp_f32 v96, v96
    v_exp_f32 v97, v97
    ds_read_b128 v[212:215], v3 offset:10240
    s_waitcnt lgkmcnt(4)
    v_mfma_f32_32x32x16_bf16 v[80:95], v[196:199], v[32:35], v[228:243]
    buffer_load_dwordx4 v2, s[8:11], s45 offen offset:0 lds
    v_exp_f32 v98, v98
    v_exp_f32 v99, v99
    v_exp_f32 v100, v100
    ds_read_b128 v[216:219], v3 offset:3072
    s_waitcnt lgkmcnt(4)
    v_mfma_f32_32x32x16_bf16 v[64:79], v[200:203], v[36:39], v[64:79]
    v_exp_f32 v101, v101
    v_exp_f32 v102, v102
    ds_read_b128 v[220:223], v3 offset:11264
    s_waitcnt lgkmcnt(4)
    v_mfma_f32_32x32x16_bf16 v[80:95], v[204:207], v[36:39], v[80:95]
    buffer_load_dwordx4 v2, s[8:11], s45 offen offset:1024 lds
    v_exp_f32 v103, v103
    v_add_f32 v23, v23, v96
    v_add_f32 v23, v23, v97
    ds_read_b128 v[192:195], v3 offset:4096
    s_waitcnt lgkmcnt(4)
    v_mfma_f32_32x32x16_bf16 v[64:79], v[208:211], v[40:43], v[64:79]
    v_add_f32 v23, v23, v98
    v_add_f32 v23, v23, v99
    ds_read_b128 v[196:199], v3 offset:12288
    s_waitcnt lgkmcnt(4)
    v_mfma_f32_32x32x16_bf16 v[80:95], v[212:215], v[40:43], v[80:95]
    buffer_load_dwordx4 v2, s[8:11], s45 offen offset:2048 lds
    v_add_f32 v23, v23, v100
    v_add_f32 v23, v23, v101
    v_add_f32 v23, v23, v102
    ds_read_b128 v[200:203], v3 offset:5120
    s_waitcnt lgkmcnt(4)
    v_mfma_f32_32x32x16_bf16 v[64:79], v[216:219], v[44:47], v[64:79]
    v_add_f32 v23, v23, v103
    v_cvt_pk_bf16_f32 v96, v96, v97
    ds_read_b128 v[204:207], v3 offset:13312
    s_waitcnt lgkmcnt(4)
    v_mfma_f32_32x32x16_bf16 v[80:95], v[220:223], v[44:47], v[80:95]
    buffer_load_dwordx4 v2, s[8:11], s45 offen offset:3072 lds
    v_cvt_pk_bf16_f32 v97, v98, v99
    v_cvt_pk_bf16_f32 v98, v100, v101
    v_cvt_pk_bf16_f32 v99, v102, v103
    ds_read_b128 v[208:211], v3 offset:6144
    s_waitcnt lgkmcnt(4)
    v_mfma_f32_32x32x16_bf16 v[64:79], v[192:195], v[48:51], v[64:79]
    s_mov_b32 m0, s49
    v_exp_f32 v104, v104
    v_exp_f32 v105, v105
    ds_read_b128 v[212:215], v3 offset:14336
    s_waitcnt lgkmcnt(4)
    v_mfma_f32_32x32x16_bf16 v[80:95], v[196:199], v[48:51], v[80:95]
    buffer_load_dwordx4 v2, s[12:15], s46 offen offset:0 lds
    v_exp_f32 v106, v106
    v_exp_f32 v107, v107
    v_exp_f32 v108, v108
    ds_read_b128 v[216:219], v3 offset:7168
    s_waitcnt lgkmcnt(4)
    v_mfma_f32_32x32x16_bf16 v[64:79], v[200:203], v[52:55], v[64:79]
    v_exp_f32 v109, v109
    v_exp_f32 v110, v110
    ds_read_b128 v[220:223], v3 offset:15360
    s_waitcnt lgkmcnt(4)
    v_mfma_f32_32x32x16_bf16 v[80:95], v[204:207], v[52:55], v[80:95]
    buffer_load_dwordx4 v2, s[12:15], s46 offen offset:1024 lds
    v_exp_f32 v111, v111
    v_add_f32 v225, v225, v104
    v_add_f32 v225, v225, v105
    ds_read_b128 v[192:195], v3 offset:49152
    s_waitcnt lgkmcnt(4)
    v_mfma_f32_32x32x16_bf16 v[64:79], v[208:211], v[56:59], v[64:79]
    v_add_f32 v225, v225, v106
    v_add_f32 v225, v225, v107
    ds_read_b128 v[196:199], v3 offset:50176
    s_waitcnt lgkmcnt(4)
    v_mfma_f32_32x32x16_bf16 v[80:95], v[212:215], v[56:59], v[80:95]
    buffer_load_dwordx4 v2, s[12:15], s46 offen offset:2048 lds
    v_add_f32 v225, v225, v108
    v_add_f32 v225, v225, v109
    v_add_f32 v225, v225, v110
    ds_read_b128 v[200:203], v3 offset:51200
    s_waitcnt lgkmcnt(4)
    v_mfma_f32_32x32x16_bf16 v[64:79], v[216:219], v[60:63], v[64:79]
    v_add_f32 v225, v225, v111
    v_cvt_pk_bf16_f32 v104, v104, v105
    ds_read_b128 v[204:207], v3 offset:52224
    s_waitcnt lgkmcnt(4)
    v_mfma_f32_32x32x16_bf16 v[80:95], v[220:223], v[60:63], v[80:95]
    buffer_load_dwordx4 v2, s[12:15], s46 offen offset:3072 lds
    v_cvt_pk_bf16_f32 v105, v106, v107
    v_cvt_pk_bf16_f32 v106, v108, v109
    v_cvt_pk_bf16_f32 v107, v110, v111
    s_add_u32 s45, s45, 32768
    s_xor_b32 s48, s48, 0x4000
    s_add_u32 s46, s46, 32768
    s_xor_b32 s49, s49, 0x4000
    ds_read_b128 v[208:211], v3 offset:53248
    s_waitcnt lgkmcnt(4)
    v_mfma_f32_32x32x16_bf16 v[128:143], v[192:195], v[96:99], v[128:143]
    v_exp_f32 v112, v112
    v_exp_f32 v113, v113
    ds_read_b128 v[212:215], v3 offset:54272
    s_waitcnt lgkmcnt(4)
    v_mfma_f32_32x32x16_bf16 v[144:159], v[196:199], v[96:99], v[144:159]
    v_exp_f32 v114, v114
    v_exp_f32 v115, v115
    v_exp_f32 v116, v116
    ds_read_b128 v[216:219], v3 offset:55296
    s_waitcnt lgkmcnt(4)
    v_mfma_f32_32x32x16_bf16 v[160:175], v[200:203], v[96:99], v[160:175]
    v_exp_f32 v117, v117
    v_exp_f32 v118, v118
    v_exp_f32 v119, v119
    ds_read_b128 v[220:223], v3 offset:56320
    s_waitcnt lgkmcnt(4)
    v_mfma_f32_32x32x16_bf16 v[176:191], v[204:207], v[96:99], v[176:191]
    v_add_f32 v23, v23, v112
    v_add_f32 v23, v23, v113
    v_add_f32 v23, v23, v114
    ds_read_b128 v[192:195], v3 offset:57344
    s_waitcnt lgkmcnt(4)
    v_mfma_f32_32x32x16_bf16 v[128:143], v[208:211], v[104:107], v[128:143]
    v_add_f32 v23, v23, v115
    v_add_f32 v23, v23, v116
    v_add_f32 v23, v23, v117
    ds_read_b128 v[196:199], v3 offset:58368
    s_waitcnt lgkmcnt(4)
    v_mfma_f32_32x32x16_bf16 v[144:159], v[212:215], v[104:107], v[144:159]
    v_add_f32 v23, v23, v118
    v_add_f32 v23, v23, v119
    v_cvt_pk_bf16_f32 v112, v112, v113
    ds_read_b128 v[200:203], v3 offset:59392
    s_waitcnt lgkmcnt(4)
    v_mfma_f32_32x32x16_bf16 v[160:175], v[216:219], v[104:107], v[160:175]
    v_cvt_pk_bf16_f32 v113, v114, v115
    v_cvt_pk_bf16_f32 v114, v116, v117
    v_cvt_pk_bf16_f32 v115, v118, v119
    s_nop 0
    ds_read_b128 v[204:207], v3 offset:60416
    s_waitcnt lgkmcnt(4)
    v_mfma_f32_32x32x16_bf16 v[176:191], v[220:223], v[104:107], v[176:191]
    v_exp_f32 v120, v120
    v_exp_f32 v121, v121
    v_exp_f32 v122, v122
    v_exp_f32 v123, v123
    v_exp_f32 v124, v124
    ds_read_b128 v[208:211], v3 offset:61440
    s_waitcnt lgkmcnt(4)
    v_mfma_f32_32x32x16_bf16 v[128:143], v[192:195], v[112:115], v[128:143]
    v_exp_f32 v125, v125
    v_exp_f32 v126, v126
    v_exp_f32 v127, v127
    v_add_f32 v225, v225, v120
    v_add_f32 v225, v225, v121
    ds_read_b128 v[212:215], v3 offset:62464
    s_waitcnt lgkmcnt(4)
    v_mfma_f32_32x32x16_bf16 v[144:159], v[196:199], v[112:115], v[144:159]
    v_add_f32 v225, v225, v122
    v_add_f32 v225, v225, v123
    v_add_f32 v225, v225, v124
    v_add_f32 v225, v225, v125
    v_add_f32 v225, v225, v126
    ds_read_b128 v[216:219], v3 offset:63488
    s_waitcnt lgkmcnt(4)
    v_mfma_f32_32x32x16_bf16 v[160:175], v[200:203], v[112:115], v[160:175]
    v_add_f32 v225, v225, v127
    v_cvt_pk_bf16_f32 v120, v120, v121
    v_cvt_pk_bf16_f32 v121, v122, v123
    v_cvt_pk_bf16_f32 v122, v124, v125
    v_cvt_pk_bf16_f32 v123, v126, v127
    s_nop 0
    s_cmp_lg_u32 s47, 2
    s_cbranch_scc1 L_nomask_attn_kernel_9
    v_mov_b32 v26, 0xff61b1e6
    v_cmp_le_i32 s[64:65], 0, v25
    v_cmp_le_i32 s[66:67], 1, v25
    v_cmp_le_i32 s[68:69], 2, v25
    v_cmp_le_i32 s[70:71], 3, v25
    s_nop 0
    v_cndmask_b32 v64, v26, v64, s[64:65]
    v_cndmask_b32 v65, v26, v65, s[66:67]
    v_cndmask_b32 v66, v26, v66, s[68:69]
    v_cndmask_b32 v67, v26, v67, s[70:71]
    v_cmp_le_i32 s[64:65], 4, v25
    v_cmp_le_i32 s[66:67], 5, v25
    v_cmp_le_i32 s[68:69], 6, v25
    v_cmp_le_i32 s[70:71], 7, v25
    s_nop 0
    v_cndmask_b32 v68, v26, v68, s[64:65]
    v_cndmask_b32 v69, v26, v69, s[66:67]
    v_cndmask_b32 v70, v26, v70, s[68:69]
    v_cndmask_b32 v71, v26, v71, s[70:71]
    v_cmp_le_i32 s[64:65], 16, v25
    v_cmp_le_i32 s[66:67], 17, v25
    v_cmp_le_i32 s[68:69], 18, v25
    v_cmp_le_i32 s[70:71], 19, v25
    s_nop 0
    v_cndmask_b32 v72, v26, v72, s[64:65]
    v_cndmask_b32 v73, v26, v73, s[66:67]
    v_cndmask_b32 v74, v26, v74, s[68:69]
    v_cndmask_b32 v75, v26, v75, s[70:71]
    v_cmp_le_i32 s[64:65], 20, v25
    v_cmp_le_i32 s[66:67], 21, v25
    v_cmp_le_i32 s[68:69], 22, v25
    v_cmp_le_i32 s[70:71], 23, v25
    s_nop 0
    v_cndmask_b32 v76, v26, v76, s[64:65]
    v_cndmask_b32 v77, v26, v77, s[66:67]
    v_cndmask_b32 v78, v26, v78, s[68:69]
    v_cndmask_b32 v79, v26, v79, s[70:71]
    v_cmp_le_i32 s[64:65], 32, v25
    v_cmp_le_i32 s[66:67], 33, v25
    v_cmp_le_i32 s[68:69], 34, v25
    v_cmp_le_i32 s[70:71], 35, v25
    s_nop 0
    v_cndmask_b32 v80, v26, v80, s[64:65]
    v_cndmask_b32 v81, v26, v81, s[66:67]
    v_cndmask_b32 v82, v26, v82, s[68:69]
    v_cndmask_b32 v83, v26, v83, s[70:71]
    v_cmp_le_i32 s[64:65], 36, v25
    v_cmp_le_i32 s[66:67], 37, v25
    v_cmp_le_i32 s[68:69], 38, v25
    v_cmp_le_i32 s[70:71], 39, v25
    s_nop 0
    v_cndmask_b32 v84, v26, v84, s[64:65]
    v_cndmask_b32 v85, v26, v85, s[66:67]
    v_cndmask_b32 v86, v26, v86, s[68:69]
    v_cndmask_b32 v87, v26, v87, s[70:71]
    v_cmp_le_i32 s[64:65], 48, v25
    v_cmp_le_i32 s[66:67], 49, v25
    v_cmp_le_i32 s[68:69], 50, v25
    v_cmp_le_i32 s[70:71], 51, v25
    s_nop 0
    v_cndmask_b32 v88, v26, v88, s[64:65]
    v_cndmask_b32 v89, v26, v89, s[66:67]
    v_cndmask_b32 v90, v26, v90, s[68:69]
    v_cndmask_b32 v91, v26, v91, s[70:71]
    v_cmp_le_i32 s[64:65], 52, v25
    v_cmp_le_i32 s[66:67], 53, v25
    v_cmp_le_i32 s[68:69], 54, v25
    v_cmp_le_i32 s[70:71], 55, v25
    s_nop 0
    v_cndmask_b32 v92, v26, v92, s[64:65]
    v_cndmask_b32 v93, v26, v93, s[66:67]
    v_cndmask_b32 v94, v26, v94, s[68:69]
    v_cndmask_b32 v95, v26, v95, s[70:71]
L_nomask_attn_kernel_9:
    ds_read_b128 v[220:223], v3 offset:64512
    s_waitcnt lgkmcnt(4)
    v_mfma_f32_32x32x16_bf16 v[176:191], v[204:207], v[112:115], v[176:191]
    v_max3_f32 v31, v64, v65, v66
    v_max3_f32 v31, v31, v67, v68
    v_max3_f32 v31, v31, v69, v70
    s_waitcnt lgkmcnt(3)
    v_mfma_f32_32x32x16_bf16 v[128:143], v[208:211], v[120:123], v[128:143]
    v_max3_f32 v31, v31, v71, v72
    v_max3_f32 v31, v31, v73, v74
    v_max3_f32 v31, v31, v75, v76
    s_waitcnt lgkmcnt(2)
    v_mfma_f32_32x32x16_bf16 v[144:159], v[212:215], v[120:123], v[144:159]
    v_max3_f32 v31, v31, v77, v78
    v_max3_f32 v31, v31, v79, v80
    v_max3_f32 v31, v31, v81, v82
    s_waitcnt lgkmcnt(1)
    v_mfma_f32_32x32x16_bf16 v[160:175], v[216:219], v[120:123], v[160:175]
    v_max3_f32 v31, v31, v83, v84
    v_max3_f32 v31, v31, v85, v86
    v_max3_f32 v31, v31, v87, v88
    s_waitcnt lgkmcnt(0)
    v_mfma_f32_32x32x16_bf16 v[176:191], v[220:223], v[120:123], v[176:191]
    v_max3_f32 v31, v31, v89, v90
    v_max3_f32 v31, v31, v91, v92
    v_max3_f32 v31, v31, v93, v94
    v_max_f32 v31, v31, v95
    v_mov_b32 v27, v31
    s_nop 1
    v_permlane32_swap_b32 v31, v27
    v_max_f32 v31, v31, v27
    v_cmp_lt_f32 vcc, 0x41000000, v31
    s_sub_u32 s47, s47, 1
    s_branch L_attn_loop
L_attn_tail0:
    s_waitcnt vmcnt(0)
    s_barrier
    s_cbranch_vccz L_nors_attn_kernel_10
    s_nop 7
    s_nop 7
    v_max_f32 v31, 0, v31
    v_sub_f32 v24, 0, v31
    v_exp_f32 v24, v24
    v_add_f32 v22, v22, v31
    v_sub_f32 v64, v64, v31
    v_sub_f32 v65, v65, v31
    v_sub_f32 v66, v66, v31
    v_sub_f32 v67, v67, v31
    v_sub_f32 v68, v68, v31
    v_sub_f32 v69, v69, v31
    v_sub_f32 v70, v70, v31
    v_sub_f32 v71, v71, v31
    v_sub_f32 v72, v72, v31
    v_sub_f32 v73, v73, v31
    v_sub_f32 v74, v74, v31
    v_sub_f32 v75, v75, v31
    v_sub_f32 v76, v76, v31
    v_sub_f32 v77, v77, v31
    v_sub_f32 v78, v78, v31
    v_sub_f32 v79, v79, v31
    v_sub_f32 v80, v80, v31
    v_sub_f32 v81, v81, v31
    v_sub_f32 v82, v82, v31
    v_sub_f32 v83, v83, v31
    v_sub_f32 v84, v84, v31
    v_sub_f32 v85, v85, v31
    v_sub_f32 v86, v86, v31
    v_sub_f32 v87, v87, v31
    v_sub_f32 v88, v88, v31
    v_sub_f32 v89, v89, v31
    v_sub_f32 v90, v90, v31
    v_sub_f32 v91, v91, v31
    v_sub_f32 v92, v92, v31
    v_sub_f32 v93, v93, v31
    v_sub_f32 v94, v94, v31
    v_sub_f32 v95, v95, v31
    v_sub_f32 v228, v228, v31
    v_sub_f32 v229, v229, v31
    v_sub_f32 v230, v230, v31
    v_sub_f32 v231, v231, v31
    v_sub_f32 v232, v232, v31
    v_sub_f32 v233, v233, v31
    v_sub_f32 v234, v234, v31
    v_sub_f32 v235, v235, v31
    v_sub_f32 v236, v236, v31
    v_sub_f32 v237, v237, v31
    v_sub_f32 v238, v238, v31
    v_sub_f32 v239, v239, v31
    v_sub_f32 v240, v240, v31
    v_sub_f32 v241, v241, v31
    v_sub_f32 v242, v242, v31
    v_sub_f32 v243, v243, v31
    v_mul_f32 v23, v23, v24
    v_mul_f32 v225, v225, v24
    v_mul_f32 v128, v128, v24
    v_mul_f32 v129, v129, v24
    v_mul_f32 v130, v130, v24
    v_mul_f32 v131, v131, v24
    v_mul_f32 v132, v132, v24
    v_mul_f32 v133, v133, v24
    v_mul_f32 v134, v134, v24
    v_mul_f32 v135, v135, v24
    v_mul_f32 v136, v136, v24
    v_mul_f32 v137, v137, v24
    v_mul_f32 v138, v138, v24
    v_mul_f32 v139, v139, v24
    v_mul_f32 v140, v140, v24
    v_mul_f32 v141, v141, v24
    v_mul_f32 v142, v142, v24
    v_mul_f32 v143, v143, v24
    v_mul_f32 v144, v144, v24
    v_mul_f32 v145, v145, v24
    v_mul_f32 v146, v146, v24
    v_mul_f32 v147, v147, v24
    v_mul_f32 v148, v148, v24
    v_mul_f32 v149, v149, v24
    v_mul_f32 v150, v150, v24
    v_mul_f32 v151, v151, v24
    v_mul_f32 v152, v152, v24
    v_mul_f32 v153, v153, v24
    v_mul_f32 v154, v154, v24
    v_mul_f32 v155, v155, v24
    v_mul_f32 v156, v156, v24
    v_mul_f32 v157, v157, v24
    v_mul_f32 v158, v158, v24
    v_mul_f32 v159, v159, v24
    v_mul_f32 v160, v160, v24
    v_mul_f32 v161, v161, v24
    v_mul_f32 v162, v162, v24
    v_mul_f32 v163, v163, v24
    v_mul_f32 v164, v164, v24
    v_mul_f32 v165, v165, v24
    v_mul_f32 v166, v166, v24
    v_mul_f32 v167, v167, v24
    v_mul_f32 v168, v168, v24
    v_mul_f32 v169, v169, v24
    v_mul_f32 v170, v170, v24
    v_mul_f32 v171, v171, v24
    v_mul_f32 v172, v172, v24
    v_mul_f32 v173, v173, v24
    v_mul_f32 v174, v174, v24
    v_mul_f32 v175, v175, v24
    v_mul_f32 v176, v176, v24
    v_mul_f32 v177, v177, v24
    v_mul_f32 v178, v178, v24
    v_mul_f32 v179, v179, v24
    v_mul_f32 v180, v180, v24
    v_mul_f32 v181, v181, v24
    v_mul_f32 v182, v182, v24
    v_mul_f32 v183, v183, v24
    v_mul_f32 v184, v184, v24
    v_mul_f32 v185, v185, v24
    v_mul_f32 v186, v186, v24
    v_mul_f32 v187, v187, v24
    v_mul_f32 v188, v188, v24
    v_mul_f32 v189, v189, v24
    v_mul_f32 v190, v190, v24
    v_mul_f32 v191, v191, v24
L_nors_attn_kernel_10:
    ds_read_b128 v[192:195], v3 offset:32768
    ds_read_b128 v[196:199], v3 offset:33792
    ds_read_b128 v[200:203], v3 offset:34816
    ds_read_b128 v[204:207], v3 offset:35840
    v_exp_f32 v64, v64
    v_exp_f32 v65, v65
    v_exp_f32 v66, v66
    v_exp_f32 v67, v67
    v_exp_f32 v68, v68
    v_exp_f32 v69, v69
    v_exp_f32 v70, v70
    v_exp_f32 v71, v71
    v_add_f32 v23, v23, v64
    v_add_f32 v23, v23, v65
    v_add_f32 v23, v23, v66
    v_add_f32 v23, v23, v67
    v_add_f32 v23, v23, v68
    v_add_f32 v23, v23, v69
    v_add_f32 v23, v23, v70
    v_add_f32 v23, v23, v71
    v_cvt_pk_bf16_f32 v64, v64, v65
    v_cvt_pk_bf16_f32 v65, v66, v67
    v_cvt_pk_bf16_f32 v66, v68, v69
    v_cvt_pk_bf16_f32 v67, v70, v71
    v_exp_f32 v72, v72
    v_exp_f32 v73, v73
    v_exp_f32 v74, v74
    v_exp_f32 v75, v75
    v_exp_f32 v76, v76
    v_exp_f32 v77, v77
    v_exp_f32 v78, v78
    v_exp_f32 v79, v79
    v_add_f32 v225, v225, v72
    v_add_f32 v225, v225, v73
    v_add_f32 v225, v225, v74
    v_add_f32 v225, v225, v75
    v_add_f32 v225, v225, v76
    v_add_f32 v225, v225, v77
    v_add_f32 v225, v225, v78
    v_add_f32 v225, v225, v79
    v_cvt_pk_bf16_f32 v72, v72, v73
    v_cvt_pk_bf16_f32 v73, v74, v75
    v_cvt_pk_bf16_f32 v74, v76, v77
    v_cvt_pk_bf16_f32 v75, v78, v79
    ds_read_b128 v[208:211], v3 offset:36864
    s_waitcnt lgkmcnt(4)
    v_mfma_f32_32x32x16_bf16 v[128:143], v[192:195], v[64:67], v[128:143]
    v_exp_f32 v80, v80
    v_exp_f32 v81, v81
    ds_read_b128 v[212:215], v3 offset:37888
    s_waitcnt lgkmcnt(4)
    v_mfma_f32_32x32x16_bf16 v[144:159], v[196:199], v[64:67], v[144:159]
    v_exp_f32 v82, v82
    v_exp_f32 v83, v83
    v_exp_f32 v84, v84
    ds_read_b128 v[216:219], v3 offset:38912
    s_waitcnt lgkmcnt(4)
    v_mfma_f32_32x32x16_bf16 v[160:175], v[200:203], v[64:67], v[160:175]
    v_exp_f32 v85, v85
    v_exp_f32 v86, v86
    v_exp_f32 v87, v87
    ds_read_b128 v[220:223], v3 offset:39936
    s_waitcnt lgkmcnt(4)
    v_mfma_f32_32x32x16_bf16 v[176:191], v[204:207], v[64:67], v[176:191]
    v_add_f32 v23, v23, v80
    v_add_f32 v23, v23, v81
    v_add_f32 v23, v23, v82
    ds_read_b128 v[192:195], v3 offset:40960
    s_waitcnt lgkmcnt(4)
    v_mfma_f32_32x32x16_bf16 v[128:143], v[208:211], v[72:75], v[128:143]
    v_add_f32 v23, v23, v83
    v_add_f32 v23, v23, v84
    v_add_f32 v23, v23, v85
    ds_read_b128 v[196:199], v3 offset:41984
    s_waitcnt lgkmcnt(4)
    v_mfma_f32_32x32x16_bf16 v[144:159], v[212:215], v[72:75], v[144:159]
    v_add_f32 v23, v23, v86
    v_add_f32 v23, v23, v87
    v_cvt_pk_bf16_f32 v80, v80, v81
    ds_read_b128 v[200:203], v3 offset:43008
    s_waitcnt lgkmcnt(4)
    v_mfma_f32_32x32x16_bf16 v[160:175], v[216:219], v[72:75], v[160:175]
    v_cvt_pk_bf16_f32 v81, v82, v83
    v_cvt_pk_bf16_f32 v82, v84, v85
    v_cvt_pk_bf16_f32 v83, v86, v87
    s_nop 0
    ds_read_b128 v[204:207], v3 offset:44032
    s_waitcnt lgkmcnt(4)
    v_mfma_f32_32x32x16_bf16 v[176:191], v[220:223], v[72:75], v[176:191]
    v_exp_f32 v88, v88
    v_exp_f32 v89, v89
    v_exp_f32 v90, v90
    v_exp_f32 v91, v91
    v_exp_f32 v92, v92
    ds_read_b128 v[208:211], v3 offset:45056
    s_waitcnt lgkmcnt(4)
    v_mfma_f32_32x32x16_bf16 v[128:143], v[192:195], v[80:83], v[128:143]
    v_exp_f32 v93, v93
    v_exp_f32 v94, v94
    v_exp_f32 v95, v95
    v_add_f32 v225, v225, v88
    v_add_f32 v225, v225, v89
    ds_read_b128 v[212:215], v3 offset:46080
    s_waitcnt lgkmcnt(4)
    v_mfma_f32_32x32x16_bf16 v[144:159], v[196:199], v[80:83], v[144:159]
    v_add_f32 v225, v225, v90
    v_add_f32 v225, v225, v91
    v_add_f32 v225, v225, v92
    v_add_f32 v225, v225, v93
    v_add_f32 v225, v225, v94
    ds_read_b128 v[216:219], v3 offset:47104
    s_waitcnt lgkmcnt(4)
    v_mfma_f32_32x32x16_bf16 v[160:175], v[200:203], v[80:83], v[160:175]
    v_add_f32 v225, v225, v95
    v_cvt_pk_bf16_f32 v88, v88, v89
    v_cvt_pk_bf16_f32 v89, v90, v91
    v_cvt_pk_bf16_f32 v90, v92, v93
    v_cvt_pk_bf16_f32 v91, v94, v95
    s_nop 0
    ds_read_b128 v[220:223], v3 offset:48128
    s_waitcnt lgkmcnt(4)
    v_mfma_f32_32x32x16_bf16 v[176:191], v[204:207], v[80:83], v[176:191]
    s_waitcnt lgkmcnt(3)
    v_mfma_f32_32x32x16_bf16 v[128:143], v[208:211], v[88:91], v[128:143]
    s_waitcnt lgkmcnt(2)
    v_mfma_f32_32x32x16_bf16 v[144:159], v[212:215], v[88:91], v[144:159]
    s_waitcnt lgkmcnt(1)
    v_mfma_f32_32x32x16_bf16 v[160:175], v[216:219], v[88:91], v[160:175]
    s_waitcnt lgkmcnt(0)
    v_mfma_f32_32x32x16_bf16 v[176:191], v[220:223], v[88:91], v[176:191]
    s_sub_u32 s47, s47, 1
    s_branch L_attn_merge
L_attn_tail1:
    s_waitcnt vmcnt(0)
    s_barrier
    s_cbranch_vccz L_nors_attn_kernel_11
    s_nop 7
    s_nop 7
    v_max_f32 v31, 0, v31
    v_sub_f32 v24, 0, v31
    v_exp_f32 v24, v24
    v_add_f32 v22, v22, v31
    v_sub_f32 v96, v96, v31
    v_sub_f32 v97, v97, v31
    v_sub_f32 v98, v98, v31
    v_sub_f32 v99, v99, v31
    v_sub_f32 v100, v100, v31
    v_sub_f32 v101, v101, v31
    v_sub_f32 v102, v102, v31
    v_sub_f32 v103, v103, v31
    v_sub_f32 v104, v104, v31
    v_sub_f32 v105, v105, v31
    v_sub_f32 v106, v106, v31
    v_sub_f32 v107, v107, v31
    v_sub_f32 v108, v108, v31
    v_sub_f32 v109, v109, v31
    v_sub_f32 v110, v110, v31
    v_sub_f32 v111, v111, v31
    v_sub_f32 v112, v112, v31
    v_sub_f32 v113, v113, v31
    v_sub_f32 v114, v114, v31
    v_sub_f32 v115, v115, v31
    v_sub_f32 v116, v116, v31
    v_sub_f32 v117, v117, v31
    v_sub_f32 v118, v118, v31
    v_sub_f32 v119, v119, v31
    v_sub_f32 v120, v120, v31
    v_sub_f32 v121, v121, v31
    v_sub_f32 v122, v122, v31
    v_sub_f32 v123, v123, v31
    v_sub_f32 v124, v124, v31
    v_sub_f32 v125, v125, v31
    v_sub_f32 v126, v126, v31
    v_sub_f32 v127, v127, v31
    v_sub_f32 v228, v228, v31
    v_sub_f32 v229, v229, v31
    v_sub_f32 v230, v230, v31
    v_sub_f32 v231, v231, v31
    v_sub_f32 v232, v232, v31
    v_sub_f32 v233, v233, v31
    v_sub_f32 v234, v234, v31
    v_sub_f32 v235, v235, v31
    v_sub_f32 v236, v236, v31
    v_sub_f32 v237, v237, v31
    v_sub_f32 v238, v238, v31
    v_sub_f32 v239, v239, v31
    v_sub_f32 v240, v240, v31
    v_sub_f32 v241, v241, v31
    v_sub_f32 v242, v242, v31
    v_sub_f32 v243, v243, v31
    v_mul_f32 v23, v23, v24
    v_mul_f32 v225, v225, v24
    v_mul_f32 v128, v128, v24
    v_mul_f32 v129, v129, v24
    v_mul_f32 v130, v130, v24
    v_mul_f32 v131, v131, v24
    v_mul_f32 v132, v132, v24
    v_mul_f32 v133, v133, v24
    v_mul_f32 v134, v134, v24
    v_mul_f32 v135, v135, v24
    v_mul_f32 v136, v136, v24
    v_mul_f32 v137, v137, v24
    v_mul_f32 v138, v138, v24
    v_mul_f32 v139, v139, v24
    v_mul_f32 v140, v140, v24
    v_mul_f32 v141, v141, v24
    v_mul_f32 v142, v142, v24
    v_mul_f32 v143, v143, v24
    v_mul_f32 v144, v144, v24
    v_mul_f32 v145, v145, v24
    v_mul_f32 v146, v146, v24
    v_mul_f32 v147, v147, v24
    v_mul_f32 v148, v148, v24
    v_mul_f32 v149, v149, v24
    v_mul_f32 v150, v150, v24
    v_mul_f32 v151, v151, v24
    v_mul_f32 v152, v152, v24
    v_mul_f32 v153, v153, v24
    v_mul_f32 v154, v154, v24
    v_mul_f32 v155, v155, v24
    v_mul_f32 v156, v156, v24
    v_mul_f32 v157, v157, v24
    v_mul_f32 v158, v158, v24
    v_mul_f32 v159, v159, v24
    v_mul_f32 v160, v160, v24
    v_mul_f32 v161, v161, v24
    v_mul_f32 v162, v162, v24
    v_mul_f32 v163, v163, v24
    v_mul_f32 v164, v164, v24
    v_mul_f32 v165, v165, v24
    v_mul_f32 v166, v166, v24
    v_mul_f32 v167, v167, v24
    v_mul_f32 v168, v168, v24
    v_mul_f32 v169, v169, v24
    v_mul_f32 v170, v170, v24
    v_mul_f32 v171, v171, v24
    v_mul_f32 v172, v172, v24
    v_mul_f32 v173, v173, v24
    v_mul_f32 v174, v174, v24
    v_mul_f32 v175, v175, v24
    v_mul_f32 v176, v176, v24
    v_mul_f32 v177, v177, v24
    v_mul_f32 v178, v178, v24
    v_mul_f32 v179, v179, v24
    v_mul_f32 v180, v180, v24
    v_mul_f32 v181, v181, v24
    v_mul_f32 v182, v182, v24
    v_mul_f32 v183, v183, v24
    v_mul_f32 v184, v184, v24
    v_mul_f32 v185, v185, v24
    v_mul_f32 v186, v186, v24
    v_mul_f32 v187, v187, v24
    v_mul_f32 v188, v188, v24
    v_mul_f32 v189, v189, v24
    v_mul_f32 v190, v190, v24
    v_mul_f32 v191, v191, v24
L_nors_attn_kernel_11:
    ds_read_b128 v[192:195], v3 offset:49152
    ds_read_b128 v[196:199], v3 offset:50176
    ds_read_b128 v[200:203], v3 offset:51200
    ds_read_b128 v[204:207], v3 offset:52224
    v_exp_f32 v96, v96
    v_exp_f32 v97, v97
    v_exp_f32 v98, v98
    v_exp_f32 v99, v99
    v_exp_f32 v100, v100
    v_exp_f32 v101, v101
    v_exp_f32 v102, v102
    v_exp_f32 v103, v103
    v_add_f32 v23, v23, v96
    v_add_f32 v23, v23, v97
    v_add_f32 v23, v23, v98
    v_add_f32 v23, v23, v99
    v_add_f32 v23, v23, v100
    v_add_f32 v23, v23, v101
    v_add_f32 v23, v23, v102
    v_add_f32 v23, v23, v103
    v_cvt_pk_bf16_f32 v96, v96, v97
    v_cvt_pk_bf16_f32 v97, v98, v99
    v_cvt_pk_bf16_f32 v98, v100, v101
    v_cvt_pk_bf16_f32 v99, v102, v103
    v_exp_f32 v104, v104
    v_exp_f32 v105, v105
    v_exp_f32 v106, v106
    v_exp_f32 v107, v107
    v_exp_f32 v108, v108
    v_exp_f32 v109, v109
    v_exp_f32 v110, v110
    v_exp_f32 v111, v111
    v_add_f32 v225, v225, v104
    v_add_f32 v225, v225, v105
    v_add_f32 v225, v225, v106
    v_add_f32 v225, v225, v107
    v_add_f32 v225, v225, v108
    v_add_f32 v225, v225, v109
    v_add_f32 v225, v225, v110
    v_add_f32 v225, v225, v111
    v_cvt_pk_bf16_f32 v104, v104, v105
    v_cvt_pk_bf16_f32 v105, v106, v107
    v_cvt_pk_bf16_f32 v106, v108, v109
    v_cvt_pk_bf16_f32 v107, v110, v111
    ds_read_b128 v[208:211], v3 offset:53248
    s_waitcnt lgkmcnt(4)
    v_mfma_f32_32x32x16_bf16 v[128:143], v[192:195], v[96:99], v[128:143]
    v_exp_f32 v112, v112
    v_exp_f32 v113, v113
    ds_read_b128 v[212:215], v3 offset:54272
    s_waitcnt lgkmcnt(4)
    v_mfma_f32_32x32x16_bf16 v[144:159], v[196:199], v[96:99], v[144:159]
    v_exp_f32 v114, v114
    v_exp_f32 v115, v115
    v_exp_f32 v116, v116
    ds_read_b128 v[216:219], v3 offset:55296
    s_waitcnt lgkmcnt(4)
    v_mfma_f32_32x32x16_bf16 v[160:175], v[200:203], v[96:99], v[160:175]
    v_exp_f32 v117, v117
    v_exp_f32 v118, v118
    v_exp_f32 v119, v119
    ds_read_b128 v[220:223], v3 offset:56320
    s_waitcnt lgkmcnt(4)
    v_mfma_f32_32x32x16_bf16 v[176:191], v[204:207], v[96:99], v[176:191]
    v_add_f32 v23, v23, v112
    v_add_f32 v23, v23, v113
    v_add_f32 v23, v23, v114
    ds_read_b128 v[192:195], v3 offset:57344
    s_waitcnt lgkmcnt(4)
    v_mfma_f32_32x32x16_bf16 v[128:143], v[208:211], v[104:107], v[128:143]
    v_add_f32 v23, v23, v115
    v_add_f32 v23, v23, v116
    v_add_f32 v23, v23, v117
    ds_read_b128 v[196:199], v3 offset:58368
    s_waitcnt lgkmcnt(4)
    v_mfma_f32_32x32x16_bf16 v[144:159], v[212:215], v[104:107], v[144:159]
    v_add_f32 v23, v23, v118
    v_add_f32 v23, v23, v119
    v_cvt_pk_bf16_f32 v112, v112, v113
    ds_read_b128 v[200:203], v3 offset:59392
    s_waitcnt lgkmcnt(4)
    v_mfma_f32_32x32x16_bf16 v[160:175], v[216:219], v[104:107], v[160:175]
    v_cvt_pk_bf16_f32 v113, v114, v115
    v_cvt_pk_bf16_f32 v114, v116, v117
    v_cvt_pk_bf16_f32 v115, v118, v119
    s_nop 0
    ds_read_b128 v[204:207], v3 offset:60416
    s_waitcnt lgkmcnt(4)
    v_mfma_f32_32x32x16_bf16 v[176:191], v[220:223], v[104:107], v[176:191]
    v_exp_f32 v120, v120
    v_exp_f32 v121, v121
    v_exp_f32 v122, v122
    v_exp_f32 v123, v123
    v_exp_f32 v124, v124
    ds_read_b128 v[208:211], v3 offset:61440
    s_waitcnt lgkmcnt(4)
    v_mfma_f32_32x32x16_bf16 v[128:143], v[192:195], v[112:115], v[128:143]
    v_exp_f32 v125, v125
    v_exp_f32 v126, v126
    v_exp_f32 v127, v127
    v_add_f32 v225, v225, v120
    v_add_f32 v225, v225, v121
    ds_read_b128 v[212:215], v3 offset:62464
    s_waitcnt lgkmcnt(4)
    v_mfma_f32_32x32x16_bf16 v[144:159], v[196:199], v[112:115], v[144:159]
    v_add_f32 v225, v225, v122
    v_add_f32 v225, v225, v123
    v_add_f32 v225, v225, v124
    v_add_f32 v225, v225, v125
    v_add_f32 v225, v225, v126
    ds_read_b128 v[216:219], v3 offset:63488
    s_waitcnt lgkmcnt(4)
    v_mfma_f32_32x32x16_bf16 v[160:175], v[200:203], v[112:115], v[160:175]
    v_add_f32 v225, v225, v127
    v_cvt_pk_bf16_f32 v120, v120, v121
    v_cvt_pk_bf16_f32 v121, v122, v123
    v_cvt_pk_bf16_f32 v122, v124, v125
    v_cvt_pk_bf16_f32 v123, v126, v127
    s_nop 0
    ds_read_b128 v[220:223], v3 offset:64512
    s_waitcnt lgkmcnt(4)
    v_mfma_f32_32x32x16_bf16 v[176:191], v[204:207], v[112:115], v[176:191]
    s_waitcnt lgkmcnt(3)
    v_mfma_f32_32x32x16_bf16 v[128:143], v[208:211], v[120:123], v[128:143]
    s_waitcnt lgkmcnt(2)
    v_mfma_f32_32x32x16_bf16 v[144:159], v[212:215], v[120:123], v[144:159]
    s_waitcnt lgkmcnt(1)
    v_mfma_f32_32x32x16_bf16 v[160:175], v[216:219], v[120:123], v[160:175]
    s_waitcnt lgkmcnt(0)
    v_mfma_f32_32x32x16_bf16 v[176:191], v[220:223], v[120:123], v[176:191]
    s_sub_u32 s47, s47, 1
L_attn_merge:
    v_add_f32 v23, v23, v225
    s_nop 7
    s_nop 7
    s_barrier
    s_mul_i32 s50, s40, 8704
    s_xor_b32 s51, s40, 4
    s_mul_i32 s51, s51, 8704
    v_lshlrev_b32 v26, 4, v1
    v_lshlrev_b32 v27, 3, v1
    v_add_u32 v28, s50, v26
    v_add_u32 v29, s50, v27
    v_add_u32 v26, s51, v26
    v_add_u32 v27, s51, v27
    ds_write_b64 v29, v[22:23] offset:8192
    s_cmp_eq_u32 s43, 0
    s_cbranch_scc1 L_attn_w0
    ds_write_b128 v28, v[128:131] offset:0
    ds_write_b128 v28, v[132:135] offset:1024
    ds_write_b128 v28, v[136:139] offset:2048
    ds_write_b128 v28, v[140:143] offset:3072
    ds_write_b128 v28, v[144:147] offset:4096
    ds_write_b128 v28, v[148:151] offset:5120
    ds_write_b128 v28, v[152:155] offset:6144
    ds_write_b128 v28, v[156:159] offset:7168
    s_branch L_attn_w1
L_attn_w0:
    ds_write_b128 v28, v[160:163] offset:0
    ds_write_b128 v28, v[164:167] offset:1024
    ds_write_b128 v28, v[168:171] offset:2048
    ds_write_b128 v28, v[172:175] offset:3072
    ds_write_b128 v28, v[176:179] offset:4096
    ds_write_b128 v28, v[180:183] offset:5120
    ds_write_b128 v28, v[184:187] offset:6144
    ds_write_b128 v28, v[188:191] offset:7168
L_attn_w1:
    s_waitcnt lgkmcnt(0)
    s_barrier
    ds_read_b64 v[28:29], v27 offset:8192
    ds_read_b128 v[64:67], v26 offset:0
    ds_read_b128 v[68:71], v26 offset:1024
    ds_read_b128 v[72:75], v26 offset:2048
    ds_read_b128 v[76:79], v26 offset:3072
    ds_read_b128 v[80:83], v26 offset:4096
    ds_read_b128 v[84:87], v26 offset:5120
    ds_read_b128 v[88:91], v26 offset:6144
    ds_read_b128 v[92:95], v26 offset:7168
    s_waitcnt lgkmcnt(0)
    s_barrier
    s_nop 0
    s_cmp_eq_u32 s33, 1
    s_cbranch_scc1 L_attn_nonext
    s_mov_b32 s32, s42
    s_lshl_b32 s56, s41, 6
    s_lshl_b32 s50, s32, 2
    s_add_u32 s56, s56, s50
    s_add_u32 s56, s56, s44
    s_lshl_b32 s57, s32, 2
    s_add_u32 s57, s57, s44
    s_lshl_b32 s56, s56, 13
    s_lshl_b32 s45, s41, 19
    s_lshl_b32 s50, s43, 14
    s_add_u32 s45, s45, s50
    s_mov_b32 s46, s45
    s_lshl_b32 s48, s43, 16
    s_lshl_b32 s50, s44, 12
    s_add_u32 s48, s48, s50
    s_add_u32 s49, s48, 32768
    s_mov_b32 m0, s48
    s_nop 0
    buffer_load_dwordx4 v2, s[8:11], s45 offen offset:0 lds
    buffer_load_dwordx4 v2, s[8:11], s45 offen offset:1024 lds
    buffer_load_dwordx4 v2, s[8:11], s45 offen offset:2048 lds
    buffer_load_dwordx4 v2, s[8:11], s45 offen offset:3072 lds
    s_add_u32 s45, s45, 32768
    s_xor_b32 s48, s48, 0x4000
    buffer_load_dwordx4 v[32:35], v4, s[4:7], s56 offen offset:0
    buffer_load_dwordx4 v[36:39], v4, s[4:7], s56 offen offset:1024
    buffer_load_dwordx4 v[40:43], v4, s[4:7], s56 offen offset:2048
    buffer_load_dwordx4 v[44:47], v4, s[4:7], s56 offen offset:3072
    s_add_u32 s50, s56, 4096
    buffer_load_dwordx4 v[48:51], v4, s[4:7], s50 offen offset:0
    buffer_load_dwordx4 v[52:55], v4, s[4:7], s50 offen offset:1024
    buffer_load_dwordx4 v[56:59], v4, s[4:7], s50 offen offset:2048
    buffer_load_dwordx4 v[60:63], v4, s[4:7], s50 offen offset:3072
    s_mov_b32 m0, s49
    s_nop 0
    buffer_load_dwordx4 v2, s[12:15], s46 offen offset:0 lds
    buffer_load_dwordx4 v2, s[12:15], s46 offen offset:1024 lds
    buffer_load_dwordx4 v2, s[12:15], s46 offen offset:2048 lds
    buffer_load_dwordx4 v2, s[12:15], s46 offen offset:3072 lds
    s_add_u32 s46, s46, 32768
    s_xor_b32 s49, s49, 0x4000
    s_mov_b32 m0, s48
    s_nop 0
    buffer_load_dwordx4 v2, s[8:11], s45 offen offset:0 lds
    buffer_load_dwordx4 v2, s[8:11], s45 offen offset:1024 lds
    buffer_load_dwordx4 v2, s[8:11], s45 offen offset:2048 lds
    buffer_load_dwordx4 v2, s[8:11], s45 offen offset:3072 lds
    s_add_u32 s45, s45, 32768
    s_xor_b32 s48, s48, 0x4000
L_attn_nonext:
    v_max_f32 v31, v22, v28
    v_sub_f32 v24, v22, v31
    v_sub_f32 v28, v28, v31
    v_exp_f32 v24, v24
    v_exp_f32 v28, v28
    s_nop 0
    v_mul_f32 v23, v23, v24
    v_fma_f32 v23, v29, v28, v23
    v_mov_b32 v29, v23
    s_nop 1
    v_permlane32_swap_b32 v23, v29
    v_add_f32 v23, v23, v29
    v_rcp_f32 v23, v23
    s_nop 0
    v_mul_f32 v24, v24, v23
    v_mul_f32 v28, v28, v23
    s_cmp_eq_u32 s43, 0
    s_cbranch_scc1 L_attn_c0
    v_mul_f32 v160, v160, v24
    v_fma_f32 v160, v64, v28, v160
    v_mul_f32 v161, v161, v24
    v_fma_f32 v161, v65, v28, v161
    v_mul_f32 v162, v162, v24
    v_fma_f32 v162, v66, v28, v162
    v_mul_f32 v163, v163, v24
    v_fma_f32 v163, v67, v28, v163
    v_mul_f32 v164, v164, v24
    v_fma_f32 v164, v68, v28, v164
    v_mul_f32 v165, v165, v24
    v_fma_f32 v165, v69, v28, v165
    v_mul_f32 v166, v166, v24
    v_fma_f32 v166, v70, v28, v166
    v_mul_f32 v167, v167, v24
    v_fma_f32 v167, v71, v28, v167
    v_mul_f32 v168, v168, v24
    v_fma_f32 v168, v72, v28, v168
    v_mul_f32 v169, v169, v24
    v_fma_f32 v169, v73, v28, v169
    v_mul_f32 v170, v170, v24
    v_fma_f32 v170, v74, v28, v170
    v_mul_f32 v171, v171, v24
    v_fma_f32 v171, v75, v28, v171
    v_mul_f32 v172, v172, v24
    v_fma_f32 v172, v76, v28, v172
    v_mul_f32 v173, v173, v24
    v_fma_f32 v173, v77, v28, v173
    v_mul_f32 v174, v174, v24
    v_fma_f32 v174, v78, v28, v174
    v_mul_f32 v175, v175, v24
    v_fma_f32 v175, v79, v28, v175
    v_mul_f32 v176, v176, v24
    v_fma_f32 v176, v80, v28, v176
    v_mul_f32 v177, v177, v24
    v_fma_f32 v177, v81, v28, v177
    v_mul_f32 v178, v178, v24
    v_fma_f32 v178, v82, v28, v178
    v_mul_f32 v179, v179, v24
    v_fma_f32 v179, v83, v28, v179
    v_mul_f32 v180, v180, v24
    v_fma_f32 v180, v84, v28, v180
    v_mul_f32 v181, v181, v24
    v_fma_f32 v181, v85, v28, v181
    v_mul_f32 v182, v182, v24
    v_fma_f32 v182, v86, v28, v182
    v_mul_f32 v183, v183, v24
    v_fma_f32 v183, v87, v28, v183
    v_mul_f32 v184, v184, v24
    v_fma_f32 v184, v88, v28, v184
    v_mul_f32 v185, v185, v24
    v_fma_f32 v185, v89, v28, v185
    v_mul_f32 v186, v186, v24
    v_fma_f32 v186, v90, v28, v186
    v_mul_f32 v187, v187, v24
    v_fma_f32 v187, v91, v28, v187
    v_mul_f32 v188, v188, v24
    v_fma_f32 v188, v92, v28, v188
    v_mul_f32 v189, v189, v24
    v_fma_f32 v189, v93, v28, v189
    v_mul_f32 v190, v190, v24
    v_fma_f32 v190, v94, v28, v190
    v_mul_f32 v191, v191, v24
    v_fma_f32 v191, v95, v28, v191
    v_cvt_pk_bf16_f32 v160, v160, v161
    v_cvt_pk_bf16_f32 v161, v162, v163
    v_cvt_pk_bf16_f32 v162, v164, v165
    v_cvt_pk_bf16_f32 v163, v166, v167
    v_cvt_pk_bf16_f32 v168, v168, v169
    v_cvt_pk_bf16_f32 v169, v170, v171
    v_cvt_pk_bf16_f32 v170, v172, v173
    v_cvt_pk_bf16_f32 v171, v174, v175
    s_lshl_b32 s50, s58, 18
    s_lshl_b32 s51, s41, 13
    s_add_u32 s50, s50, s51
    s_add_u32 s50, s50, 4096
    v_permlane32_swap_b32 v160, v162
    v_permlane32_swap_b32 v161, v163
    v_permlane32_swap_b32 v168, v170
    v_permlane32_swap_b32 v169, v171
    buffer_store_dwordx4 v[160:163], v4, s[16:19], s50 offen offset:0
    buffer_store_dwordx4 v[168:171], v4, s[16:19], s50 offen offset:1024
    v_cvt_pk_bf16_f32 v176, v176, v177
    v_cvt_pk_bf16_f32 v177, v178, v179
    v_cvt_pk_bf16_f32 v178, v180, v181
    v_cvt_pk_bf16_f32 v179, v182, v183
    v_cvt_pk_bf16_f32 v184, v184, v185
    v_cvt_pk_bf16_f32 v185, v186, v187
    v_cvt_pk_bf16_f32 v186, v188, v189
    v_cvt_pk_bf16_f32 v187, v190, v191
    s_lshl_b32 s50, s58, 18
    s_lshl_b32 s51, s41, 13
    s_add_u32 s50, s50, s51
    s_add_u32 s50, s50, 6144
    v_permlane32_swap_b32 v176, v178
    v_permlane32_swap_b32 v177, v179
    v_permlane32_swap_b32 v184, v186
    v_permlane32_swap_b32 v185, v187
    buffer_store_dwordx4 v[176:179], v4, s[16:19], s50 offen offset:0
    buffer_store_dwordx4 v[184:187], v4, s[16:19], s50 offen offset:1024
    s_branch L_attn_c1
L_attn_c0:
    v_mul_f32 v128, v128, v24
    v_fma_f32 v128, v64, v28, v128
    v_mul_f32 v129, v129, v24
    v_fma_f32 v129, v65, v28, v129
    v_mul_f32 v130, v130, v24
    v_fma_f32 v130, v66, v28, v130
    v_mul_f32 v131, v131, v24
    v_fma_f32 v131, v67, v28, v131
    v_mul_f32 v132, v132, v24
    v_fma_f32 v132, v68, v28, v132
    v_mul_f32 v133, v133, v24
    v_fma_f32 v133, v69, v28, v133
    v_mul_f32 v134, v134, v24
    v_fma_f32 v134, v70, v28, v134
    v_mul_f32 v135, v135, v24
    v_fma_f32 v135, v71, v28, v135
    v_mul_f32 v136, v136, v24
    v_fma_f32 v136, v72, v28, v136
    v_mul_f32 v137, v137, v24
    v_fma_f32 v137, v73, v28, v137
    v_mul_f32 v138, v138, v24
    v_fma_f32 v138, v74, v28, v138
    v_mul_f32 v139, v139, v24
    v_fma_f32 v139, v75, v28, v139
    v_mul_f32 v140, v140, v24
    v_fma_f32 v140, v76, v28, v140
    v_mul_f32 v141, v141, v24
    v_fma_f32 v141, v77, v28, v141
    v_mul_f32 v142, v142, v24
    v_fma_f32 v142, v78, v28, v142
    v_mul_f32 v143, v143, v24
    v_fma_f32 v143, v79, v28, v143
    v_mul_f32 v144, v144, v24
    v_fma_f32 v144, v80, v28, v144
    v_mul_f32 v145, v145, v24
    v_fma_f32 v145, v81, v28, v145
    v_mul_f32 v146, v146, v24
    v_fma_f32 v146, v82, v28, v146
    v_mul_f32 v147, v147, v24
    v_fma_f32 v147, v83, v28, v147
    v_mul_f32 v148, v148, v24
    v_fma_f32 v148, v84, v28, v148
    v_mul_f32 v149, v149, v24
    v_fma_f32 v149, v85, v28, v149
    v_mul_f32 v150, v150, v24
    v_fma_f32 v150, v86, v28, v150
    v_mul_f32 v151, v151, v24
    v_fma_f32 v151, v87, v28, v151
    v_mul_f32 v152, v152, v24
    v_fma_f32 v152, v88, v28, v152
    v_mul_f32 v153, v153, v24
    v_fma_f32 v153, v89, v28, v153
    v_mul_f32 v154, v154, v24
    v_fma_f32 v154, v90, v28, v154
    v_mul_f32 v155, v155, v24
    v_fma_f32 v155, v91, v28, v155
    v_mul_f32 v156, v156, v24
    v_fma_f32 v156, v92, v28, v156
    v_mul_f32 v157, v157, v24
    v_fma_f32 v157, v93, v28, v157
    v_mul_f32 v158, v158, v24
    v_fma_f32 v158, v94, v28, v158
    v_mul_f32 v159, v159, v24
    v_fma_f32 v159, v95, v28, v159
    v_cvt_pk_bf16_f32 v128, v128, v129
    v_cvt_pk_bf16_f32 v129, v130, v131
    v_cvt_pk_bf16_f32 v130, v132, v133
    v_cvt_pk_bf16_f32 v131, v134, v135
    v_cvt_pk_bf16_f32 v136, v136, v137
    v_cvt_pk_bf16_f32 v137, v138, v139
    v_cvt_pk_bf16_f32 v138, v140, v141
    v_cvt_pk_bf16_f32 v139, v142, v143
    s_lshl_b32 s50, s58, 18
    s_lshl_b32 s51, s41, 13
    s_add_u32 s50, s50, s51
    s_add_u32 s50, s50, 0
    v_permlane32_swap_b32 v128, v130
    v_permlane32_swap_b32 v129, v131
    v_permlane32_swap_b32 v136, v138
    v_permlane32_swap_b32 v137, v139
    buffer_store_dwordx4 v[128:131], v4, s[16:19], s50 offen offset:0
    buffer_store_dwordx4 v[136:139], v4, s[16:19], s50 offen offset:1024
    v_cvt_pk_bf16_f32 v144, v144, v145
    v_cvt_pk_bf16_f32 v145, v146, v147
    v_cvt_pk_bf16_f32 v146, v148, v149
    v_cvt_pk_bf16_f32 v147, v150, v151
    v_cvt_pk_bf16_f32 v152, v152, v153
    v_cvt_pk_bf16_f32 v153, v154, v155
    v_cvt_pk_bf16_f32 v154, v156, v157
    v_cvt_pk_bf16_f32 v155, v158, v159
    s_lshl_b32 s50, s58, 18
    s_lshl_b32 s51, s41, 13
    s_add_u32 s50, s50, s51
    s_add_u32 s50, s50, 2048
    v_permlane32_swap_b32 v144, v146
    v_permlane32_swap_b32 v145, v147
    v_permlane32_swap_b32 v152, v154
    v_permlane32_swap_b32 v153, v155
    buffer_store_dwordx4 v[144:147], v4, s[16:19], s50 offen offset:0
    buffer_store_dwordx4 v[152:155], v4, s[16:19], s50 offen offset:1024
L_attn_c1:
    s_cmp_eq_u32 s33, 1
    s_cbranch_scc1 L_attn_end
    s_mov_b32 s33, 1
    s_branch L_attn_qblock
L_attn_end:
    s_endpgm
.section .rodata,"a"
.p2align 6
.amdhsa_kernel attn_kernel
  .amdhsa_next_free_vgpr 256
  .amdhsa_next_free_sgpr 100
  .amdhsa_accum_offset 256
  .amdhsa_group_segment_fixed_size 0
  .amdhsa_kernarg_size 96
  .amdhsa_user_sgpr_count 2
  .amdhsa_user_sgpr_kernarg_segment_ptr 1
  .amdhsa_system_sgpr_workgroup_id_x 1
.end_amdhsa_kernel
.text

.globl oproj_kernel
.p2align 8
.type oproj_kernel,@function
oproj_kernel:
    s_cmp_ge_u32 s2, 256
    s_cbranch_scc1 L_op_end
    s_cmp_ge_u32 s2, 192
    s_cbranch_scc1 L_op_b3
    s_load_dwordx2 s[24:25], s[0:1], 40
    s_load_dwordx2 s[26:27], s[0:1], 72
    s_load_dwordx2 s[28:29], s[0:1], 88
    v_and_b32 v1, 63, v0
    v_lshrrev_b32 v16, 6, v0
    s_nop 1
    v_readfirstlane_b32 s40, v16
    s_lshr_b32 s50, s2, 3
    s_mul_i32 s51, s50, 43
    s_lshr_b32 s51, s51, 8
    s_mul_i32 s52, s51, 6
    s_sub_u32 s42, s50, s52
    s_and_b32 s41, s2, 7
    s_lshl_b32 s41, s41, 2
    s_add_u32 s41, s41, s51
    s_waitcnt lgkmcnt(0)
    s_add_u32 s4, s28, 50331648
    s_addc_u32 s5, s29, 0
    s_and_b32 s5, s5, 0xffff
    s_mov_b32 s6, 16777216
    s_mov_b32 s7, 0x00020000
    s_mov_b32 s8, s24
    s_and_b32 s9, s25, 0xffff
    s_mov_b32 s10, 4718592
    s_mov_b32 s11, 0x00020000
    s_mov_b32 s12, s26
    s_and_b32 s13, s27, 0xffff
    s_mov_b32 s14, 4718592
    s_mov_b32 s15, 0x00020000
    v_lshlrev_b32 v2, 4, v1
    s_lshl_b32 s45, s41, 19
    s_lshl_b32 s50, s40, 15
    s_add_u32 s45, s45, s50
    s_add_u32 s46, s45, 262144
    s_mul_i32 s50, s40, 589824
    s_mul_i32 s51, s42, 192
    s_add_u32 s50, s50, s51
    s_mov_b32 s52, 43691
    s_mov_b32 s53, 1152
    v_add_u32 v16, 0, v1
    v_mul_lo_u32 v17, v16, s52
    v_lshrrev_b32 v17, 19, v17
    v_mul_u32_u24 v18, 12, v17
    v_sub_u32 v18, v16, v18
    v_mul_lo_u32 v17, v17, s53
    v_lshl_add_u32 v17, v18, 4, v17
    v_add_u32 v17, s50, v17
    v_subrev_u32 v6, 0, v17
    v_add_u32 v16, 64, v1
    v_mul_lo_u32 v17, v16, s52
    v_lshrrev_b32 v17, 19, v17
    v_mul_u32_u24 v18, 12, v17
    v_sub_u32 v18, v16, v18
    v_mul_lo_u32 v17, v17, s53
    v_lshl_add_u32 v17, v18, 4, v17
    v_add_u32 v17, s50, v17
    v_subrev_u32 v7, 1024, v17
    v_add_u32 v16, 128, v1
    v_mul_lo_u32 v17, v16, s52
    v_lshrrev_b32 v17, 19, v17
    v_mul_u32_u24 v18, 12, v17
    v_sub_u32 v18, v16, v18
    v_mul_lo_u32 v17, v17, s53
    v_lshl_add_u32 v17, v18, 4, v17
    v_add_u32 v17, s50, v17
    v_subrev_u32 v8, 2048, v17
    v_add_u32 v16, 192, v1
    v_mul_lo_u32 v17, v16, s52
    v_lshrrev_b32 v17, 19, v17
    v_mul_u32_u24 v18, 12, v17
    v_sub_u32 v18, v16, v18
    v_mul_lo_u32 v17, v17, s53
    v_lshl_add_u32 v17, v18, 4, v17
    v_add_u32 v17, s50, v17
    v_subrev_u32 v9, 3072, v17
    v_add_u32 v16, 256, v1
    v_mul_lo_u32 v17, v16, s52
    v_lshrrev_b32 v17, 19, v17
    v_mul_u32_u24 v18, 12, v17
    v_sub_u32 v18, v16, v18
    v_mul_lo_u32 v17, v17, s53
    v_lshl_add_u32 v17, v18, 4, v17
    v_add_u32 v17, s50, v17
    v_subrev_u32 v10, 0, v17
    v_add_u32 v16, 320, v1
    v_mul_lo_u32 v17, v16, s52
    v_lshrrev_b32 v17, 19, v17
    v_mul_u32_u24 v18, 12, v17
    v_sub_u32 v18, v16, v18
    v_mul_lo_u32 v17, v17, s53
    v_lshl_add_u32 v17, v18, 4, v17
    v_add_u32 v17, s50, v17
    v_subrev_u32 v11, 1024, v17
    s_mul_i32 s48, s40, 18432
    v_lshrrev_b32 v16, 5, v1
    v_lshlrev_b32 v16, 3, v16
    v_bfe_u32 v17, v1, 2, 2
    v_add_u32 v16, v16, v17
    v_mul_u32_u24 v16, 192, v16
    v_bfe_u32 v18, v1, 4, 1
    v_lshl_add_u32 v16, v18, 5, v16
    v_and_b32 v18, 3, v1
    v_lshl_add_u32 v16, v18, 3, v16
    v_add_u32 v14, s48, v16
    s_add_u32 s50, s45, 0
    buffer_load_dwordx4 v[160:163], v2, s[4:7], s50 offen offset:0
    s_add_u32 s50, s45, 0
    buffer_load_dwordx4 v[164:167], v2, s[4:7], s50 offen offset:1024
    s_add_u32 s50, s46, 0
    buffer_load_dwordx4 v[168:171], v2, s[4:7], s50 offen offset:0
    s_add_u32 s50, s46, 0
    buffer_load_dwordx4 v[172:175], v2, s[4:7], s50 offen offset:1024
    s_add_u32 m0, s48, 0
    s_mov_b32 s51, 0
    buffer_load_dwordx4 v6, s[8:11], s51 offen offset:0 lds
    buffer_load_dwordx4 v7, s[8:11], s51 offen offset:1024 lds
    buffer_load_dwordx4 v8, s[8:11], s51 offen offset:2048 lds
    buffer_load_dwordx4 v9, s[8:11], s51 offen offset:3072 lds
    s_add_u32 m0, s48, 4096
    s_nop 0
    buffer_load_dwordx4 v10, s[8:11], s51 offen offset:0 lds
    buffer_load_dwordx4 v11, s[8:11], s51 offen offset:1024 lds
    s_add_u32 s50, s45, 0
    buffer_load_dwordx4 v[176:179], v2, s[4:7], s50 offen offset:2048
    s_add_u32 s50, s45, 0
    buffer_load_dwordx4 v[180:183], v2, s[4:7], s50 offen offset:3072
    s_add_u32 s50, s46, 0
    buffer_load_dwordx4 v[184:187], v2, s[4:7], s50 offen offset:2048
    s_add_u32 s50, s46, 0
    buffer_load_dwordx4 v[188:191], v2, s[4:7], s50 offen offset:3072
    s_add_u32 m0, s48, 6144
    s_mov_b32 s51, 36864
    buffer_load_dwordx4 v6, s[8:11], s51 offen offset:0 lds
    buffer_load_dwordx4 v7, s[8:11], s51 offen offset:1024 lds
    buffer_load_dwordx4 v8, s[8:11], s51 offen offset:2048 lds
    buffer_load_dwordx4 v9, s[8:11], s51 offen offset:3072 lds
    s_add_u32 m0, s48, 10240
    s_nop 0
    buffer_load_dwordx4 v10, s[8:11], s51 offen offset:0 lds
    buffer_load_dwordx4 v11, s[8:11], s51 offen offset:1024 lds
    s_add_u32 s50, s45, 4096
    buffer_load_dwordx4 v[192:195], v2, s[4:7], s50 offen offset:0
    s_add_u32 s50, s45, 4096
    buffer_load_dwordx4 v[196:199], v2, s[4:7], s50 offen offset:1024
    s_add_u32 s50, s46, 4096
    buffer_load_dwordx4 v[200:203], v2, s[4:7], s50 offen offset:0
    s_add_u32 s50, s46, 4096
    buffer_load_dwordx4 v[204:207], v2, s[4:7], s50 offen offset:1024
    s_add_u32 m0, s48, 12288
    s_mov_b32 s51, 73728
    buffer_load_dwordx4 v6, s[8:11], s51 offen offset:0 lds
    buffer_load_dwordx4 v7, s[8:11], s51 offen offset:1024 lds
    buffer_load_dwordx4 v8, s[8:11], s51 offen offset:2048 lds
    buffer_load_dwordx4 v9, s[8:11], s51 offen offset:3072 lds
    s_add_u32 m0, s48, 16384
    s_nop 0
    buffer_load_dwordx4 v10, s[8:11], s51 offen offset:0 lds
    buffer_load_dwordx4 v11, s[8:11], s51 offen offset:1024 lds
    s_waitcnt vmcnt(20)
    ds_read_b64_tr_b16 v[24:25], v14 offset:0
    ds_read_b64_tr_b16 v[26:27], v14 offset:768
    ds_read_b64_tr_b16 v[28:29], v14 offset:64
    ds_read_b64_tr_b16 v[30:31], v14 offset:832
    ds_read_b64_tr_b16 v[32:33], v14 offset:128
    ds_read_b64_tr_b16 v[34:35], v14 offset:896
    ds_read_b64_tr_b16 v[36:37], v14 offset:3072
    ds_read_b64_tr_b16 v[38:39], v14 offset:3840
    ds_read_b64_tr_b16 v[40:41], v14 offset:3136
    ds_read_b64_tr_b16 v[42:43], v14 offset:3904
    ds_read_b64_tr_b16 v[44:45], v14 offset:3200
    ds_read_b64_tr_b16 v[46:47], v14 offset:3968
    s_waitcnt lgkmcnt(6)
    v_mfma_f32_32x32x16_bf16 v[64:79], v[24:27], v[160:163], 0
    v_mfma_f32_32x32x16_bf16 v[80:95], v[28:31], v[160:163], 0
    v_mfma_f32_32x32x16_bf16 v[96:111], v[32:35], v[160:163], 0
    v_mfma_f32_32x32x16_bf16 v[112:127], v[24:27], v[168:171], 0
    v_mfma_f32_32x32x16_bf16 v[128:143], v[28:31], v[168:171], 0
    v_mfma_f32_32x32x16_bf16 v[144:159], v[32:35], v[168:171], 0
    s_waitcnt lgkmcnt(0)
    v_mfma_f32_32x32x16_bf16 v[64:79], v[36:39], v[164:167], v[64:79]
    v_mfma_f32_32x32x16_bf16 v[80:95], v[40:43], v[164:167], v[80:95]
    v_mfma_f32_32x32x16_bf16 v[96:111], v[44:47], v[164:167], v[96:111]
    v_mfma_f32_32x32x16_bf16 v[112:127], v[36:39], v[172:175], v[112:127]
    v_mfma_f32_32x32x16_bf16 v[128:143], v[40:43], v[172:175], v[128:143]
    v_mfma_f32_32x32x16_bf16 v[144:159], v[44:47], v[172:175], v[144:159]
    s_add_u32 s50, s45, 4096
    buffer_load_dwordx4 v[160:163], v2, s[4:7], s50 offen offset:2048
    s_add_u32 s50, s45, 4096
    buffer_load_dwordx4 v[164:167], v2, s[4:7], s50 offen offset:3072
    s_add_u32 s50, s46, 4096
    buffer_load_dwordx4 v[168:171], v2, s[4:7], s50 offen offset:2048
    s_add_u32 s50, s46, 4096
    buffer_load_dwordx4 v[172:175], v2, s[4:7], s50 offen offset:3072
    s_add_u32 m0, s48, 0
    s_mov_b32 s51, 110592
    buffer_load_dwordx4 v6, s[8:11], s51 offen offset:0 lds
    buffer_load_dwordx4 v7, s[8:11], s51 offen offset:1024 lds
    buffer_load_dwordx4 v8, s[8:11], s51 offen offset:2048 lds
    buffer_load_dwordx4 v9, s[8:11], s51 offen offset:3072 lds
    s_add_u32 m0, s48, 4096
    s_nop 0
    buffer_load_dwordx4 v10, s[8:11], s51 offen offset:0 lds
    buffer_load_dwordx4 v11, s[8:11], s51 offen offset:1024 lds
    s_waitcnt vmcnt(20)
    ds_read_b64_tr_b16 v[24:25], v14 offset:6144
    ds_read_b64_tr_b16 v[26:27], v14 offset:6912
    ds_read_b64_tr_b16 v[28:29], v14 offset:6208
    ds_read_b64_tr_b16 v[30:31], v14 offset:6976
    ds_read_b64_tr_b16 v[32:33], v14 offset:6272
    ds_read_b64_tr_b16 v[34:35], v14 offset:7040
    ds_read_b64_tr_b16 v[36:37], v14 offset:9216
    ds_read_b64_tr_b16 v[38:39], v14 offset:9984
    ds_read_b64_tr_b16 v[40:41], v14 offset:9280
    ds_read_b64_tr_b16 v[42:43], v14 offset:10048
    ds_read_b64_tr_b16 v[44:45], v14 offset:9344
    ds_read_b64_tr_b16 v[46:47], v14 offset:10112
    s_waitcnt lgkmcnt(6)
    v_mfma_f32_32x32x16_bf16 v[64:79], v[24:27], v[176:179], v[64:79]
    v_mfma_f32_32x32x16_bf16 v[80:95], v[28:31], v[176:179], v[80:95]
    v_mfma_f32_32x32x16_bf16 v[96:111], v[32:35], v[176:179], v[96:111]
    v_mfma_f32_32x32x16_bf16 v[112:127], v[24:27], v[184:187], v[112:127]
    v_mfma_f32_32x32x16_bf16 v[128:143], v[28:31], v[184:187], v[128:143]
    v_mfma_f32_32x32x16_bf16 v[144:159], v[32:35], v[184:187], v[144:159]
    s_waitcnt lgkmcnt(0)
    v_mfma_f32_32x32x16_bf16 v[64:79], v[36:39], v[180:183], v[64:79]
    v_mfma_f32_32x32x16_bf16 v[80:95], v[40:43], v[180:183], v[80:95]
    v_mfma_f32_32x32x16_bf16 v[96:111], v[44:47], v[180:183], v[96:111]
    v_mfma_f32_32x32x16_bf16 v[112:127], v[36:39], v[188:191], v[112:127]
    v_mfma_f32_32x32x16_bf16 v[128:143], v[40:43], v[188:191], v[128:143]
    v_mfma_f32_32x32x16_bf16 v[144:159], v[44:47], v[188:191], v[144:159]
    s_add_u32 s50, s45, 8192
    buffer_load_dwordx4 v[176:179], v2, s[4:7], s50 offen offset:0
    s_add_u32 s50, s45, 8192
    buffer_load_dwordx4 v[180:183], v2, s[4:7], s50 offen offset:1024
    s_add_u32 s50, s46, 8192
    buffer_load_dwordx4 v[184:187], v2, s[4:7], s50 offen offset:0
    s_add_u32 s50, s46, 8192
    buffer_load_dwordx4 v[188:191], v2, s[4:7], s50 offen offset:1024
    s_add_u32 m0, s48, 6144
    s_mov_b32 s51, 147456
    buffer_load_dwordx4 v6, s[8:11], s51 offen offset:0 lds
    buffer_load_dwordx4 v7, s[8:11], s51 offen offset:1024 lds
    buffer_load_dwordx4 v8, s[8:11], s51 offen offset:2048 lds
    buffer_load_dwordx4 v9, s[8:11], s51 offen offset:3072 lds
    s_add_u32 m0, s48, 10240
    s_nop 0
    buffer_load_dwordx4 v10, s[8:11], s51 offen offset:0 lds
    buffer_load_dwordx4 v11, s[8:11], s51 offen offset:1024 lds
    s_waitcnt vmcnt(20)
    ds_read_b64_tr_b16 v[24:25], v14 offset:12288
    ds_read_b64_tr_b16 v[26:27], v14 offset:13056
    ds_read_b64_tr_b16 v[28:29], v14 offset:12352
    ds_read_b64_tr_b16 v[30:31], v14 offset:13120
    ds_read_b64_tr_b16 v[32:33], v14 offset:12416
    ds_read_b64_tr_b16 v[34:35], v14 offset:13184
    ds_read_b64_tr_b16 v[36:37], v14 offset:15360
    ds_read_b64_tr_b16 v[38:39], v14 offset:16128
    ds_read_b64_tr_b16 v[40:41], v14 offset:15424
    ds_read_b64_tr_b16 v[42:43], v14 offset:16192
    ds_read_b64_tr_b16 v[44:45], v14 offset:15488
    ds_read_b64_tr_b16 v[46:47], v14 offset:16256
    s_waitcnt lgkmcnt(6)
    v_mfma_f32_32x32x16_bf16 v[64:79], v[24:27], v[192:195], v[64:79]
    v_mfma_f32_32x32x16_bf16 v[80:95], v[28:31], v[192:195], v[80:95]
    v_mfma_f32_32x32x16_bf16 v[96:111], v[32:35], v[192:195], v[96:111]
    v_mfma_f32_32x32x16_bf16 v[112:127], v[24:27], v[200:203], v[112:127]
    v_mfma_f32_32x32x16_bf16 v[128:143], v[28:31], v[200:203], v[128:143]
    v_mfma_f32_32x32x16_bf16 v[144:159], v[32:35], v[200:203], v[144:159]
    s_waitcnt lgkmcnt(0)
    v_mfma_f32_32x32x16_bf16 v[64:79], v[36:39], v[196:199], v[64:79]
    v_mfma_f32_32x32x16_bf16 v[80:95], v[40:43], v[196:199], v[80:95]
    v_mfma_f32_32x32x16_bf16 v[96:111], v[44:47], v[196:199], v[96:111]
    v_mfma_f32_32x32x16_bf16 v[112:127], v[36:39], v[204:207], v[112:127]
    v_mfma_f32_32x32x16_bf16 v[128:143], v[40:43], v[204:207], v[128:143]
    v_mfma_f32_32x32x16_bf16 v[144:159], v[44:47], v[204:207], v[144:159]
    s_add_u32 s50, s45, 8192
    buffer_load_dwordx4 v[192:195], v2, s[4:7], s50 offen offset:2048
    s_add_u32 s50, s45, 8192
    buffer_load_dwordx4 v[196:199], v2, s[4:7], s50 offen offset:3072
    s_add_u32 s50, s46, 8192
    buffer_load_dwordx4 v[200:203], v2, s[4:7], s50 offen offset:2048
    s_add_u32 s50, s46, 8192
    buffer_load_dwordx4 v[204:207], v2, s[4:7], s50 offen offset:3072
    s_add_u32 m0, s48, 12288
    s_mov_b32 s51, 184320
    buffer_load_dwordx4 v6, s[8:11], s51 offen offset:0 lds
    buffer_load_dwordx4 v7, s[8:11], s51 offen offset:1024 lds
    buffer_load_dwordx4 v8, s[8:11], s51 offen offset:2048 lds
    buffer_load_dwordx4 v9, s[8:11], s51 offen offset:3072 lds
    s_add_u32 m0, s48, 16384
    s_nop 0
    buffer_load_dwordx4 v10, s[8:11], s51 offen offset:0 lds
    buffer_load_dwordx4 v11, s[8:11], s51 offen offset:1024 lds
    s_waitcnt vmcnt(20)
    ds_read_b64_tr_b16 v[24:25], v14 offset:0
    ds_read_b64_tr_b16 v[26:27], v14 offset:768
    ds_read_b64_tr_b16 v[28:29], v14 offset:64
    ds_read_b64_tr_b16 v[30:31], v14 offset:832
    ds_read_b64_tr_b16 v[32:33], v14 offset:128
    ds_read_b64_tr_b16 v[34:35], v14 offset:896
    ds_read_b64_tr_b16 v[36:37], v14 offset:3072
    ds_read_b64_tr_b16 v[38:39], v14 offset:3840
    ds_read_b64_tr_b16 v[40:41], v14 offset:3136
    ds_read_b64_tr_b16 v[42:43], v14 offset:3904
    ds_read_b64_tr_b16 v[44:45], v14 offset:3200
    ds_read_b64_tr_b16 v[46:47], v14 offset:3968
    s_waitcnt lgkmcnt(6)
    v_mfma_f32_32x32x16_bf16 v[64:79], v[24:27], v[160:163], v[64:79]
    v_mfma_f32_32x32x16_bf16 v[80:95], v[28:31], v[160:163], v[80:95]
    v_mfma_f32_32x32x16_bf16 v[96:111], v[32:35], v[160:163], v[96:111]
    v_mfma_f32_32x32x16_bf16 v[112:127], v[24:27], v[168:171], v[112:127]
    v_mfma_f32_32x32x16_bf16 v[128:143], v[28:31], v[168:171], v[128:143]
    v_mfma_f32_32x32x16_bf16 v[144:159], v[32:35], v[168:171], v[144:159]
    s_waitcnt lgkmcnt(0)
    v_mfma_f32_32x32x16_bf16 v[64:79], v[36:39], v[164:167], v[64:79]
    v_mfma_f32_32x32x16_bf16 v[80:95], v[40:43], v[164:167], v[80:95]
    v_mfma_f32_32x32x16_bf16 v[96:111], v[44:47], v[164:167], v[96:111]
    v_mfma_f32_32x32x16_bf16 v[112:127], v[36:39], v[172:175], v[112:127]
    v_mfma_f32_32x32x16_bf16 v[128:143], v[40:43], v[172:175], v[128:143]
    v_mfma_f32_32x32x16_bf16 v[144:159], v[44:47], v[172:175], v[144:159]
    s_add_u32 s50, s45, 12288
    buffer_load_dwordx4 v[160:163], v2, s[4:7], s50 offen offset:0
    s_add_u32 s50, s45, 12288
    buffer_load_dwordx4 v[164:167], v2, s[4:7], s50 offen offset:1024
    s_add_u32 s50, s46, 12288
    buffer_load_dwordx4 v[168:171], v2, s[4:7], s50 offen offset:0
    s_add_u32 s50, s46, 12288
    buffer_load_dwordx4 v[172:175], v2, s[4:7], s50 offen offset:1024
    s_add_u32 m0, s48, 0
    s_mov_b32 s51, 221184
    buffer_load_dwordx4 v6, s[8:11], s51 offen offset:0 lds
    buffer_load_dwordx4 v7, s[8:11], s51 offen offset:1024 lds
    buffer_load_dwordx4 v8, s[8:11], s51 offen offset:2048 lds
    buffer_load_dwordx4 v9, s[8:11], s51 offen offset:3072 lds
    s_add_u32 m0, s48, 4096
    s_nop 0
    buffer_load_dwordx4 v10, s[8:11], s51 offen offset:0 lds
    buffer_load_dwordx4 v11, s[8:11], s51 offen offset:1024 lds
    s_waitcnt vmcnt(20)
    ds_read_b64_tr_b16 v[24:25], v14 offset:6144
    ds_read_b64_tr_b16 v[26:27], v14 offset:6912
    ds_read_b64_tr_b16 v[28:29], v14 offset:6208
    ds_read_b64_tr_b16 v[30:31], v14 offset:6976
    ds_read_b64_tr_b16 v[32:33], v14 offset:6272
    ds_read_b64_tr_b16 v[34:35], v14 offset:7040
    ds_read_b64_tr_b16 v[36:37], v14 offset:9216
    ds_read_b64_tr_b16 v[38:39], v14 offset:9984
    ds_read_b64_tr_b16 v[40:41], v14 offset:9280
    ds_read_b64_tr_b16 v[42:43], v14 offset:10048
    ds_read_b64_tr_b16 v[44:45], v14 offset:9344
    ds_read_b64_tr_b16 v[46:47], v14 offset:10112
    s_waitcnt lgkmcnt(6)
    v_mfma_f32_32x32x16_bf16 v[64:79], v[24:27], v[176:179], v[64:79]
    v_mfma_f32_32x32x16_bf16 v[80:95], v[28:31], v[176:179], v[80:95]
    v_mfma_f32_32x32x16_bf16 v[96:111], v[32:35], v[176:179], v[96:111]
    v_mfma_f32_32x32x16_bf16 v[112:127], v[24:27], v[184:187], v[112:127]
    v_mfma_f32_32x32x16_bf16 v[128:143], v[28:31], v[184:187], v[128:143]
    v_mfma_f32_32x32x16_bf16 v[144:159], v[32:35], v[184:187], v[144:159]
    s_waitcnt lgkmcnt(0)
    v_mfma_f32_32x32x16_bf16 v[64:79], v[36:39], v[180:183], v[64:79]
    v_mfma_f32_32x32x16_bf16 v[80:95], v[40:43], v[180:183], v[80:95]
    v_mfma_f32_32x32x16_bf16 v[96:111], v[44:47], v[180:183], v[96:111]
    v_mfma_f32_32x32x16_bf16 v[112:127], v[36:39], v[188:191], v[112:127]
    v_mfma_f32_32x32x16_bf16 v[128:143], v[40:43], v[188:191], v[128:143]
    v_mfma_f32_32x32x16_bf16 v[144:159], v[44:47], v[188:191], v[144:159]
    s_add_u32 s50, s45, 12288
    buffer_load_dwordx4 v[176:179], v2, s[4:7], s50 offen offset:2048
    s_add_u32 s50, s45, 12288
    buffer_load_dwordx4 v[180:183], v2, s[4:7], s50 offen offset:3072
    s_add_u32 s50, s46, 12288
    buffer_load_dwordx4 v[184:187], v2, s[4:7], s50 offen offset:2048
    s_add_u32 s50, s46, 12288
    buffer_load_dwordx4 v[188:191], v2, s[4:7], s50 offen offset:3072
    s_add_u32 m0, s48, 6144
    s_mov_b32 s51, 258048
    buffer_load_dwordx4 v6, s[8:11], s51 offen offset:0 lds
    buffer_load_dwordx4 v7, s[8:11], s51 offen offset:1024 lds
    buffer_load_dwordx4 v8, s[8:11], s51 offen offset:2048 lds
    buffer_load_dwordx4 v9, s[8:11], s51 offen offset:3072 lds
    s_add_u32 m0, s48, 10240
    s_nop 0
    buffer_load_dwordx4 v10, s[8:11], s51 offen offset:0 lds
    buffer_load_dwordx4 v11, s[8:11], s51 offen offset:1024 lds
    s_waitcnt vmcnt(20)
    ds_read_b64_tr_b16 v[24:25], v14 offset:12288
    ds_read_b64_tr_b16 v[26:27], v14 offset:13056
    ds_read_b64_tr_b16 v[28:29], v14 offset:12352
    ds_read_b64_tr_b16 v[30:31], v14 offset:13120
    ds_read_b64_tr_b16 v[32:33], v14 offset:12416
    ds_read_b64_tr_b16 v[34:35], v14 offset:13184
    ds_read_b64_tr_b16 v[36:37], v14 offset:15360
    ds_read_b64_tr_b16 v[38:39], v14 offset:16128
    ds_read_b64_tr_b16 v[40:41], v14 offset:15424
    ds_read_b64_tr_b16 v[42:43], v14 offset:16192
    ds_read_b64_tr_b16 v[44:45], v14 offset:15488
    ds_read_b64_tr_b16 v[46:47], v14 offset:16256
    s_waitcnt lgkmcnt(6)
    v_mfma_f32_32x32x16_bf16 v[64:79], v[24:27], v[192:195], v[64:79]
    v_mfma_f32_32x32x16_bf16 v[80:95], v[28:31], v[192:195], v[80:95]
    v_mfma_f32_32x32x16_bf16 v[96:111], v[32:35], v[192:195], v[96:111]
    v_mfma_f32_32x32x16_bf16 v[112:127], v[24:27], v[200:203], v[112:127]
    v_mfma_f32_32x32x16_bf16 v[128:143], v[28:31], v[200:203], v[128:143]
    v_mfma_f32_32x32x16_bf16 v[144:159], v[32:35], v[200:203], v[144:159]
    s_waitcnt lgkmcnt(0)
    v_mfma_f32_32x32x16_bf16 v[64:79], v[36:39], v[196:199], v[64:79]
    v_mfma_f32_32x32x16_bf16 v[80:95], v[40:43], v[196:199], v[80:95]
    v_mfma_f32_32x32x16_bf16 v[96:111], v[44:47], v[196:199], v[96:111]
    v_mfma_f32_32x32x16_bf16 v[112:127], v[36:39], v[204:207], v[112:127]
    v_mfma_f32_32x32x16_bf16 v[128:143], v[40:43], v[204:207], v[128:143]
    v_mfma_f32_32x32x16_bf16 v[144:159], v[44:47], v[204:207], v[144:159]
    s_add_u32 s50, s45, 16384
    buffer_load_dwordx4 v[192:195], v2, s[4:7], s50 offen offset:0
    s_add_u32 s50, s45, 16384
    buffer_load_dwordx4 v[196:199], v2, s[4:7], s50 offen offset:1024
    s_add_u32 s50, s46, 16384
    buffer_load_dwordx4 v[200:203], v2, s[4:7], s50 offen offset:0
    s_add_u32 s50, s46, 16384
    buffer_load_dwordx4 v[204:207], v2, s[4:7], s50 offen offset:1024
    s_add_u32 m0, s48, 12288
    s_mov_b32 s51, 294912
    buffer_load_dwordx4 v6, s[8:11], s51 offen offset:0 lds
    buffer_load_dwordx4 v7, s[8:11], s51 offen offset:1024 lds
    buffer_load_dwordx4 v8, s[8:11], s51 offen offset:2048 lds
    buffer_load_dwordx4 v9, s[8:11], s51 offen offset:3072 lds
    s_add_u32 m0, s48, 16384
    s_nop 0
    buffer_load_dwordx4 v10, s[8:11], s51 offen offset:0 lds
    buffer_load_dwordx4 v11, s[8:11], s51 offen offset:1024 lds
    s_waitcnt vmcnt(20)
    ds_read_b64_tr_b16 v[24:25], v14 offset:0
    ds_read_b64_tr_b16 v[26:27], v14 offset:768
    ds_read_b64_tr_b16 v[28:29], v14 offset:64
    ds_read_b64_tr_b16 v[30:31], v14 offset:832
    ds_read_b64_tr_b16 v[32:33], v14 offset:128
    ds_read_b64_tr_b16 v[34:35], v14 offset:896
    ds_read_b64_tr_b16 v[36:37], v14 offset:3072
    ds_read_b64_tr_b16 v[38:39], v14 offset:3840
    ds_read_b64_tr_b16 v[40:41], v14 offset:3136
    ds_read_b64_tr_b16 v[42:43], v14 offset:3904
    ds_read_b64_tr_b16 v[44:45], v14 offset:3200
    ds_read_b64_tr_b16 v[46:47], v14 offset:3968
    s_waitcnt lgkmcnt(6)
    v_mfma_f32_32x32x16_bf16 v[64:79], v[24:27], v[160:163], v[64:79]
    v_mfma_f32_32x32x16_bf16 v[80:95], v[28:31], v[160:163], v[80:95]
    v_mfma_f32_32x32x16_bf16 v[96:111], v[32:35], v[160:163], v[96:111]
    v_mfma_f32_32x32x16_bf16 v[112:127], v[24:27], v[168:171], v[112:127]
    v_mfma_f32_32x32x16_bf16 v[128:143], v[28:31], v[168:171], v[128:143]
    v_mfma_f32_32x32x16_bf16 v[144:159], v[32:35], v[168:171], v[144:159]
    s_waitcnt lgkmcnt(0)
    v_mfma_f32_32x32x16_bf16 v[64:79], v[36:39], v[164:167], v[64:79]
    v_mfma_f32_32x32x16_bf16 v[80:95], v[40:43], v[164:167], v[80:95]
    v_mfma_f32_32x32x16_bf16 v[96:111], v[44:47], v[164:167], v[96:111]
    v_mfma_f32_32x32x16_bf16 v[112:127], v[36:39], v[172:175], v[112:127]
    v_mfma_f32_32x32x16_bf16 v[128:143], v[40:43], v[172:175], v[128:143]
    v_mfma_f32_32x32x16_bf16 v[144:159], v[44:47], v[172:175], v[144:159]
    s_add_u32 s50, s45, 16384
    buffer_load_dwordx4 v[160:163], v2, s[4:7], s50 offen offset:2048
    s_add_u32 s50, s45, 16384
    buffer_load_dwordx4 v[164:167], v2, s[4:7], s50 offen offset:3072
    s_add_u32 s50, s46, 16384
    buffer_load_dwordx4 v[168:171], v2, s[4:7], s50 offen offset:2048
    s_add_u32 s50, s46, 16384
    buffer_load_dwordx4 v[172:175], v2, s[4:7], s50 offen offset:3072
    s_add_u32 m0, s48, 0
    s_mov_b32 s51, 331776
    buffer_load_dwordx4 v6, s[8:11], s51 offen offset:0 lds
    buffer_load_dwordx4 v7, s[8:11], s51 offen offset:1024 lds
    buffer_load_dwordx4 v8, s[8:11], s51 offen offset:2048 lds
    buffer_load_dwordx4 v9, s[8:11], s51 offen offset:3072 lds
    s_add_u32 m0, s48, 4096
    s_nop 0
    buffer_load_dwordx4 v10, s[8:11], s51 offen offset:0 lds
    buffer_load_dwordx4 v11, s[8:11], s51 offen offset:1024 lds
    s_waitcnt vmcnt(20)
    ds_read_b64_tr_b16 v[24:25], v14 offset:6144
    ds_read_b64_tr_b16 v[26:27], v14 offset:6912
    ds_read_b64_tr_b16 v[28:29], v14 offset:6208
    ds_read_b64_tr_b16 v[30:31], v14 offset:6976
    ds_read_b64_tr_b16 v[32:33], v14 offset:6272
    ds_read_b64_tr_b16 v[34:35], v14 offset:7040
    ds_read_b64_tr_b16 v[36:37], v14 offset:9216
    ds_read_b64_tr_b16 v[38:39], v14 offset:9984
    ds_read_b64_tr_b16 v[40:41], v14 offset:9280
    ds_read_b64_tr_b16 v[42:43], v14 offset:10048
    ds_read_b64_tr_b16 v[44:45], v14 offset:9344
    ds_read_b64_tr_b16 v[46:47], v14 offset:10112
    s_waitcnt lgkmcnt(6)
    v_mfma_f32_32x32x16_bf16 v[64:79], v[24:27], v[176:179], v[64:79]
    v_mfma_f32_32x32x16_bf16 v[80:95], v[28:31], v[176:179], v[80:95]
    v_mfma_f32_32x32x16_bf16 v[96:111], v[32:35], v[176:179], v[96:111]
    v_mfma_f32_32x32x16_bf16 v[112:127], v[24:27], v[184:187], v[112:127]
    v_mfma_f32_32x32x16_bf16 v[128:143], v[28:31], v[184:187], v[128:143]
    v_mfma_f32_32x32x16_bf16 v[144:159], v[32:35], v[184:187], v[144:159]
    s_waitcnt lgkmcnt(0)
    v_mfma_f32_32x32x16_bf16 v[64:79], v[36:39], v[180:183], v[64:79]
    v_mfma_f32_32x32x16_bf16 v[80:95], v[40:43], v[180:183], v[80:95]
    v_mfma_f32_32x32x16_bf16 v[96:111], v[44:47], v[180:183], v[96:111]
    v_mfma_f32_32x32x16_bf16 v[112:127], v[36:39], v[188:191], v[112:127]
    v_mfma_f32_32x32x16_bf16 v[128:143], v[40:43], v[188:191], v[128:143]
    v_mfma_f32_32x32x16_bf16 v[144:159], v[44:47], v[188:191], v[144:159]
    s_add_u32 s50, s45, 20480
    buffer_load_dwordx4 v[176:179], v2, s[4:7], s50 offen offset:0
    s_add_u32 s50, s45, 20480
    buffer_load_dwordx4 v[180:183], v2, s[4:7], s50 offen offset:1024
    s_add_u32 s50, s46, 20480
    buffer_load_dwordx4 v[184:187], v2, s[4:7], s50 offen offset:0
    s_add_u32 s50, s46, 20480
    buffer_load_dwordx4 v[188:191], v2, s[4:7], s50 offen offset:1024
    s_add_u32 m0, s48, 6144
    s_mov_b32 s51, 368640
    buffer_load_dwordx4 v6, s[8:11], s51 offen offset:0 lds
    buffer_load_dwordx4 v7, s[8:11], s51 offen offset:1024 lds
    buffer_load_dwordx4 v8, s[8:11], s51 offen offset:2048 lds
    buffer_load_dwordx4 v9, s[8:11], s51 offen offset:3072 lds
    s_add_u32 m0, s48, 10240
    s_nop 0
    buffer_load_dwordx4 v10, s[8:11], s51 offen offset:0 lds
    buffer_load_dwordx4 v11, s[8:11], s51 offen offset:1024 lds
    s_waitcnt vmcnt(20)
    ds_read_b64_tr_b16 v[24:25], v14 offset:12288
    ds_read_b64_tr_b16 v[26:27], v14 offset:13056
    ds_read_b64_tr_b16 v[28:29], v14 offset:12352
    ds_read_b64_tr_b16 v[30:31], v14 offset:13120
    ds_read_b64_tr_b16 v[32:33], v14 offset:12416
    ds_read_b64_tr_b16 v[34:35], v14 offset:13184
    ds_read_b64_tr_b16 v[36:37], v14 offset:15360
    ds_read_b64_tr_b16 v[38:39], v14 offset:16128
    ds_read_b64_tr_b16 v[40:41], v14 offset:15424
    ds_read_b64_tr_b16 v[42:43], v14 offset:16192
    ds_read_b64_tr_b16 v[44:45], v14 offset:15488
    ds_read_b64_tr_b16 v[46:47], v14 offset:16256
    s_waitcnt lgkmcnt(6)
    v_mfma_f32_32x32x16_bf16 v[64:79], v[24:27], v[192:195], v[64:79]
    v_mfma_f32_32x32x16_bf16 v[80:95], v[28:31], v[192:195], v[80:95]
    v_mfma_f32_32x32x16_bf16 v[96:111], v[32:35], v[192:195], v[96:111]
    v_mfma_f32_32x32x16_bf16 v[112:127], v[24:27], v[200:203], v[112:127]
    v_mfma_f32_32x32x16_bf16 v[128:143], v[28:31], v[200:203], v[128:143]
    v_mfma_f32_32x32x16_bf16 v[144:159], v[32:35], v[200:203], v[144:159]
    s_waitcnt lgkmcnt(0)
    v_mfma_f32_32x32x16_bf16 v[64:79], v[36:39], v[196:199], v[64:79]
    v_mfma_f32_32x32x16_bf16 v[80:95], v[40:43], v[196:199], v[80:95]
    v_mfma_f32_32x32x16_bf16 v[96:111], v[44:47], v[196:199], v[96:111]
    v_mfma_f32_32x32x16_bf16 v[112:127], v[36:39], v[204:207], v[112:127]
    v_mfma_f32_32x32x16_bf16 v[128:143], v[40:43], v[204:207], v[128:143]
    v_mfma_f32_32x32x16_bf16 v[144:159], v[44:47], v[204:207], v[144:159]
    s_add_u32 s50, s45, 20480
    buffer_load_dwordx4 v[192:195], v2, s[4:7], s50 offen offset:2048
    s_add_u32 s50, s45, 20480
    buffer_load_dwordx4 v[196:199], v2, s[4:7], s50 offen offset:3072
    s_add_u32 s50, s46, 20480
    buffer_load_dwordx4 v[200:203], v2, s[4:7], s50 offen offset:2048
    s_add_u32 s50, s46, 20480
    buffer_load_dwordx4 v[204:207], v2, s[4:7], s50 offen offset:3072
    s_add_u32 m0, s48, 12288
    s_mov_b32 s51, 405504
    buffer_load_dwordx4 v6, s[8:11], s51 offen offset:0 lds
    buffer_load_dwordx4 v7, s[8:11], s51 offen offset:1024 lds
    buffer_load_dwordx4 v8, s[8:11], s51 offen offset:2048 lds
    buffer_load_dwordx4 v9, s[8:11], s51 offen offset:3072 lds
    s_add_u32 m0, s48, 16384
    s_nop 0
    buffer_load_dwordx4 v10, s[8:11], s51 offen offset:0 lds
    buffer_load_dwordx4 v11, s[8:11], s51 offen offset:1024 lds
    s_waitcnt vmcnt(20)
    ds_read_b64_tr_b16 v[24:25], v14 offset:0
    ds_read_b64_tr_b16 v[26:27], v14 offset:768
    ds_read_b64_tr_b16 v[28:29], v14 offset:64
    ds_read_b64_tr_b16 v[30:31], v14 offset:832
    ds_read_b64_tr_b16 v[32:33], v14 offset:128
    ds_read_b64_tr_b16 v[34:35], v14 offset:896
    ds_read_b64_tr_b16 v[36:37], v14 offset:3072
    ds_read_b64_tr_b16 v[38:39], v14 offset:3840
    ds_read_b64_tr_b16 v[40:41], v14 offset:3136
    ds_read_b64_tr_b16 v[42:43], v14 offset:3904
    ds_read_b64_tr_b16 v[44:45], v14 offset:3200
    ds_read_b64_tr_b16 v[46:47], v14 offset:3968
    s_waitcnt lgkmcnt(6)
    v_mfma_f32_32x32x16_bf16 v[64:79], v[24:27], v[160:163], v[64:79]
    v_mfma_f32_32x32x16_bf16 v[80:95], v[28:31], v[160:163], v[80:95]
    v_mfma_f32_32x32x16_bf16 v[96:111], v[32:35], v[160:163], v[96:111]
    v_mfma_f32_32x32x16_bf16 v[112:127], v[24:27], v[168:171], v[112:127]
    v_mfma_f32_32x32x16_bf16 v[128:143], v[28:31], v[168:171], v[128:143]
    v_mfma_f32_32x32x16_bf16 v[144:159], v[32:35], v[168:171], v[144:159]
    s_waitcnt lgkmcnt(0)
    v_mfma_f32_32x32x16_bf16 v[64:79], v[36:39], v[164:167], v[64:79]
    v_mfma_f32_32x32x16_bf16 v[80:95], v[40:43], v[164:167], v[80:95]
    v_mfma_f32_32x32x16_bf16 v[96:111], v[44:47], v[164:167], v[96:111]
    v_mfma_f32_32x32x16_bf16 v[112:127], v[36:39], v[172:175], v[112:127]
    v_mfma_f32_32x32x16_bf16 v[128:143], v[40:43], v[172:175], v[128:143]
    v_mfma_f32_32x32x16_bf16 v[144:159], v[44:47], v[172:175], v[144:159]
    s_add_u32 s50, s45, 24576
    buffer_load_dwordx4 v[160:163], v2, s[4:7], s50 offen offset:0
    s_add_u32 s50, s45, 24576
    buffer_load_dwordx4 v[164:167], v2, s[4:7], s50 offen offset:1024
    s_add_u32 s50, s46, 24576
    buffer_load_dwordx4 v[168:171], v2, s[4:7], s50 offen offset:0
    s_add_u32 s50, s46, 24576
    buffer_load_dwordx4 v[172:175], v2, s[4:7], s50 offen offset:1024
    s_add_u32 m0, s48, 0
    s_mov_b32 s51, 442368
    buffer_load_dwordx4 v6, s[8:11], s51 offen offset:0 lds
    buffer_load_dwordx4 v7, s[8:11], s51 offen offset:1024 lds
    buffer_load_dwordx4 v8, s[8:11], s51 offen offset:2048 lds
    buffer_load_dwordx4 v9, s[8:11], s51 offen offset:3072 lds
    s_add_u32 m0, s48, 4096
    s_nop 0
    buffer_load_dwordx4 v10, s[8:11], s51 offen offset:0 lds
    buffer_load_dwordx4 v11, s[8:11], s51 offen offset:1024 lds
    s_waitcnt vmcnt(20)
    ds_read_b64_tr_b16 v[24:25], v14 offset:6144
    ds_read_b64_tr_b16 v[26:27], v14 offset:6912
    ds_read_b64_tr_b16 v[28:29], v14 offset:6208
    ds_read_b64_tr_b16 v[30:31], v14 offset:6976
    ds_read_b64_tr_b16 v[32:33], v14 offset:6272
    ds_read_b64_tr_b16 v[34:35], v14 offset:7040
    ds_read_b64_tr_b16 v[36:37], v14 offset:9216
    ds_read_b64_tr_b16 v[38:39], v14 offset:9984
    ds_read_b64_tr_b16 v[40:41], v14 offset:9280
    ds_read_b64_tr_b16 v[42:43], v14 offset:10048
    ds_read_b64_tr_b16 v[44:45], v14 offset:9344
    ds_read_b64_tr_b16 v[46:47], v14 offset:10112
    s_waitcnt lgkmcnt(6)
    v_mfma_f32_32x32x16_bf16 v[64:79], v[24:27], v[176:179], v[64:79]
    v_mfma_f32_32x32x16_bf16 v[80:95], v[28:31], v[176:179], v[80:95]
    v_mfma_f32_32x32x16_bf16 v[96:111], v[32:35], v[176:179], v[96:111]
    v_mfma_f32_32x32x16_bf16 v[112:127], v[24:27], v[184:187], v[112:127]
    v_mfma_f32_32x32x16_bf16 v[128:143], v[28:31], v[184:187], v[128:143]
    v_mfma_f32_32x32x16_bf16 v[144:159], v[32:35], v[184:187], v[144:159]
    s_waitcnt lgkmcnt(0)
    v_mfma_f32_32x32x16_bf16 v[64:79], v[36:39], v[180:183], v[64:79]
    v_mfma_f32_32x32x16_bf16 v[80:95], v[40:43], v[180:183], v[80:95]
    v_mfma_f32_32x32x16_bf16 v[96:111], v[44:47], v[180:183], v[96:111]
    v_mfma_f32_32x32x16_bf16 v[112:127], v[36:39], v[188:191], v[112:127]
    v_mfma_f32_32x32x16_bf16 v[128:143], v[40:43], v[188:191], v[128:143]
    v_mfma_f32_32x32x16_bf16 v[144:159], v[44:47], v[188:191], v[144:159]
    s_add_u32 s50, s45, 24576
    buffer_load_dwordx4 v[176:179], v2, s[4:7], s50 offen offset:2048
    s_add_u32 s50, s45, 24576
    buffer_load_dwordx4 v[180:183], v2, s[4:7], s50 offen offset:3072
    s_add_u32 s50, s46, 24576
    buffer_load_dwordx4 v[184:187], v2, s[4:7], s50 offen offset:2048
    s_add_u32 s50, s46, 24576
    buffer_load_dwordx4 v[188:191], v2, s[4:7], s50 offen offset:3072
    s_add_u32 m0, s48, 6144
    s_mov_b32 s51, 479232
    buffer_load_dwordx4 v6, s[8:11], s51 offen offset:0 lds
    buffer_load_dwordx4 v7, s[8:11], s51 offen offset:1024 lds
    buffer_load_dwordx4 v8, s[8:11], s51 offen offset:2048 lds
    buffer_load_dwordx4 v9, s[8:11], s51 offen offset:3072 lds
    s_add_u32 m0, s48, 10240
    s_nop 0
    buffer_load_dwordx4 v10, s[8:11], s51 offen offset:0 lds
    buffer_load_dwordx4 v11, s[8:11], s51 offen offset:1024 lds
    s_waitcnt vmcnt(20)
    ds_read_b64_tr_b16 v[24:25], v14 offset:12288
    ds_read_b64_tr_b16 v[26:27], v14 offset:13056
    ds_read_b64_tr_b16 v[28:29], v14 offset:12352
    ds_read_b64_tr_b16 v[30:31], v14 offset:13120
    ds_read_b64_tr_b16 v[32:33], v14 offset:12416
    ds_read_b64_tr_b16 v[34:35], v14 offset:13184
    ds_read_b64_tr_b16 v[36:37], v14 offset:15360
    ds_read_b64_tr_b16 v[38:39], v14 offset:16128
    ds_read_b64_tr_b16 v[40:41], v14 offset:15424
    ds_read_b64_tr_b16 v[42:43], v14 offset:16192
    ds_read_b64_tr_b16 v[44:45], v14 offset:15488
    ds_read_b64_tr_b16 v[46:47], v14 offset:16256
    s_waitcnt lgkmcnt(6)
    v_mfma_f32_32x32x16_bf16 v[64:79], v[24:27], v[192:195], v[64:79]
    v_mfma_f32_32x32x16_bf16 v[80:95], v[28:31], v[192:195], v[80:95]
    v_mfma_f32_32x32x16_bf16 v[96:111], v[32:35], v[192:195], v[96:111]
    v_mfma_f32_32x32x16_bf16 v[112:127], v[24:27], v[200:203], v[112:127]
    v_mfma_f32_32x32x16_bf16 v[128:143], v[28:31], v[200:203], v[128:143]
    v_mfma_f32_32x32x16_bf16 v[144:159], v[32:35], v[200:203], v[144:159]
    s_waitcnt lgkmcnt(0)
    v_mfma_f32_32x32x16_bf16 v[64:79], v[36:39], v[196:199], v[64:79]
    v_mfma_f32_32x32x16_bf16 v[80:95], v[40:43], v[196:199], v[80:95]
    v_mfma_f32_32x32x16_bf16 v[96:111], v[44:47], v[196:199], v[96:111]
    v_mfma_f32_32x32x16_bf16 v[112:127], v[36:39], v[204:207], v[112:127]
    v_mfma_f32_32x32x16_bf16 v[128:143], v[40:43], v[204:207], v[128:143]
    v_mfma_f32_32x32x16_bf16 v[144:159], v[44:47], v[204:207], v[144:159]
    s_add_u32 s50, s45, 28672
    buffer_load_dwordx4 v[192:195], v2, s[4:7], s50 offen offset:0
    s_add_u32 s50, s45, 28672
    buffer_load_dwordx4 v[196:199], v2, s[4:7], s50 offen offset:1024
    s_add_u32 s50, s46, 28672
    buffer_load_dwordx4 v[200:203], v2, s[4:7], s50 offen offset:0
    s_add_u32 s50, s46, 28672
    buffer_load_dwordx4 v[204:207], v2, s[4:7], s50 offen offset:1024
    s_add_u32 m0, s48, 12288
    s_mov_b32 s51, 516096
    buffer_load_dwordx4 v6, s[8:11], s51 offen offset:0 lds
    buffer_load_dwordx4 v7, s[8:11], s51 offen offset:1024 lds
    buffer_load_dwordx4 v8, s[8:11], s51 offen offset:2048 lds
    buffer_load_dwordx4 v9, s[8:11], s51 offen offset:3072 lds
    s_add_u32 m0, s48, 16384
    s_nop 0
    buffer_load_dwordx4 v10, s[8:11], s51 offen offset:0 lds
    buffer_load_dwordx4 v11, s[8:11], s51 offen offset:1024 lds
    s_waitcnt vmcnt(20)
    ds_read_b64_tr_b16 v[24:25], v14 offset:0
    ds_read_b64_tr_b16 v[26:27], v14 offset:768
    ds_read_b64_tr_b16 v[28:29], v14 offset:64
    ds_read_b64_tr_b16 v[30:31], v14 offset:832
    ds_read_b64_tr_b16 v[32:33], v14 offset:128
    ds_read_b64_tr_b16 v[34:35], v14 offset:896
    ds_read_b64_tr_b16 v[36:37], v14 offset:3072
    ds_read_b64_tr_b16 v[38:39], v14 offset:3840
    ds_read_b64_tr_b16 v[40:41], v14 offset:3136
    ds_read_b64_tr_b16 v[42:43], v14 offset:3904
    ds_read_b64_tr_b16 v[44:45], v14 offset:3200
    ds_read_b64_tr_b16 v[46:47], v14 offset:3968
    s_waitcnt lgkmcnt(6)
    v_mfma_f32_32x32x16_bf16 v[64:79], v[24:27], v[160:163], v[64:79]
    v_mfma_f32_32x32x16_bf16 v[80:95], v[28:31], v[160:163], v[80:95]
    v_mfma_f32_32x32x16_bf16 v[96:111], v[32:35], v[160:163], v[96:111]
    v_mfma_f32_32x32x16_bf16 v[112:127], v[24:27], v[168:171], v[112:127]
    v_mfma_f32_32x32x16_bf16 v[128:143], v[28:31], v[168:171], v[128:143]
    v_mfma_f32_32x32x16_bf16 v[144:159], v[32:35], v[168:171], v[144:159]
    s_waitcnt lgkmcnt(0)
    v_mfma_f32_32x32x16_bf16 v[64:79], v[36:39], v[164:167], v[64:79]
    v_mfma_f32_32x32x16_bf16 v[80:95], v[40:43], v[164:167], v[80:95]
    v_mfma_f32_32x32x16_bf16 v[96:111], v[44:47], v[164:167], v[96:111]
    v_mfma_f32_32x32x16_bf16 v[112:127], v[36:39], v[172:175], v[112:127]
    v_mfma_f32_32x32x16_bf16 v[128:143], v[40:43], v[172:175], v[128:143]
    v_mfma_f32_32x32x16_bf16 v[144:159], v[44:47], v[172:175], v[144:159]
    s_add_u32 s50, s45, 28672
    buffer_load_dwordx4 v[160:163], v2, s[4:7], s50 offen offset:2048
    s_add_u32 s50, s45, 28672
    buffer_load_dwordx4 v[164:167], v2, s[4:7], s50 offen offset:3072
    s_add_u32 s50, s46, 28672
    buffer_load_dwordx4 v[168:171], v2, s[4:7], s50 offen offset:2048
    s_add_u32 s50, s46, 28672
    buffer_load_dwordx4 v[172:175], v2, s[4:7], s50 offen offset:3072
    s_add_u32 m0, s48, 0
    s_mov_b32 s51, 552960
    buffer_load_dwordx4 v6, s[8:11], s51 offen offset:0 lds
    buffer_load_dwordx4 v7, s[8:11], s51 offen offset:1024 lds
    buffer_load_dwordx4 v8, s[8:11], s51 offen offset:2048 lds
    buffer_load_dwordx4 v9, s[8:11], s51 offen offset:3072 lds
    s_add_u32 m0, s48, 4096
    s_nop 0
    buffer_load_dwordx4 v10, s[8:11], s51 offen offset:0 lds
    buffer_load_dwordx4 v11, s[8:11], s51 offen offset:1024 lds
    s_waitcnt vmcnt(20)
    ds_read_b64_tr_b16 v[24:25], v14 offset:6144
    ds_read_b64_tr_b16 v[26:27], v14 offset:6912
    ds_read_b64_tr_b16 v[28:29], v14 offset:6208
    ds_read_b64_tr_b16 v[30:31], v14 offset:6976
    ds_read_b64_tr_b16 v[32:33], v14 offset:6272
    ds_read_b64_tr_b16 v[34:35], v14 offset:7040
    ds_read_b64_tr_b16 v[36:37], v14 offset:9216
    ds_read_b64_tr_b16 v[38:39], v14 offset:9984
    ds_read_b64_tr_b16 v[40:41], v14 offset:9280
    ds_read_b64_tr_b16 v[42:43], v14 offset:10048
    ds_read_b64_tr_b16 v[44:45], v14 offset:9344
    ds_read_b64_tr_b16 v[46:47], v14 offset:10112
    s_waitcnt lgkmcnt(6)
    v_mfma_f32_32x32x16_bf16 v[64:79], v[24:27], v[176:179], v[64:79]
    v_mfma_f32_32x32x16_bf16 v[80:95], v[28:31], v[176:179], v[80:95]
    v_mfma_f32_32x32x16_bf16 v[96:111], v[32:35], v[176:179], v[96:111]
    v_mfma_f32_32x32x16_bf16 v[112:127], v[24:27], v[184:187], v[112:127]
    v_mfma_f32_32x32x16_bf16 v[128:143], v[28:31], v[184:187], v[128:143]
    v_mfma_f32_32x32x16_bf16 v[144:159], v[32:35], v[184:187], v[144:159]
    s_waitcnt lgkmcnt(0)
    v_mfma_f32_32x32x16_bf16 v[64:79], v[36:39], v[180:183], v[64:79]
    v_mfma_f32_32x32x16_bf16 v[80:95], v[40:43], v[180:183], v[80:95]
    v_mfma_f32_32x32x16_bf16 v[96:111], v[44:47], v[180:183], v[96:111]
    v_mfma_f32_32x32x16_bf16 v[112:127], v[36:39], v[188:191], v[112:127]
    v_mfma_f32_32x32x16_bf16 v[128:143], v[40:43], v[188:191], v[128:143]
    v_mfma_f32_32x32x16_bf16 v[144:159], v[44:47], v[188:191], v[144:159]
    s_waitcnt vmcnt(10)
    ds_read_b64_tr_b16 v[24:25], v14 offset:12288
    ds_read_b64_tr_b16 v[26:27], v14 offset:13056
    ds_read_b64_tr_b16 v[28:29], v14 offset:12352
    ds_read_b64_tr_b16 v[30:31], v14 offset:13120
    ds_read_b64_tr_b16 v[32:33], v14 offset:12416
    ds_read_b64_tr_b16 v[34:35], v14 offset:13184
    ds_read_b64_tr_b16 v[36:37], v14 offset:15360
    ds_read_b64_tr_b16 v[38:39], v14 offset:16128
    ds_read_b64_tr_b16 v[40:41], v14 offset:15424
    ds_read_b64_tr_b16 v[42:43], v14 offset:16192
    ds_read_b64_tr_b16 v[44:45], v14 offset:15488
    ds_read_b64_tr_b16 v[46:47], v14 offset:16256
    s_waitcnt lgkmcnt(6)
    v_mfma_f32_32x32x16_bf16 v[64:79], v[24:27], v[192:195], v[64:79]
    v_mfma_f32_32x32x16_bf16 v[80:95], v[28:31], v[192:195], v[80:95]
    v_mfma_f32_32x32x16_bf16 v[96:111], v[32:35], v[192:195], v[96:111]
    v_mfma_f32_32x32x16_bf16 v[112:127], v[24:27], v[200:203], v[112:127]
    v_mfma_f32_32x32x16_bf16 v[128:143], v[28:31], v[200:203], v[128:143]
    v_mfma_f32_32x32x16_bf16 v[144:159], v[32:35], v[200:203], v[144:159]
    s_waitcnt lgkmcnt(0)
    v_mfma_f32_32x32x16_bf16 v[64:79], v[36:39], v[196:199], v[64:79]
    v_mfma_f32_32x32x16_bf16 v[80:95], v[40:43], v[196:199], v[80:95]
    v_mfma_f32_32x32x16_bf16 v[96:111], v[44:47], v[196:199], v[96:111]
    v_mfma_f32_32x32x16_bf16 v[112:127], v[36:39], v[204:207], v[112:127]
    v_mfma_f32_32x32x16_bf16 v[128:143], v[40:43], v[204:207], v[128:143]
    v_mfma_f32_32x32x16_bf16 v[144:159], v[44:47], v[204:207], v[144:159]
    s_waitcnt vmcnt(0)
    ds_read_b64_tr_b16 v[24:25], v14 offset:0
    ds_read_b64_tr_b16 v[26:27], v14 offset:768
    ds_read_b64_tr_b16 v[28:29], v14 offset:64
    ds_read_b64_tr_b16 v[30:31], v14 offset:832
    ds_read_b64_tr_b16 v[32:33], v14 offset:128
    ds_read_b64_tr_b16 v[34:35], v14 offset:896
    ds_read_b64_tr_b16 v[36:37], v14 offset:3072
    ds_read_b64_tr_b16 v[38:39], v14 offset:3840
    ds_read_b64_tr_b16 v[40:41], v14 offset:3136
    ds_read_b64_tr_b16 v[42:43], v14 offset:3904
    ds_read_b64_tr_b16 v[44:45], v14 offset:3200
    ds_read_b64_tr_b16 v[46:47], v14 offset:3968
    s_waitcnt lgkmcnt(6)
    v_mfma_f32_32x32x16_bf16 v[64:79], v[24:27], v[160:163], v[64:79]
    v_mfma_f32_32x32x16_bf16 v[80:95], v[28:31], v[160:163], v[80:95]
    v_mfma_f32_32x32x16_bf16 v[96:111], v[32:35], v[160:163], v[96:111]
    v_mfma_f32_32x32x16_bf16 v[112:127], v[24:27], v[168:171], v[112:127]
    v_mfma_f32_32x32x16_bf16 v[128:143], v[28:31], v[168:171], v[128:143]
    v_mfma_f32_32x32x16_bf16 v[144:159], v[32:35], v[168:171], v[144:159]
    s_waitcnt lgkmcnt(0)
    v_mfma_f32_32x32x16_bf16 v[64:79], v[36:39], v[164:167], v[64:79]
    v_mfma_f32_32x32x16_bf16 v[80:95], v[40:43], v[164:167], v[80:95]
    v_mfma_f32_32x32x16_bf16 v[96:111], v[44:47], v[164:167], v[96:111]
    v_mfma_f32_32x32x16_bf16 v[112:127], v[36:39], v[172:175], v[112:127]
    v_mfma_f32_32x32x16_bf16 v[128:143], v[40:43], v[172:175], v[128:143]
    v_mfma_f32_32x32x16_bf16 v[144:159], v[44:47], v[172:175], v[144:159]
    s_nop 15
    s_nop 3
    v_lshlrev_b32 v16, 4, v1
    s_barrier
    s_and_b32 s50, s40, 3
    s_mul_i32 s50, s50, 24576
    v_add_u32 v17, s50, v16
    s_cmp_lt_u32 s40, 4
    s_cbranch_scc1 L_op_r1b
    ds_write_b128 v17, v[64:67] offset:0
    ds_write_b128 v17, v[68:71] offset:1024
    ds_write_b128 v17, v[72:75] offset:2048
    ds_write_b128 v17, v[76:79] offset:3072
    ds_write_b128 v17, v[80:83] offset:4096
    ds_write_b128 v17, v[84:87] offset:5120
    ds_write_b128 v17, v[88:91] offset:6144
    ds_write_b128 v17, v[92:95] offset:7168
    ds_write_b128 v17, v[96:99] offset:8192
    ds_write_b128 v17, v[100:103] offset:9216
    ds_write_b128 v17, v[104:107] offset:10240
    ds_write_b128 v17, v[108:111] offset:11264
    ds_write_b128 v17, v[112:115] offset:12288
    ds_write_b128 v17, v[116:119] offset:13312
    ds_write_b128 v17, v[120:123] offset:14336
    ds_write_b128 v17, v[124:127] offset:15360
    ds_write_b128 v17, v[128:131] offset:16384
    ds_write_b128 v17, v[132:135] offset:17408
    ds_write_b128 v17, v[136:139] offset:18432
    ds_write_b128 v17, v[140:143] offset:19456
    ds_write_b128 v17, v[144:147] offset:20480
    ds_write_b128 v17, v[148:151] offset:21504
    ds_write_b128 v17, v[152:155] offset:22528
    ds_write_b128 v17, v[156:159] offset:23552
    s_waitcnt lgkmcnt(0)
L_op_r1b:
    s_barrier
    s_cmp_ge_u32 s40, 4
    s_cbranch_scc1 L_op_r2a
    ds_read_b128 v[160:163], v17 offset:0
    ds_read_b128 v[164:167], v17 offset:1024
    ds_read_b128 v[168:171], v17 offset:2048
    ds_read_b128 v[172:175], v17 offset:3072
    ds_read_b128 v[176:179], v17 offset:4096
    ds_read_b128 v[180:183], v17 offset:5120
    ds_read_b128 v[184:187], v17 offset:6144
    ds_read_b128 v[188:191], v17 offset:7168
    ds_read_b128 v[192:195], v17 offset:8192
    ds_read_b128 v[196:199], v17 offset:9216
    ds_read_b128 v[200:203], v17 offset:10240
    ds_read_b128 v[204:207], v17 offset:11264
    ds_read_b128 v[208:211], v17 offset:12288
    ds_read_b128 v[212:215], v17 offset:13312
    ds_read_b128 v[216:219], v17 offset:14336
    ds_read_b128 v[220:223], v17 offset:15360
    ds_read_b128 v[224:227], v17 offset:16384
    ds_read_b128 v[228:231], v17 offset:17408
    ds_read_b128 v[232:235], v17 offset:18432
    ds_read_b128 v[236:239], v17 offset:19456
    ds_read_b128 v[240:243], v17 offset:20480
    ds_read_b128 v[244:247], v17 offset:21504
    ds_read_b128 v[248:251], v17 offset:22528
    ds_read_b128 v[252:255], v17 offset:23552
    s_waitcnt lgkmcnt(0)
    v_add_f32 v64, v64, v160
    v_add_f32 v65, v65, v161
    v_add_f32 v66, v66, v162
    v_add_f32 v67, v67, v163
    v_add_f32 v68, v68, v164
    v_add_f32 v69, v69, v165
    v_add_f32 v70, v70, v166
    v_add_f32 v71, v71, v167
    v_add_f32 v72, v72, v168
    v_add_f32 v73, v73, v169
    v_add_f32 v74, v74, v170
    v_add_f32 v75, v75, v171
    v_add_f32 v76, v76, v172
    v_add_f32 v77, v77, v173
    v_add_f32 v78, v78, v174
    v_add_f32 v79, v79, v175
    v_add_f32 v80, v80, v176
    v_add_f32 v81, v81, v177
    v_add_f32 v82, v82, v178
    v_add_f32 v83, v83, v179
    v_add_f32 v84, v84, v180
    v_add_f32 v85, v85, v181
    v_add_f32 v86, v86, v182
    v_add_f32 v87, v87, v183
    v_add_f32 v88, v88, v184
    v_add_f32 v89, v89, v185
    v_add_f32 v90, v90, v186
    v_add_f32 v91, v91, v187
    v_add_f32 v92, v92, v188
    v_add_f32 v93, v93, v189
    v_add_f32 v94, v94, v190
    v_add_f32 v95, v95, v191
    v_add_f32 v96, v96, v192
    v_add_f32 v97, v97, v193
    v_add_f32 v98, v98, v194
    v_add_f32 v99, v99, v195
    v_add_f32 v100, v100, v196
    v_add_f32 v101, v101, v197
    v_add_f32 v102, v102, v198
    v_add_f32 v103, v103, v199
    v_add_f32 v104, v104, v200
    v_add_f32 v105, v105, v201
    v_add_f32 v106, v106, v202
    v_add_f32 v107, v107, v203
    v_add_f32 v108, v108, v204
    v_add_f32 v109, v109, v205
    v_add_f32 v110, v110, v206
    v_add_f32 v111, v111, v207
    v_add_f32 v112, v112, v208
    v_add_f32 v113, v113, v209
    v_add_f32 v114, v114, v210
    v_add_f32 v115, v115, v211
    v_add_f32 v116, v116, v212
    v_add_f32 v117, v117, v213
    v_add_f32 v118, v118, v214
    v_add_f32 v119, v119, v215
    v_add_f32 v120, v120, v216
    v_add_f32 v121, v121, v217
    v_add_f32 v122, v122, v218
    v_add_f32 v123, v123, v219
    v_add_f32 v124, v124, v220
    v_add_f32 v125, v125, v221
    v_add_f32 v126, v126, v222
    v_add_f32 v127, v127, v223
    v_add_f32 v128, v128, v224
    v_add_f32 v129, v129, v225
    v_add_f32 v130, v130, v226
    v_add_f32 v131, v131, v227
    v_add_f32 v132, v132, v228
    v_add_f32 v133, v133, v229
    v_add_f32 v134, v134, v230
    v_add_f32 v135, v135, v231
    v_add_f32 v136, v136, v232
    v_add_f32 v137, v137, v233
    v_add_f32 v138, v138, v234
    v_add_f32 v139, v139, v235
    v_add_f32 v140, v140, v236
    v_add_f32 v141, v141, v237
    v_add_f32 v142, v142, v238
    v_add_f32 v143, v143, v239
    v_add_f32 v144, v144, v240
    v_add_f32 v145, v145, v241
    v_add_f32 v146, v146, v242
    v_add_f32 v147, v147, v243
    v_add_f32 v148, v148, v244
    v_add_f32 v149, v149, v245
    v_add_f32 v150, v150, v246
    v_add_f32 v151, v151, v247
    v_add_f32 v152, v152, v248
    v_add_f32 v153, v153, v249
    v_add_f32 v154, v154, v250
    v_add_f32 v155, v155, v251
    v_add_f32 v156, v156, v252
    v_add_f32 v157, v157, v253
    v_add_f32 v158, v158, v254
    v_add_f32 v159, v159, v255
L_op_r2a:
    s_barrier
    s_and_b32 s50, s40, 1
    s_mul_i32 s50, s50, 24576
    v_add_u32 v17, s50, v16
    s_lshr_b32 s51, s40, 1
    s_cmp_lg_u32 s51, 1
    s_cbranch_scc1 L_op_r2b
    ds_write_b128 v17, v[64:67] offset:0
    ds_write_b128 v17, v[68:71] offset:1024
    ds_write_b128 v17, v[72:75] offset:2048
    ds_write_b128 v17, v[76:79] offset:3072
    ds_write_b128 v17, v[80:83] offset:4096
    ds_write_b128 v17, v[84:87] offset:5120
    ds_write_b128 v17, v[88:91] offset:6144
    ds_write_b128 v17, v[92:95] offset:7168
    ds_write_b128 v17, v[96:99] offset:8192
    ds_write_b128 v17, v[100:103] offset:9216
    ds_write_b128 v17, v[104:107] offset:10240
    ds_write_b128 v17, v[108:111] offset:11264
    ds_write_b128 v17, v[112:115] offset:12288
    ds_write_b128 v17, v[116:119] offset:13312
    ds_write_b128 v17, v[120:123] offset:14336
    ds_write_b128 v17, v[124:127] offset:15360
    ds_write_b128 v17, v[128:131] offset:16384
    ds_write_b128 v17, v[132:135] offset:17408
    ds_write_b128 v17, v[136:139] offset:18432
    ds_write_b128 v17, v[140:143] offset:19456
    ds_write_b128 v17, v[144:147] offset:20480
    ds_write_b128 v17, v[148:151] offset:21504
    ds_write_b128 v17, v[152:155] offset:22528
    ds_write_b128 v17, v[156:159] offset:23552
    s_waitcnt lgkmcnt(0)
L_op_r2b:
    s_barrier
    s_cmp_ge_u32 s40, 2
    s_cbranch_scc1 L_op_r3a
    ds_read_b128 v[160:163], v17 offset:0
    ds_read_b128 v[164:167], v17 offset:1024
    ds_read_b128 v[168:171], v17 offset:2048
    ds_read_b128 v[172:175], v17 offset:3072
    ds_read_b128 v[176:179], v17 offset:4096
    ds_read_b128 v[180:183], v17 offset:5120
    ds_read_b128 v[184:187], v17 offset:6144
    ds_read_b128 v[188:191], v17 offset:7168
    ds_read_b128 v[192:195], v17 offset:8192
    ds_read_b128 v[196:199], v17 offset:9216
    ds_read_b128 v[200:203], v17 offset:10240
    ds_read_b128 v[204:207], v17 offset:11264
    ds_read_b128 v[208:211], v17 offset:12288
    ds_read_b128 v[212:215], v17 offset:13312
    ds_read_b128 v[216:219], v17 offset:14336
    ds_read_b128 v[220:223], v17 offset:15360
    ds_read_b128 v[224:227], v17 offset:16384
    ds_read_b128 v[228:231], v17 offset:17408
    ds_read_b128 v[232:235], v17 offset:18432
    ds_read_b128 v[236:239], v17 offset:19456
    ds_read_b128 v[240:243], v17 offset:20480
    ds_read_b128 v[244:247], v17 offset:21504
    ds_read_b128 v[248:251], v17 offset:22528
    ds_read_b128 v[252:255], v17 offset:23552
    s_waitcnt lgkmcnt(0)
    v_add_f32 v64, v64, v160
    v_add_f32 v65, v65, v161
    v_add_f32 v66, v66, v162
    v_add_f32 v67, v67, v163
    v_add_f32 v68, v68, v164
    v_add_f32 v69, v69, v165
    v_add_f32 v70, v70, v166
    v_add_f32 v71, v71, v167
    v_add_f32 v72, v72, v168
    v_add_f32 v73, v73, v169
    v_add_f32 v74, v74, v170
    v_add_f32 v75, v75, v171
    v_add_f32 v76, v76, v172
    v_add_f32 v77, v77, v173
    v_add_f32 v78, v78, v174
    v_add_f32 v79, v79, v175
    v_add_f32 v80, v80, v176
    v_add_f32 v81, v81, v177
    v_add_f32 v82, v82, v178
    v_add_f32 v83, v83, v179
    v_add_f32 v84, v84, v180
    v_add_f32 v85, v85, v181
    v_add_f32 v86, v86, v182
    v_add_f32 v87, v87, v183
    v_add_f32 v88, v88, v184
    v_add_f32 v89, v89, v185
    v_add_f32 v90, v90, v186
    v_add_f32 v91, v91, v187
    v_add_f32 v92, v92, v188
    v_add_f32 v93, v93, v189
    v_add_f32 v94, v94, v190
    v_add_f32 v95, v95, v191
    v_add_f32 v96, v96, v192
    v_add_f32 v97, v97, v193
    v_add_f32 v98, v98, v194
    v_add_f32 v99, v99, v195
    v_add_f32 v100, v100, v196
    v_add_f32 v101, v101, v197
    v_add_f32 v102, v102, v198
    v_add_f32 v103, v103, v199
    v_add_f32 v104, v104, v200
    v_add_f32 v105, v105, v201
    v_add_f32 v106, v106, v202
    v_add_f32 v107, v107, v203
    v_add_f32 v108, v108, v204
    v_add_f32 v109, v109, v205
    v_add_f32 v110, v110, v206
    v_add_f32 v111, v111, v207
    v_add_f32 v112, v112, v208
    v_add_f32 v113, v113, v209
    v_add_f32 v114, v114, v210
    v_add_f32 v115, v115, v211
    v_add_f32 v116, v116, v212
    v_add_f32 v117, v117, v213
    v_add_f32 v118, v118, v214
    v_add_f32 v119, v119, v215
    v_add_f32 v120, v120, v216
    v_add_f32 v121, v121, v217
    v_add_f32 v122, v122, v218
    v_add_f32 v123, v123, v219
    v_add_f32 v124, v124, v220
    v_add_f32 v125, v125, v221
    v_add_f32 v126, v126, v222
    v_add_f32 v127, v127, v223
    v_add_f32 v128, v128, v224
    v_add_f32 v129, v129, v225
    v_add_f32 v130, v130, v226
    v_add_f32 v131, v131, v227
    v_add_f32 v132, v132, v228
    v_add_f32 v133, v133, v229
    v_add_f32 v134, v134, v230
    v_add_f32 v135, v135, v231
    v_add_f32 v136, v136, v232
    v_add_f32 v137, v137, v233
    v_add_f32 v138, v138, v234
    v_add_f32 v139, v139, v235
    v_add_f32 v140, v140, v236
    v_add_f32 v141, v141, v237
    v_add_f32 v142, v142, v238
    v_add_f32 v143, v143, v239
    v_add_f32 v144, v144, v240
    v_add_f32 v145, v145, v241
    v_add_f32 v146, v146, v242
    v_add_f32 v147, v147, v243
    v_add_f32 v148, v148, v244
    v_add_f32 v149, v149, v245
    v_add_f32 v150, v150, v246
    v_add_f32 v151, v151, v247
    v_add_f32 v152, v152, v248
    v_add_f32 v153, v153, v249
    v_add_f32 v154, v154, v250
    v_add_f32 v155, v155, v251
    v_add_f32 v156, v156, v252
    v_add_f32 v157, v157, v253
    v_add_f32 v158, v158, v254
    v_add_f32 v159, v159, v255
L_op_r3a:
    s_barrier
    s_cmp_ge_u32 s40, 2
    s_cbranch_scc1 L_op_r3b
    s_cmp_eq_u32 s40, 0
    s_cbranch_scc1 L_op_r3w0
    ds_write_b128 v16, v[64:67] offset:24576
    ds_write_b128 v16, v[68:71] offset:25600
    ds_write_b128 v16, v[72:75] offset:26624
    ds_write_b128 v16, v[76:79] offset:27648
    ds_write_b128 v16, v[80:83] offset:28672
    ds_write_b128 v16, v[84:87] offset:29696
    ds_write_b128 v16, v[88:91] offset:30720
    ds_write_b128 v16, v[92:95] offset:31744
    ds_write_b128 v16, v[96:99] offset:32768
    ds_write_b128 v16, v[100:103] offset:33792
    ds_write_b128 v16, v[104:107] offset:34816
    ds_write_b128 v16, v[108:111] offset:35840
    s_branch L_op_r3w
L_op_r3w0:
    ds_write_b128 v16, v[112:115] offset:0
    ds_write_b128 v16, v[116:119] offset:1024
    ds_write_b128 v16, v[120:123] offset:2048
    ds_write_b128 v16, v[124:127] offset:3072
    ds_write_b128 v16, v[128:131] offset:4096
    ds_write_b128 v16, v[132:135] offset:5120
    ds_write_b128 v16, v[136:139] offset:6144
    ds_write_b128 v16, v[140:143] offset:7168
    ds_write_b128 v16, v[144:147] offset:8192
    ds_write_b128 v16, v[148:151] offset:9216
    ds_write_b128 v16, v[152:155] offset:10240
    ds_write_b128 v16, v[156:159] offset:11264
L_op_r3w:
    s_waitcnt lgkmcnt(0)
L_op_r3b:
    s_barrier
    s_cmp_ge_u32 s40, 2
    s_cbranch_scc1 L_op_end
    s_lshl_b32 s50, s41, 6
    v_and_b32 v18, 31, v1
    v_add_u32 v18, s50, v18
    s_mov_b32 s50, 2304
    v_mul_lo_u32 v18, v18, s50
    s_mul_i32 s50, s42, 192
    v_add_u32 v18, s50, v18
    v_lshrrev_b32 v19, 5, v1
    v_lshl_add_u32 v18, v19, 4, v18
    s_cmp_eq_u32 s40, 0
    s_cbranch_scc0 L_op_f1
    ds_read_b128 v[160:163], v16 offset:24576
    ds_read_b128 v[164:167], v16 offset:25600
    ds_read_b128 v[168:171], v16 offset:26624
    ds_read_b128 v[172:175], v16 offset:27648
    ds_read_b128 v[176:179], v16 offset:28672
    ds_read_b128 v[180:183], v16 offset:29696
    ds_read_b128 v[184:187], v16 offset:30720
    ds_read_b128 v[188:191], v16 offset:31744
    ds_read_b128 v[192:195], v16 offset:32768
    ds_read_b128 v[196:199], v16 offset:33792
    ds_read_b128 v[200:203], v16 offset:34816
    ds_read_b128 v[204:207], v16 offset:35840
    s_waitcnt lgkmcnt(0)
    v_add_f32 v64, v64, v160
    v_add_f32 v65, v65, v161
    v_add_f32 v66, v66, v162
    v_add_f32 v67, v67, v163
    v_add_f32 v68, v68, v164
    v_add_f32 v69, v69, v165
    v_add_f32 v70, v70, v166
    v_add_f32 v71, v71, v167
    v_add_f32 v72, v72, v168
    v_add_f32 v73, v73, v169
    v_add_f32 v74, v74, v170
    v_add_f32 v75, v75, v171
    v_add_f32 v76, v76, v172
    v_add_f32 v77, v77, v173
    v_add_f32 v78, v78, v174
    v_add_f32 v79, v79, v175
    v_add_f32 v80, v80, v176
    v_add_f32 v81, v81, v177
    v_add_f32 v82, v82, v178
    v_add_f32 v83, v83, v179
    v_add_f32 v84, v84, v180
    v_add_f32 v85, v85, v181
    v_add_f32 v86, v86, v182
    v_add_f32 v87, v87, v183
    v_add_f32 v88, v88, v184
    v_add_f32 v89, v89, v185
    v_add_f32 v90, v90, v186
    v_add_f32 v91, v91, v187
    v_add_f32 v92, v92, v188
    v_add_f32 v93, v93, v189
    v_add_f32 v94, v94, v190
    v_add_f32 v95, v95, v191
    v_add_f32 v96, v96, v192
    v_add_f32 v97, v97, v193
    v_add_f32 v98, v98, v194
    v_add_f32 v99, v99, v195
    v_add_f32 v100, v100, v196
    v_add_f32 v101, v101, v197
    v_add_f32 v102, v102, v198
    v_add_f32 v103, v103, v199
    v_add_f32 v104, v104, v200
    v_add_f32 v105, v105, v201
    v_add_f32 v106, v106, v202
    v_add_f32 v107, v107, v203
    v_add_f32 v108, v108, v204
    v_add_f32 v109, v109, v205
    v_add_f32 v110, v110, v206
    v_add_f32 v111, v111, v207
    v_cvt_pk_bf16_f32 v64, v64, v65
    v_cvt_pk_bf16_f32 v65, v66, v67
    v_cvt_pk_bf16_f32 v66, v68, v69
    v_cvt_pk_bf16_f32 v67, v70, v71
    v_cvt_pk_bf16_f32 v72, v72, v73
    v_cvt_pk_bf16_f32 v73, v74, v75
    v_cvt_pk_bf16_f32 v74, v76, v77
    v_cvt_pk_bf16_f32 v75, v78, v79
    s_nop 1
    v_permlane32_swap_b32 v64, v66
    v_permlane32_swap_b32 v65, v67
    v_permlane32_swap_b32 v72, v74
    v_permlane32_swap_b32 v73, v75
    buffer_store_dwordx4 v[64:67], v18, s[12:15], 0 offen offset:0
    buffer_store_dwordx4 v[72:75], v18, s[12:15], 0 offen offset:32
    v_cvt_pk_bf16_f32 v80, v80, v81
    v_cvt_pk_bf16_f32 v81, v82, v83
    v_cvt_pk_bf16_f32 v82, v84, v85
    v_cvt_pk_bf16_f32 v83, v86, v87
    v_cvt_pk_bf16_f32 v88, v88, v89
    v_cvt_pk_bf16_f32 v89, v90, v91
    v_cvt_pk_bf16_f32 v90, v92, v93
    v_cvt_pk_bf16_f32 v91, v94, v95
    s_nop 1
    v_permlane32_swap_b32 v80, v82
    v_permlane32_swap_b32 v81, v83
    v_permlane32_swap_b32 v88, v90
    v_permlane32_swap_b32 v89, v91
    buffer_store_dwordx4 v[80:83], v18, s[12:15], 0 offen offset:64
    buffer_store_dwordx4 v[88:91], v18, s[12:15], 0 offen offset:96
    v_cvt_pk_bf16_f32 v96, v96, v97
    v_cvt_pk_bf16_f32 v97, v98, v99
    v_cvt_pk_bf16_f32 v98, v100, v101
    v_cvt_pk_bf16_f32 v99, v102, v103
    v_cvt_pk_bf16_f32 v104, v104, v105
    v_cvt_pk_bf16_f32 v105, v106, v107
    v_cvt_pk_bf16_f32 v106, v108, v109
    v_cvt_pk_bf16_f32 v107, v110, v111
    s_nop 1
    v_permlane32_swap_b32 v96, v98
    v_permlane32_swap_b32 v97, v99
    v_permlane32_swap_b32 v104, v106
    v_permlane32_swap_b32 v105, v107
    buffer_store_dwordx4 v[96:99], v18, s[12:15], 0 offen offset:128
    buffer_store_dwordx4 v[104:107], v18, s[12:15], 0 offen offset:160
    s_branch L_op_end
L_op_f1:
    ds_read_b128 v[160:163], v16 offset:0
    ds_read_b128 v[164:167], v16 offset:1024
    ds_read_b128 v[168:171], v16 offset:2048
    ds_read_b128 v[172:175], v16 offset:3072
    ds_read_b128 v[176:179], v16 offset:4096
    ds_read_b128 v[180:183], v16 offset:5120
    ds_read_b128 v[184:187], v16 offset:6144
    ds_read_b128 v[188:191], v16 offset:7168
    ds_read_b128 v[192:195], v16 offset:8192
    ds_read_b128 v[196:199], v16 offset:9216
    ds_read_b128 v[200:203], v16 offset:10240
    ds_read_b128 v[204:207], v16 offset:11264
    s_waitcnt lgkmcnt(0)
    v_add_f32 v112, v112, v160
    v_add_f32 v113, v113, v161
    v_add_f32 v114, v114, v162
    v_add_f32 v115, v115, v163
    v_add_f32 v116, v116, v164
    v_add_f32 v117, v117, v165
    v_add_f32 v118, v118, v166
    v_add_f32 v119, v119, v167
    v_add_f32 v120, v120, v168
    v_add_f32 v121, v121, v169
    v_add_f32 v122, v122, v170
    v_add_f32 v123, v123, v171
    v_add_f32 v124, v124, v172
    v_add_f32 v125, v125, v173
    v_add_f32 v126, v126, v174
    v_add_f32 v127, v127, v175
    v_add_f32 v128, v128, v176
    v_add_f32 v129, v129, v177
    v_add_f32 v130, v130, v178
    v_add_f32 v131, v131, v179
    v_add_f32 v132, v132, v180
    v_add_f32 v133, v133, v181
    v_add_f32 v134, v134, v182
    v_add_f32 v135, v135, v183
    v_add_f32 v136, v136, v184
    v_add_f32 v137, v137, v185
    v_add_f32 v138, v138, v186
    v_add_f32 v139, v139, v187
    v_add_f32 v140, v140, v188
    v_add_f32 v141, v141, v189
    v_add_f32 v142, v142, v190
    v_add_f32 v143, v143, v191
    v_add_f32 v144, v144, v192
    v_add_f32 v145, v145, v193
    v_add_f32 v146, v146, v194
    v_add_f32 v147, v147, v195
    v_add_f32 v148, v148, v196
    v_add_f32 v149, v149, v197
    v_add_f32 v150, v150, v198
    v_add_f32 v151, v151, v199
    v_add_f32 v152, v152, v200
    v_add_f32 v153, v153, v201
    v_add_f32 v154, v154, v202
    v_add_f32 v155, v155, v203
    v_add_f32 v156, v156, v204
    v_add_f32 v157, v157, v205
    v_add_f32 v158, v158, v206
    v_add_f32 v159, v159, v207
    v_add_u32 v18, 73728, v18
    v_cvt_pk_bf16_f32 v112, v112, v113
    v_cvt_pk_bf16_f32 v113, v114, v115
    v_cvt_pk_bf16_f32 v114, v116, v117
    v_cvt_pk_bf16_f32 v115, v118, v119
    v_cvt_pk_bf16_f32 v120, v120, v121
    v_cvt_pk_bf16_f32 v121, v122, v123
    v_cvt_pk_bf16_f32 v122, v124, v125
    v_cvt_pk_bf16_f32 v123, v126, v127
    s_nop 1
    v_permlane32_swap_b32 v112, v114
    v_permlane32_swap_b32 v113, v115
    v_permlane32_swap_b32 v120, v122
    v_permlane32_swap_b32 v121, v123
    buffer_store_dwordx4 v[112:115], v18, s[12:15], 0 offen offset:0
    buffer_store_dwordx4 v[120:123], v18, s[12:15], 0 offen offset:32
    v_cvt_pk_bf16_f32 v128, v128, v129
    v_cvt_pk_bf16_f32 v129, v130, v131
    v_cvt_pk_bf16_f32 v130, v132, v133
    v_cvt_pk_bf16_f32 v131, v134, v135
    v_cvt_pk_bf16_f32 v136, v136, v137
    v_cvt_pk_bf16_f32 v137, v138, v139
    v_cvt_pk_bf16_f32 v138, v140, v141
    v_cvt_pk_bf16_f32 v139, v142, v143
    s_nop 1
    v_permlane32_swap_b32 v128, v130
    v_permlane32_swap_b32 v129, v131
    v_permlane32_swap_b32 v136, v138
    v_permlane32_swap_b32 v137, v139
    buffer_store_dwordx4 v[128:131], v18, s[12:15], 0 offen offset:64
    buffer_store_dwordx4 v[136:139], v18, s[12:15], 0 offen offset:96
    v_cvt_pk_bf16_f32 v144, v144, v145
    v_cvt_pk_bf16_f32 v145, v146, v147
    v_cvt_pk_bf16_f32 v146, v148, v149
    v_cvt_pk_bf16_f32 v147, v150, v151
    v_cvt_pk_bf16_f32 v152, v152, v153
    v_cvt_pk_bf16_f32 v153, v154, v155
    v_cvt_pk_bf16_f32 v154, v156, v157
    v_cvt_pk_bf16_f32 v155, v158, v159
    s_nop 1
    v_permlane32_swap_b32 v144, v146
    v_permlane32_swap_b32 v145, v147
    v_permlane32_swap_b32 v152, v154
    v_permlane32_swap_b32 v153, v155
    buffer_store_dwordx4 v[144:147], v18, s[12:15], 0 offen offset:128
    buffer_store_dwordx4 v[152:155], v18, s[12:15], 0 offen offset:160
    s_branch L_op_end
L_op_b3:
    s_load_dwordx2 s[24:25], s[0:1], 72
    s_load_dwordx2 s[26:27], s[0:1], 88
    v_and_b32 v1, 63, v0
    v_lshrrev_b32 v2, 6, v0
    s_nop 1
    v_readfirstlane_b32 s40, v2
    s_sub_u32 s50, s2, 192
    s_lshr_b32 s41, s50, 1
    s_and_b32 s42, s50, 1
    s_waitcnt lgkmcnt(0)
    s_add_u32 s4, s26, 75497472
    s_addc_u32 s5, s27, 0
    s_and_b32 s5, s5, 0xffff
    s_mov_b32 s6, 2621440
    s_mov_b32 s7, 0x00020000
    s_add_u32 s8, s26, 85983232
    s_addc_u32 s9, s27, 0
    s_and_b32 s9, s9, 0xffff
    s_mov_b32 s10, 368640
    s_mov_b32 s11, 0x00020000
    s_add_u32 s12, s26, 87031808
    s_addc_u32 s13, s27, 0
    s_and_b32 s13, s13, 0xffff
    s_mov_b32 s14, 368640
    s_mov_b32 s15, 0x00020000
    s_mov_b32 s16, s24
    s_and_b32 s17, s25, 0xffff
    s_mov_b32 s18, 4718592
    s_mov_b32 s19, 0x00020000
    s_mov_b32 s52, 97612894
    s_mul_i32 s53, s40, 704
    s_lshl_b32 s54, s41, 1
    v_add_u32 v2, s53, v1
    v_add_u32 v2, 0, v2
    v_mul_hi_u32 v3, v2, s52
    v_mul_u32_u24 v4, 44, v3
    v_sub_u32 v4, v2, v4
    v_min_u32 v4, 39, v4
    v_and_b32 v5, 63, v3
    v_lshlrev_b32 v5, 6, v5
    v_add_u32 v5, s54, v5
    v_lshrrev_b32 v3, 6, v3
    v_add_u32 v5, v5, v3
    v_mul_u32_u24 v5, 640, v5
    v_lshl_add_u32 v5, v4, 4, v5
    s_mul_i32 s50, s40, 11264
    s_add_u32 m0, s50, 0
    s_nop 0
    buffer_load_dwordx4 v5, s[4:7], 0 offen lds
    v_add_u32 v2, s53, v1
    v_add_u32 v2, 64, v2
    v_mul_hi_u32 v3, v2, s52
    v_mul_u32_u24 v4, 44, v3
    v_sub_u32 v4, v2, v4
    v_min_u32 v4, 39, v4
    v_and_b32 v5, 63, v3
    v_lshlrev_b32 v5, 6, v5
    v_add_u32 v5, s54, v5
    v_lshrrev_b32 v3, 6, v3
    v_add_u32 v5, v5, v3
    v_mul_u32_u24 v5, 640, v5
    v_lshl_add_u32 v5, v4, 4, v5
    s_mul_i32 s50, s40, 11264
    s_add_u32 m0, s50, 1024
    s_nop 0
    buffer_load_dwordx4 v5, s[4:7], 0 offen lds
    v_add_u32 v2, s53, v1
    v_add_u32 v2, 128, v2
    v_mul_hi_u32 v3, v2, s52
    v_mul_u32_u24 v4, 44, v3
    v_sub_u32 v4, v2, v4
    v_min_u32 v4, 39, v4
    v_and_b32 v5, 63, v3
    v_lshlrev_b32 v5, 6, v5
    v_add_u32 v5, s54, v5
    v_lshrrev_b32 v3, 6, v3
    v_add_u32 v5, v5, v3
    v_mul_u32_u24 v5, 640, v5
    v_lshl_add_u32 v5, v4, 4, v5
    s_mul_i32 s50, s40, 11264
    s_add_u32 m0, s50, 2048
    s_nop 0
    buffer_load_dwordx4 v5, s[4:7], 0 offen lds
    v_add_u32 v2, s53, v1
    v_add_u32 v2, 192, v2
    v_mul_hi_u32 v3, v2, s52
    v_mul_u32_u24 v4, 44, v3
    v_sub_u32 v4, v2, v4
    v_min_u32 v4, 39, v4
    v_and_b32 v5, 63, v3
    v_lshlrev_b32 v5, 6, v5
    v_add_u32 v5, s54, v5
    v_lshrrev_b32 v3, 6, v3
    v_add_u32 v5, v5, v3
    v_mul_u32_u24 v5, 640, v5
    v_lshl_add_u32 v5, v4, 4, v5
    s_mul_i32 s50, s40, 11264
    s_add_u32 m0, s50, 3072
    s_nop 0
    buffer_load_dwordx4 v5, s[4:7], 0 offen lds
    v_add_u32 v2, s53, v1
    v_add_u32 v2, 256, v2
    v_mul_hi_u32 v3, v2, s52
    v_mul_u32_u24 v4, 44, v3
    v_sub_u32 v4, v2, v4
    v_min_u32 v4, 39, v4
    v_and_b32 v5, 63, v3
    v_lshlrev_b32 v5, 6, v5
    v_add_u32 v5, s54, v5
    v_lshrrev_b32 v3, 6, v3
    v_add_u32 v5, v5, v3
    v_mul_u32_u24 v5, 640, v5
    v_lshl_add_u32 v5, v4, 4, v5
    s_mul_i32 s50, s40, 11264
    s_add_u32 m0, s50, 4096
    s_nop 0
    buffer_load_dwordx4 v5, s[4:7], 0 offen lds
    v_add_u32 v2, s53, v1
    v_add_u32 v2, 320, v2
    v_mul_hi_u32 v3, v2, s52
    v_mul_u32_u24 v4, 44, v3
    v_sub_u32 v4, v2, v4
    v_min_u32 v4, 39, v4
    v_and_b32 v5, 63, v3
    v_lshlrev_b32 v5, 6, v5
    v_add_u32 v5, s54, v5
    v_lshrrev_b32 v3, 6, v3
    v_add_u32 v5, v5, v3
    v_mul_u32_u24 v5, 640, v5
    v_lshl_add_u32 v5, v4, 4, v5
    s_mul_i32 s50, s40, 11264
    s_add_u32 m0, s50, 5120
    s_nop 0
    buffer_load_dwordx4 v5, s[4:7], 0 offen lds
    v_add_u32 v2, s53, v1
    v_add_u32 v2, 384, v2
    v_mul_hi_u32 v3, v2, s52
    v_mul_u32_u24 v4, 44, v3
    v_sub_u32 v4, v2, v4
    v_min_u32 v4, 39, v4
    v_and_b32 v5, 63, v3
    v_lshlrev_b32 v5, 6, v5
    v_add_u32 v5, s54, v5
    v_lshrrev_b32 v3, 6, v3
    v_add_u32 v5, v5, v3
    v_mul_u32_u24 v5, 640, v5
    v_lshl_add_u32 v5, v4, 4, v5
    s_mul_i32 s50, s40, 11264
    s_add_u32 m0, s50, 6144
    s_nop 0
    buffer_load_dwordx4 v5, s[4:7], 0 offen lds
    v_add_u32 v2, s53, v1
    v_add_u32 v2, 448, v2
    v_mul_hi_u32 v3, v2, s52
    v_mul_u32_u24 v4, 44, v3
    v_sub_u32 v4, v2, v4
    v_min_u32 v4, 39, v4
    v_and_b32 v5, 63, v3
    v_lshlrev_b32 v5, 6, v5
    v_add_u32 v5, s54, v5
    v_lshrrev_b32 v3, 6, v3
    v_add_u32 v5, v5, v3
    v_mul_u32_u24 v5, 640, v5
    v_lshl_add_u32 v5, v4, 4, v5
    s_mul_i32 s50, s40, 11264
    s_add_u32 m0, s50, 7168
    s_nop 0
    buffer_load_dwordx4 v5, s[4:7], 0 offen lds
    v_add_u32 v2, s53, v1
    v_add_u32 v2, 512, v2
    v_mul_hi_u32 v3, v2, s52
    v_mul_u32_u24 v4, 44, v3
    v_sub_u32 v4, v2, v4
    v_min_u32 v4, 39, v4
    v_and_b32 v5, 63, v3
    v_lshlrev_b32 v5, 6, v5
    v_add_u32 v5, s54, v5
    v_lshrrev_b32 v3, 6, v3
    v_add_u32 v5, v5, v3
    v_mul_u32_u24 v5, 640, v5
    v_lshl_add_u32 v5, v4, 4, v5
    s_mul_i32 s50, s40, 11264
    s_add_u32 m0, s50, 8192
    s_nop 0
    buffer_load_dwordx4 v5, s[4:7], 0 offen lds
    v_add_u32 v2, s53, v1
    v_add_u32 v2, 576, v2
    v_mul_hi_u32 v3, v2, s52
    v_mul_u32_u24 v4, 44, v3
    v_sub_u32 v4, v2, v4
    v_min_u32 v4, 39, v4
    v_and_b32 v5, 63, v3
    v_lshlrev_b32 v5, 6, v5
    v_add_u32 v5, s54, v5
    v_lshrrev_b32 v3, 6, v3
    v_add_u32 v5, v5, v3
    v_mul_u32_u24 v5, 640, v5
    v_lshl_add_u32 v5, v4, 4, v5
    s_mul_i32 s50, s40, 11264
    s_add_u32 m0, s50, 9216
    s_nop 0
    buffer_load_dwordx4 v5, s[4:7], 0 offen lds
    v_add_u32 v2, s53, v1
    v_add_u32 v2, 640, v2
    v_mul_hi_u32 v3, v2, s52
    v_mul_u32_u24 v4, 44, v3
    v_sub_u32 v4, v2, v4
    v_min_u32 v4, 39, v4
    v_and_b32 v5, 63, v3
    v_lshlrev_b32 v5, 6, v5
    v_add_u32 v5, s54, v5
    v_lshrrev_b32 v3, 6, v3
    v_add_u32 v5, v5, v3
    v_mul_u32_u24 v5, 640, v5
    v_lshl_add_u32 v5, v4, 4, v5
    s_mul_i32 s50, s40, 11264
    s_add_u32 m0, s50, 10240
    s_nop 0
    buffer_load_dwordx4 v5, s[4:7], 0 offen lds
    v_and_b32 v3, 31, v1
    v_lshrrev_b32 v4, 5, v1
    s_lshl_b32 s50, s42, 5
    v_add_u32 v5, s50, v3
    v_lshlrev_b32 v5, 5, v5
    v_add_u32 v5, s41, v5
    v_lshl_add_u32 v6, v4, 3, 0
    v_mul_u32_u24 v6, v6, v5
    v_and_b32 v6, 2047, v6
    v_cvt_f32_u32 v6, v6
    v_mul_f32 v6, 0x3a000000, v6
    v_lshl_add_u32 v7, v4, 3, 1
    v_mul_u32_u24 v7, v7, v5
    v_and_b32 v7, 2047, v7
    v_cvt_f32_u32 v7, v7
    v_mul_f32 v7, 0x3a000000, v7
    v_cos_f32 v8, v6
    v_cos_f32 v9, v7
    v_sin_f32 v10, v6
    v_sin_f32 v11, v7
    s_nop 0
    v_cvt_pk_bf16_f32 v16, v8, v9
    v_cvt_pk_bf16_f32 v32, v10, v11
    v_lshl_add_u32 v6, v4, 3, 2
    v_mul_u32_u24 v6, v6, v5
    v_and_b32 v6, 2047, v6
    v_cvt_f32_u32 v6, v6
    v_mul_f32 v6, 0x3a000000, v6
    v_lshl_add_u32 v7, v4, 3, 3
    v_mul_u32_u24 v7, v7, v5
    v_and_b32 v7, 2047, v7
    v_cvt_f32_u32 v7, v7
    v_mul_f32 v7, 0x3a000000, v7
    v_cos_f32 v8, v6
    v_cos_f32 v9, v7
    v_sin_f32 v10, v6
    v_sin_f32 v11, v7
    s_nop 0
    v_cvt_pk_bf16_f32 v17, v8, v9
    v_cvt_pk_bf16_f32 v33, v10, v11
    v_lshl_add_u32 v6, v4, 3, 4
    v_mul_u32_u24 v6, v6, v5
    v_and_b32 v6, 2047, v6
    v_cvt_f32_u32 v6, v6
    v_mul_f32 v6, 0x3a000000, v6
    v_lshl_add_u32 v7, v4, 3, 5
    v_mul_u32_u24 v7, v7, v5
    v_and_b32 v7, 2047, v7
    v_cvt_f32_u32 v7, v7
    v_mul_f32 v7, 0x3a000000, v7
    v_cos_f32 v8, v6
    v_cos_f32 v9, v7
    v_sin_f32 v10, v6
    v_sin_f32 v11, v7
    s_nop 0
    v_cvt_pk_bf16_f32 v18, v8, v9
    v_cvt_pk_bf16_f32 v34, v10, v11
    v_lshl_add_u32 v6, v4, 3, 6
    v_mul_u32_u24 v6, v6, v5
    v_and_b32 v6, 2047, v6
    v_cvt_f32_u32 v6, v6
    v_mul_f32 v6, 0x3a000000, v6
    v_lshl_add_u32 v7, v4, 3, 7
    v_mul_u32_u24 v7, v7, v5
    v_and_b32 v7, 2047, v7
    v_cvt_f32_u32 v7, v7
    v_mul_f32 v7, 0x3a000000, v7
    v_cos_f32 v8, v6
    v_cos_f32 v9, v7
    v_sin_f32 v10, v6
    v_sin_f32 v11, v7
    s_nop 0
    v_cvt_pk_bf16_f32 v19, v8, v9
    v_cvt_pk_bf16_f32 v35, v10, v11
    v_lshl_add_u32 v6, v4, 3, 16
    v_mul_u32_u24 v6, v6, v5
    v_and_b32 v6, 2047, v6
    v_cvt_f32_u32 v6, v6
    v_mul_f32 v6, 0x3a000000, v6
    v_lshl_add_u32 v7, v4, 3, 17
    v_mul_u32_u24 v7, v7, v5
    v_and_b32 v7, 2047, v7
    v_cvt_f32_u32 v7, v7
    v_mul_f32 v7, 0x3a000000, v7
    v_cos_f32 v8, v6
    v_cos_f32 v9, v7
    v_sin_f32 v10, v6
    v_sin_f32 v11, v7
    s_nop 0
    v_cvt_pk_bf16_f32 v20, v8, v9
    v_cvt_pk_bf16_f32 v36, v10, v11
    v_lshl_add_u32 v6, v4, 3, 18
    v_mul_u32_u24 v6, v6, v5
    v_and_b32 v6, 2047, v6
    v_cvt_f32_u32 v6, v6
    v_mul_f32 v6, 0x3a000000, v6
    v_lshl_add_u32 v7, v4, 3, 19
    v_mul_u32_u24 v7, v7, v5
    v_and_b32 v7, 2047, v7
    v_cvt_f32_u32 v7, v7
    v_mul_f32 v7, 0x3a000000, v7
    v_cos_f32 v8, v6
    v_cos_f32 v9, v7
    v_sin_f32 v10, v6
    v_sin_f32 v11, v7
    s_nop 0
    v_cvt_pk_bf16_f32 v21, v8, v9
    v_cvt_pk_bf16_f32 v37, v10, v11
    v_lshl_add_u32 v6, v4, 3, 20
    v_mul_u32_u24 v6, v6, v5
    v_and_b32 v6, 2047, v6
    v_cvt_f32_u32 v6, v6
    v_mul_f32 v6, 0x3a000000, v6
    v_lshl_add_u32 v7, v4, 3, 21
    v_mul_u32_u24 v7, v7, v5
    v_and_b32 v7, 2047, v7
    v_cvt_f32_u32 v7, v7
    v_mul_f32 v7, 0x3a000000, v7
    v_cos_f32 v8, v6
    v_cos_f32 v9, v7
    v_sin_f32 v10, v6
    v_sin_f32 v11, v7
    s_nop 0
    v_cvt_pk_bf16_f32 v22, v8, v9
    v_cvt_pk_bf16_f32 v38, v10, v11
    v_lshl_add_u32 v6, v4, 3, 22
    v_mul_u32_u24 v6, v6, v5
    v_and_b32 v6, 2047, v6
    v_cvt_f32_u32 v6, v6
    v_mul_f32 v6, 0x3a000000, v6
    v_lshl_add_u32 v7, v4, 3, 23
    v_mul_u32_u24 v7, v7, v5
    v_and_b32 v7, 2047, v7
    v_cvt_f32_u32 v7, v7
    v_mul_f32 v7, 0x3a000000, v7
    v_cos_f32 v8, v6
    v_cos_f32 v9, v7
    v_sin_f32 v10, v6
    v_sin_f32 v11, v7
    s_nop 0
    v_cvt_pk_bf16_f32 v23, v8, v9
    v_cvt_pk_bf16_f32 v39, v10, v11
    v_lshl_add_u32 v6, v4, 3, 32
    v_mul_u32_u24 v6, v6, v5
    v_and_b32 v6, 2047, v6
    v_cvt_f32_u32 v6, v6
    v_mul_f32 v6, 0x3a000000, v6
    v_lshl_add_u32 v7, v4, 3, 33
    v_mul_u32_u24 v7, v7, v5
    v_and_b32 v7, 2047, v7
    v_cvt_f32_u32 v7, v7
    v_mul_f32 v7, 0x3a000000, v7
    v_cos_f32 v8, v6
    v_cos_f32 v9, v7
    v_sin_f32 v10, v6
    v_sin_f32 v11, v7
    s_nop 0
    v_cvt_pk_bf16_f32 v24, v8, v9
    v_cvt_pk_bf16_f32 v40, v10, v11
    v_lshl_add_u32 v6, v4, 3, 34
    v_mul_u32_u24 v6, v6, v5
    v_and_b32 v6, 2047, v6
    v_cvt_f32_u32 v6, v6
    v_mul_f32 v6, 0x3a000000, v6
    v_lshl_add_u32 v7, v4, 3, 35
    v_mul_u32_u24 v7, v7, v5
    v_and_b32 v7, 2047, v7
    v_cvt_f32_u32 v7, v7
    v_mul_f32 v7, 0x3a000000, v7
    v_cos_f32 v8, v6
    v_cos_f32 v9, v7
    v_sin_f32 v10, v6
    v_sin_f32 v11, v7
    s_nop 0
    v_cvt_pk_bf16_f32 v25, v8, v9
    v_cvt_pk_bf16_f32 v41, v10, v11
    v_lshl_add_u32 v6, v4, 3, 36
    v_mul_u32_u24 v6, v6, v5
    v_and_b32 v6, 2047, v6
    v_cvt_f32_u32 v6, v6
    v_mul_f32 v6, 0x3a000000, v6
    v_lshl_add_u32 v7, v4, 3, 37
    v_mul_u32_u24 v7, v7, v5
    v_and_b32 v7, 2047, v7
    v_cvt_f32_u32 v7, v7
    v_mul_f32 v7, 0x3a000000, v7
    v_cos_f32 v8, v6
    v_cos_f32 v9, v7
    v_sin_f32 v10, v6
    v_sin_f32 v11, v7
    s_nop 0
    v_cvt_pk_bf16_f32 v26, v8, v9
    v_cvt_pk_bf16_f32 v42, v10, v11
    v_lshl_add_u32 v6, v4, 3, 38
    v_mul_u32_u24 v6, v6, v5
    v_and_b32 v6, 2047, v6
    v_cvt_f32_u32 v6, v6
    v_mul_f32 v6, 0x3a000000, v6
    v_lshl_add_u32 v7, v4, 3, 39
    v_mul_u32_u24 v7, v7, v5
    v_and_b32 v7, 2047, v7
    v_cvt_f32_u32 v7, v7
    v_mul_f32 v7, 0x3a000000, v7
    v_cos_f32 v8, v6
    v_cos_f32 v9, v7
    v_sin_f32 v10, v6
    v_sin_f32 v11, v7
    s_nop 0
    v_cvt_pk_bf16_f32 v27, v8, v9
    v_cvt_pk_bf16_f32 v43, v10, v11
    v_lshl_add_u32 v6, v4, 3, 48
    v_mul_u32_u24 v6, v6, v5
    v_and_b32 v6, 2047, v6
    v_cvt_f32_u32 v6, v6
    v_mul_f32 v6, 0x3a000000, v6
    v_lshl_add_u32 v7, v4, 3, 49
    v_mul_u32_u24 v7, v7, v5
    v_and_b32 v7, 2047, v7
    v_cvt_f32_u32 v7, v7
    v_mul_f32 v7, 0x3a000000, v7
    v_cos_f32 v8, v6
    v_cos_f32 v9, v7
    v_sin_f32 v10, v6
    v_sin_f32 v11, v7
    s_nop 0
    v_cvt_pk_bf16_f32 v28, v8, v9
    v_cvt_pk_bf16_f32 v44, v10, v11
    v_lshl_add_u32 v6, v4, 3, 50
    v_mul_u32_u24 v6, v6, v5
    v_and_b32 v6, 2047, v6
    v_cvt_f32_u32 v6, v6
    v_mul_f32 v6, 0x3a000000, v6
    v_lshl_add_u32 v7, v4, 3, 51
    v_mul_u32_u24 v7, v7, v5
    v_and_b32 v7, 2047, v7
    v_cvt_f32_u32 v7, v7
    v_mul_f32 v7, 0x3a000000, v7
    v_cos_f32 v8, v6
    v_cos_f32 v9, v7
    v_sin_f32 v10, v6
    v_sin_f32 v11, v7
    s_nop 0
    v_cvt_pk_bf16_f32 v29, v8, v9
    v_cvt_pk_bf16_f32 v45, v10, v11
    v_lshl_add_u32 v6, v4, 3, 52
    v_mul_u32_u24 v6, v6, v5
    v_and_b32 v6, 2047, v6
    v_cvt_f32_u32 v6, v6
    v_mul_f32 v6, 0x3a000000, v6
    v_lshl_add_u32 v7, v4, 3, 53
    v_mul_u32_u24 v7, v7, v5
    v_and_b32 v7, 2047, v7
    v_cvt_f32_u32 v7, v7
    v_mul_f32 v7, 0x3a000000, v7
    v_cos_f32 v8, v6
    v_cos_f32 v9, v7
    v_sin_f32 v10, v6
    v_sin_f32 v11, v7
    s_nop 0
    v_cvt_pk_bf16_f32 v30, v8, v9
    v_cvt_pk_bf16_f32 v46, v10, v11
    v_lshl_add_u32 v6, v4, 3, 54
    v_mul_u32_u24 v6, v6, v5
    v_and_b32 v6, 2047, v6
    v_cvt_f32_u32 v6, v6
    v_mul_f32 v6, 0x3a000000, v6
    v_lshl_add_u32 v7, v4, 3, 55
    v_mul_u32_u24 v7, v7, v5
    v_and_b32 v7, 2047, v7
    v_cvt_f32_u32 v7, v7
    v_mul_f32 v7, 0x3a000000, v7
    v_cos_f32 v8, v6
    v_cos_f32 v9, v7
    v_sin_f32 v10, v6
    v_sin_f32 v11, v7
    s_nop 0
    v_cvt_pk_bf16_f32 v31, v8, v9
    v_cvt_pk_bf16_f32 v47, v10, v11
    v_lshrrev_b32 v2, 5, v1
    v_lshlrev_b32 v2, 3, v2
    v_bfe_u32 v6, v1, 2, 2
    v_add_u32 v2, v2, v6
    v_mul_u32_u24 v2, 704, v2
    v_bfe_u32 v6, v1, 4, 1
    v_lshl_add_u32 v2, v6, 5, v2
    v_and_b32 v6, 3, v1
    v_lshl_add_u32 v224, v6, 3, v2
    v_add_u32 v226, 45056, v224
    v_lshlrev_b32 v225, 4, v1
    v_mov_b32 v80, 0
    v_mov_b32 v81, 0
    v_mov_b32 v82, 0
    v_mov_b32 v83, 0
    v_mov_b32 v84, 0
    v_mov_b32 v85, 0
    v_mov_b32 v86, 0
    v_mov_b32 v87, 0
    v_mov_b32 v88, 0
    v_mov_b32 v89, 0
    v_mov_b32 v90, 0
    v_mov_b32 v91, 0
    v_mov_b32 v92, 0
    v_mov_b32 v93, 0
    v_mov_b32 v94, 0
    v_mov_b32 v95, 0
    v_mov_b32 v96, 0
    v_mov_b32 v97, 0
    v_mov_b32 v98, 0
    v_mov_b32 v99, 0
    v_mov_b32 v100, 0
    v_mov_b32 v101, 0
    v_mov_b32 v102, 0
    v_mov_b32 v103, 0
    v_mov_b32 v104, 0
    v_mov_b32 v105, 0
    v_mov_b32 v106, 0
    v_mov_b32 v107, 0
    v_mov_b32 v108, 0
    v_mov_b32 v109, 0
    v_mov_b32 v110, 0
    v_mov_b32 v111, 0
    v_mov_b32 v112, 0
    v_mov_b32 v113, 0
    v_mov_b32 v114, 0
    v_mov_b32 v115, 0
    v_mov_b32 v116, 0
    v_mov_b32 v117, 0
    v_mov_b32 v118, 0
    v_mov_b32 v119, 0
    v_mov_b32 v120, 0
    v_mov_b32 v121, 0
    v_mov_b32 v122, 0
    v_mov_b32 v123, 0
    v_mov_b32 v124, 0
    v_mov_b32 v125, 0
    v_mov_b32 v126, 0
    v_mov_b32 v127, 0
    s_waitcnt vmcnt(0)
    s_barrier
    s_cmp_ge_u32 s40, 6
    s_cbranch_scc1 L_b3_end_oproj_kernel_1
    s_mul_i32 s44, s40, 61440
    s_add_u32 s50, s44, 0
    buffer_load_dwordx4 v[176:179], v225, s[8:11], s50 offen offset:0
    buffer_load_dwordx4 v[180:183], v225, s[12:15], s50 offen offset:0
    s_add_u32 s50, s44, 0
    buffer_load_dwordx4 v[184:187], v225, s[8:11], s50 offen offset:1024
    buffer_load_dwordx4 v[188:191], v225, s[12:15], s50 offen offset:1024
    s_add_u32 s50, s44, 20480
    buffer_load_dwordx4 v[192:195], v225, s[8:11], s50 offen offset:0
    buffer_load_dwordx4 v[196:199], v225, s[12:15], s50 offen offset:0
    s_add_u32 s50, s44, 20480
    buffer_load_dwordx4 v[200:203], v225, s[8:11], s50 offen offset:1024
    buffer_load_dwordx4 v[204:207], v225, s[12:15], s50 offen offset:1024
    s_add_u32 s50, s44, 40960
    buffer_load_dwordx4 v[208:211], v225, s[8:11], s50 offen offset:0
    buffer_load_dwordx4 v[212:215], v225, s[12:15], s50 offen offset:0
    s_add_u32 s50, s44, 40960
    buffer_load_dwordx4 v[216:219], v225, s[8:11], s50 offen offset:1024
    buffer_load_dwordx4 v[220:223], v225, s[12:15], s50 offen offset:1024
    ds_read_b64_tr_b16 v[128:129], v224 offset:0
    ds_read_b64_tr_b16 v[130:131], v224 offset:2816
    ds_read_b64_tr_b16 v[132:133], v224 offset:11264
    ds_read_b64_tr_b16 v[134:135], v224 offset:14080
    ds_read_b64_tr_b16 v[136:137], v224 offset:22528
    ds_read_b64_tr_b16 v[138:139], v224 offset:25344
    ds_read_b64_tr_b16 v[140:141], v224 offset:33792
    ds_read_b64_tr_b16 v[142:143], v224 offset:36608
    ds_read_b64_tr_b16 v[144:145], v226 offset:0
    ds_read_b64_tr_b16 v[146:147], v226 offset:2816
    ds_read_b64_tr_b16 v[148:149], v226 offset:11264
    ds_read_b64_tr_b16 v[150:151], v226 offset:14080
    ds_read_b64_tr_b16 v[152:153], v226 offset:22528
    ds_read_b64_tr_b16 v[154:155], v226 offset:25344
    ds_read_b64_tr_b16 v[156:157], v226 offset:33792
    ds_read_b64_tr_b16 v[158:159], v226 offset:36608
    s_waitcnt lgkmcnt(0)
    v_xor_b32 v160, 0x80008000, v144
    v_xor_b32 v161, 0x80008000, v145
    v_xor_b32 v162, 0x80008000, v146
    v_xor_b32 v163, 0x80008000, v147
    v_xor_b32 v164, 0x80008000, v148
    v_xor_b32 v165, 0x80008000, v149
    v_xor_b32 v166, 0x80008000, v150
    v_xor_b32 v167, 0x80008000, v151
    v_xor_b32 v168, 0x80008000, v152
    v_xor_b32 v169, 0x80008000, v153
    v_xor_b32 v170, 0x80008000, v154
    v_xor_b32 v171, 0x80008000, v155
    v_xor_b32 v172, 0x80008000, v156
    v_xor_b32 v173, 0x80008000, v157
    v_xor_b32 v174, 0x80008000, v158
    v_xor_b32 v175, 0x80008000, v159
    v_mfma_f32_32x32x16_bf16 v[48:63], v[128:131], v[16:19], 0
    v_mfma_f32_32x32x16_bf16 v[64:79], v[128:131], v[32:35], 0
    v_mfma_f32_32x32x16_bf16 v[48:63], v[132:135], v[20:23], v[48:63]
    v_mfma_f32_32x32x16_bf16 v[64:79], v[132:135], v[36:39], v[64:79]
    v_mfma_f32_32x32x16_bf16 v[48:63], v[136:139], v[24:27], v[48:63]
    v_mfma_f32_32x32x16_bf16 v[64:79], v[136:139], v[40:43], v[64:79]
    v_mfma_f32_32x32x16_bf16 v[48:63], v[140:143], v[28:31], v[48:63]
    v_mfma_f32_32x32x16_bf16 v[64:79], v[140:143], v[44:47], v[64:79]
    v_mfma_f32_32x32x16_bf16 v[48:63], v[160:163], v[32:35], v[48:63]
    v_mfma_f32_32x32x16_bf16 v[64:79], v[144:147], v[16:19], v[64:79]
    v_mfma_f32_32x32x16_bf16 v[48:63], v[164:167], v[36:39], v[48:63]
    v_mfma_f32_32x32x16_bf16 v[64:79], v[148:151], v[20:23], v[64:79]
    v_mfma_f32_32x32x16_bf16 v[48:63], v[168:171], v[40:43], v[48:63]
    v_mfma_f32_32x32x16_bf16 v[64:79], v[152:155], v[24:27], v[64:79]
    v_mfma_f32_32x32x16_bf16 v[48:63], v[172:175], v[44:47], v[48:63]
    v_mfma_f32_32x32x16_bf16 v[64:79], v[156:159], v[28:31], v[64:79]
    s_nop 15
    s_nop 3
    v_cvt_pk_bf16_f32 v48, v48, v49
    v_cvt_pk_bf16_f32 v49, v50, v51
    v_cvt_pk_bf16_f32 v50, v52, v53
    v_cvt_pk_bf16_f32 v51, v54, v55
    v_cvt_pk_bf16_f32 v56, v56, v57
    v_cvt_pk_bf16_f32 v57, v58, v59
    v_cvt_pk_bf16_f32 v58, v60, v61
    v_cvt_pk_bf16_f32 v59, v62, v63
    v_cvt_pk_bf16_f32 v64, v64, v65
    v_cvt_pk_bf16_f32 v65, v66, v67
    v_cvt_pk_bf16_f32 v66, v68, v69
    v_cvt_pk_bf16_f32 v67, v70, v71
    v_cvt_pk_bf16_f32 v72, v72, v73
    v_cvt_pk_bf16_f32 v73, v74, v75
    v_cvt_pk_bf16_f32 v74, v76, v77
    v_cvt_pk_bf16_f32 v75, v78, v79
    s_waitcnt vmcnt(0)
    s_nop 1
    v_mfma_f32_32x32x16_bf16 v[80:95], v[176:179], v[48:51], v[80:95]
    v_mfma_f32_32x32x16_bf16 v[80:95], v[180:183], v[64:67], v[80:95]
    v_mfma_f32_32x32x16_bf16 v[80:95], v[184:187], v[56:59], v[80:95]
    v_mfma_f32_32x32x16_bf16 v[80:95], v[188:191], v[72:75], v[80:95]
    v_mfma_f32_32x32x16_bf16 v[96:111], v[192:195], v[48:51], v[96:111]
    v_mfma_f32_32x32x16_bf16 v[96:111], v[196:199], v[64:67], v[96:111]
    v_mfma_f32_32x32x16_bf16 v[96:111], v[200:203], v[56:59], v[96:111]
    v_mfma_f32_32x32x16_bf16 v[96:111], v[204:207], v[72:75], v[96:111]
    v_mfma_f32_32x32x16_bf16 v[112:127], v[208:211], v[48:51], v[112:127]
    v_mfma_f32_32x32x16_bf16 v[112:127], v[212:215], v[64:67], v[112:127]
    v_mfma_f32_32x32x16_bf16 v[112:127], v[216:219], v[56:59], v[112:127]
    v_mfma_f32_32x32x16_bf16 v[112:127], v[220:223], v[72:75], v[112:127]
    s_add_u32 s50, s44, 2048
    buffer_load_dwordx4 v[176:179], v225, s[8:11], s50 offen offset:0
    buffer_load_dwordx4 v[180:183], v225, s[12:15], s50 offen offset:0
    s_add_u32 s50, s44, 2048
    buffer_load_dwordx4 v[184:187], v225, s[8:11], s50 offen offset:1024
    buffer_load_dwordx4 v[188:191], v225, s[12:15], s50 offen offset:1024
    s_add_u32 s50, s44, 22528
    buffer_load_dwordx4 v[192:195], v225, s[8:11], s50 offen offset:0
    buffer_load_dwordx4 v[196:199], v225, s[12:15], s50 offen offset:0
    s_add_u32 s50, s44, 22528
    buffer_load_dwordx4 v[200:203], v225, s[8:11], s50 offen offset:1024
    buffer_load_dwordx4 v[204:207], v225, s[12:15], s50 offen offset:1024
    s_add_u32 s50, s44, 43008
    buffer_load_dwordx4 v[208:211], v225, s[8:11], s50 offen offset:0
    buffer_load_dwordx4 v[212:215], v225, s[12:15], s50 offen offset:0
    s_add_u32 s50, s44, 43008
    buffer_load_dwordx4 v[216:219], v225, s[8:11], s50 offen offset:1024
    buffer_load_dwordx4 v[220:223], v225, s[12:15], s50 offen offset:1024
    ds_read_b64_tr_b16 v[128:129], v224 offset:64
    ds_read_b64_tr_b16 v[130:131], v224 offset:2880
    ds_read_b64_tr_b16 v[132:133], v224 offset:11328
    ds_read_b64_tr_b16 v[134:135], v224 offset:14144
    ds_read_b64_tr_b16 v[136:137], v224 offset:22592
    ds_read_b64_tr_b16 v[138:139], v224 offset:25408
    ds_read_b64_tr_b16 v[140:141], v224 offset:33856
    ds_read_b64_tr_b16 v[142:143], v224 offset:36672
    ds_read_b64_tr_b16 v[144:145], v226 offset:64
    ds_read_b64_tr_b16 v[146:147], v226 offset:2880
    ds_read_b64_tr_b16 v[148:149], v226 offset:11328
    ds_read_b64_tr_b16 v[150:151], v226 offset:14144
    ds_read_b64_tr_b16 v[152:153], v226 offset:22592
    ds_read_b64_tr_b16 v[154:155], v226 offset:25408
    ds_read_b64_tr_b16 v[156:157], v226 offset:33856
    ds_read_b64_tr_b16 v[158:159], v226 offset:36672
    s_waitcnt lgkmcnt(0)
    v_xor_b32 v160, 0x80008000, v144
    v_xor_b32 v161, 0x80008000, v145
    v_xor_b32 v162, 0x80008000, v146
    v_xor_b32 v163, 0x80008000, v147
    v_xor_b32 v164, 0x80008000, v148
    v_xor_b32 v165, 0x80008000, v149
    v_xor_b32 v166, 0x80008000, v150
    v_xor_b32 v167, 0x80008000, v151
    v_xor_b32 v168, 0x80008000, v152
    v_xor_b32 v169, 0x80008000, v153
    v_xor_b32 v170, 0x80008000, v154
    v_xor_b32 v171, 0x80008000, v155
    v_xor_b32 v172, 0x80008000, v156
    v_xor_b32 v173, 0x80008000, v157
    v_xor_b32 v174, 0x80008000, v158
    v_xor_b32 v175, 0x80008000, v159
    v_mfma_f32_32x32x16_bf16 v[48:63], v[128:131], v[16:19], 0
    v_mfma_f32_32x32x16_bf16 v[64:79], v[128:131], v[32:35], 0
    v_mfma_f32_32x32x16_bf16 v[48:63], v[132:135], v[20:23], v[48:63]
    v_mfma_f32_32x32x16_bf16 v[64:79], v[132:135], v[36:39], v[64:79]
    v_mfma_f32_32x32x16_bf16 v[48:63], v[136:139], v[24:27], v[48:63]
    v_mfma_f32_32x32x16_bf16 v[64:79], v[136:139], v[40:43], v[64:79]
    v_mfma_f32_32x32x16_bf16 v[48:63], v[140:143], v[28:31], v[48:63]
    v_mfma_f32_32x32x16_bf16 v[64:79], v[140:143], v[44:47], v[64:79]
    v_mfma_f32_32x32x16_bf16 v[48:63], v[160:163], v[32:35], v[48:63]
    v_mfma_f32_32x32x16_bf16 v[64:79], v[144:147], v[16:19], v[64:79]
    v_mfma_f32_32x32x16_bf16 v[48:63], v[164:167], v[36:39], v[48:63]
    v_mfma_f32_32x32x16_bf16 v[64:79], v[148:151], v[20:23], v[64:79]
    v_mfma_f32_32x32x16_bf16 v[48:63], v[168:171], v[40:43], v[48:63]
    v_mfma_f32_32x32x16_bf16 v[64:79], v[152:155], v[24:27], v[64:79]
    v_mfma_f32_32x32x16_bf16 v[48:63], v[172:175], v[44:47], v[48:63]
    v_mfma_f32_32x32x16_bf16 v[64:79], v[156:159], v[28:31], v[64:79]
    s_nop 15
    s_nop 3
    v_cvt_pk_bf16_f32 v48, v48, v49
    v_cvt_pk_bf16_f32 v49, v50, v51
    v_cvt_pk_bf16_f32 v50, v52, v53
    v_cvt_pk_bf16_f32 v51, v54, v55
    v_cvt_pk_bf16_f32 v56, v56, v57
    v_cvt_pk_bf16_f32 v57, v58, v59
    v_cvt_pk_bf16_f32 v58, v60, v61
    v_cvt_pk_bf16_f32 v59, v62, v63
    v_cvt_pk_bf16_f32 v64, v64, v65
    v_cvt_pk_bf16_f32 v65, v66, v67
    v_cvt_pk_bf16_f32 v66, v68, v69
    v_cvt_pk_bf16_f32 v67, v70, v71
    v_cvt_pk_bf16_f32 v72, v72, v73
    v_cvt_pk_bf16_f32 v73, v74, v75
    v_cvt_pk_bf16_f32 v74, v76, v77
    v_cvt_pk_bf16_f32 v75, v78, v79
    s_waitcnt vmcnt(0)
    s_nop 1
    v_mfma_f32_32x32x16_bf16 v[80:95], v[176:179], v[48:51], v[80:95]
    v_mfma_f32_32x32x16_bf16 v[80:95], v[180:183], v[64:67], v[80:95]
    v_mfma_f32_32x32x16_bf16 v[80:95], v[184:187], v[56:59], v[80:95]
    v_mfma_f32_32x32x16_bf16 v[80:95], v[188:191], v[72:75], v[80:95]
    v_mfma_f32_32x32x16_bf16 v[96:111], v[192:195], v[48:51], v[96:111]
    v_mfma_f32_32x32x16_bf16 v[96:111], v[196:199], v[64:67], v[96:111]
    v_mfma_f32_32x32x16_bf16 v[96:111], v[200:203], v[56:59], v[96:111]
    v_mfma_f32_32x32x16_bf16 v[96:111], v[204:207], v[72:75], v[96:111]
    v_mfma_f32_32x32x16_bf16 v[112:127], v[208:211], v[48:51], v[112:127]
    v_mfma_f32_32x32x16_bf16 v[112:127], v[212:215], v[64:67], v[112:127]
    v_mfma_f32_32x32x16_bf16 v[112:127], v[216:219], v[56:59], v[112:127]
    v_mfma_f32_32x32x16_bf16 v[112:127], v[220:223], v[72:75], v[112:127]
    s_add_u32 s50, s44, 4096
    buffer_load_dwordx4 v[176:179], v225, s[8:11], s50 offen offset:0
    buffer_load_dwordx4 v[180:183], v225, s[12:15], s50 offen offset:0
    s_add_u32 s50, s44, 4096
    buffer_load_dwordx4 v[184:187], v225, s[8:11], s50 offen offset:1024
    buffer_load_dwordx4 v[188:191], v225, s[12:15], s50 offen offset:1024
    s_add_u32 s50, s44, 24576
    buffer_load_dwordx4 v[192:195], v225, s[8:11], s50 offen offset:0
    buffer_load_dwordx4 v[196:199], v225, s[12:15], s50 offen offset:0
    s_add_u32 s50, s44, 24576
    buffer_load_dwordx4 v[200:203], v225, s[8:11], s50 offen offset:1024
    buffer_load_dwordx4 v[204:207], v225, s[12:15], s50 offen offset:1024
    s_add_u32 s50, s44, 45056
    buffer_load_dwordx4 v[208:211], v225, s[8:11], s50 offen offset:0
    buffer_load_dwordx4 v[212:215], v225, s[12:15], s50 offen offset:0
    s_add_u32 s50, s44, 45056
    buffer_load_dwordx4 v[216:219], v225, s[8:11], s50 offen offset:1024
    buffer_load_dwordx4 v[220:223], v225, s[12:15], s50 offen offset:1024
    ds_read_b64_tr_b16 v[128:129], v224 offset:128
    ds_read_b64_tr_b16 v[130:131], v224 offset:2944
    ds_read_b64_tr_b16 v[132:133], v224 offset:11392
    ds_read_b64_tr_b16 v[134:135], v224 offset:14208
    ds_read_b64_tr_b16 v[136:137], v224 offset:22656
    ds_read_b64_tr_b16 v[138:139], v224 offset:25472
    ds_read_b64_tr_b16 v[140:141], v224 offset:33920
    ds_read_b64_tr_b16 v[142:143], v224 offset:36736
    ds_read_b64_tr_b16 v[144:145], v226 offset:128
    ds_read_b64_tr_b16 v[146:147], v226 offset:2944
    ds_read_b64_tr_b16 v[148:149], v226 offset:11392
    ds_read_b64_tr_b16 v[150:151], v226 offset:14208
    ds_read_b64_tr_b16 v[152:153], v226 offset:22656
    ds_read_b64_tr_b16 v[154:155], v226 offset:25472
    ds_read_b64_tr_b16 v[156:157], v226 offset:33920
    ds_read_b64_tr_b16 v[158:159], v226 offset:36736
    s_waitcnt lgkmcnt(0)
    v_xor_b32 v160, 0x80008000, v144
    v_xor_b32 v161, 0x80008000, v145
    v_xor_b32 v162, 0x80008000, v146
    v_xor_b32 v163, 0x80008000, v147
    v_xor_b32 v164, 0x80008000, v148
    v_xor_b32 v165, 0x80008000, v149
    v_xor_b32 v166, 0x80008000, v150
    v_xor_b32 v167, 0x80008000, v151
    v_xor_b32 v168, 0x80008000, v152
    v_xor_b32 v169, 0x80008000, v153
    v_xor_b32 v170, 0x80008000, v154
    v_xor_b32 v171, 0x80008000, v155
    v_xor_b32 v172, 0x80008000, v156
    v_xor_b32 v173, 0x80008000, v157
    v_xor_b32 v174, 0x80008000, v158
    v_xor_b32 v175, 0x80008000, v159
    v_mfma_f32_32x32x16_bf16 v[48:63], v[128:131], v[16:19], 0
    v_mfma_f32_32x32x16_bf16 v[64:79], v[128:131], v[32:35], 0
    v_mfma_f32_32x32x16_bf16 v[48:63], v[132:135], v[20:23], v[48:63]
    v_mfma_f32_32x32x16_bf16 v[64:79], v[132:135], v[36:39], v[64:79]
    v_mfma_f32_32x32x16_bf16 v[48:63], v[136:139], v[24:27], v[48:63]
    v_mfma_f32_32x32x16_bf16 v[64:79], v[136:139], v[40:43], v[64:79]
    v_mfma_f32_32x32x16_bf16 v[48:63], v[140:143], v[28:31], v[48:63]
    v_mfma_f32_32x32x16_bf16 v[64:79], v[140:143], v[44:47], v[64:79]
    v_mfma_f32_32x32x16_bf16 v[48:63], v[160:163], v[32:35], v[48:63]
    v_mfma_f32_32x32x16_bf16 v[64:79], v[144:147], v[16:19], v[64:79]
    v_mfma_f32_32x32x16_bf16 v[48:63], v[164:167], v[36:39], v[48:63]
    v_mfma_f32_32x32x16_bf16 v[64:79], v[148:151], v[20:23], v[64:79]
    v_mfma_f32_32x32x16_bf16 v[48:63], v[168:171], v[40:43], v[48:63]
    v_mfma_f32_32x32x16_bf16 v[64:79], v[152:155], v[24:27], v[64:79]
    v_mfma_f32_32x32x16_bf16 v[48:63], v[172:175], v[44:47], v[48:63]
    v_mfma_f32_32x32x16_bf16 v[64:79], v[156:159], v[28:31], v[64:79]
    s_nop 15
    s_nop 3
    v_cvt_pk_bf16_f32 v48, v48, v49
    v_cvt_pk_bf16_f32 v49, v50, v51
    v_cvt_pk_bf16_f32 v50, v52, v53
    v_cvt_pk_bf16_f32 v51, v54, v55
    v_cvt_pk_bf16_f32 v56, v56, v57
    v_cvt_pk_bf16_f32 v57, v58, v59
    v_cvt_pk_bf16_f32 v58, v60, v61
    v_cvt_pk_bf16_f32 v59, v62, v63
    v_cvt_pk_bf16_f32 v64, v64, v65
    v_cvt_pk_bf16_f32 v65, v66, v67
    v_cvt_pk_bf16_f32 v66, v68, v69
    v_cvt_pk_bf16_f32 v67, v70, v71
    v_cvt_pk_bf16_f32 v72, v72, v73
    v_cvt_pk_bf16_f32 v73, v74, v75
    v_cvt_pk_bf16_f32 v74, v76, v77
    v_cvt_pk_bf16_f32 v75, v78, v79
    s_waitcnt vmcnt(0)
    s_nop 1
    v_mfma_f32_32x32x16_bf16 v[80:95], v[176:179], v[48:51], v[80:95]
    v_mfma_f32_32x32x16_bf16 v[80:95], v[180:183], v[64:67], v[80:95]
    v_mfma_f32_32x32x16_bf16 v[80:95], v[184:187], v[56:59], v[80:95]
    v_mfma_f32_32x32x16_bf16 v[80:95], v[188:191], v[72:75], v[80:95]
    v_mfma_f32_32x32x16_bf16 v[96:111], v[192:195], v[48:51], v[96:111]
    v_mfma_f32_32x32x16_bf16 v[96:111], v[196:199], v[64:67], v[96:111]
    v_mfma_f32_32x32x16_bf16 v[96:111], v[200:203], v[56:59], v[96:111]
    v_mfma_f32_32x32x16_bf16 v[96:111], v[204:207], v[72:75], v[96:111]
    v_mfma_f32_32x32x16_bf16 v[112:127], v[208:211], v[48:51], v[112:127]
    v_mfma_f32_32x32x16_bf16 v[112:127], v[212:215], v[64:67], v[112:127]
    v_mfma_f32_32x32x16_bf16 v[112:127], v[216:219], v[56:59], v[112:127]
    v_mfma_f32_32x32x16_bf16 v[112:127], v[220:223], v[72:75], v[112:127]
    s_add_u32 s50, s44, 6144
    buffer_load_dwordx4 v[176:179], v225, s[8:11], s50 offen offset:0
    buffer_load_dwordx4 v[180:183], v225, s[12:15], s50 offen offset:0
    s_add_u32 s50, s44, 6144
    buffer_load_dwordx4 v[184:187], v225, s[8:11], s50 offen offset:1024
    buffer_load_dwordx4 v[188:191], v225, s[12:15], s50 offen offset:1024
    s_add_u32 s50, s44, 26624
    buffer_load_dwordx4 v[192:195], v225, s[8:11], s50 offen offset:0
    buffer_load_dwordx4 v[196:199], v225, s[12:15], s50 offen offset:0
    s_add_u32 s50, s44, 26624
    buffer_load_dwordx4 v[200:203], v225, s[8:11], s50 offen offset:1024
    buffer_load_dwordx4 v[204:207], v225, s[12:15], s50 offen offset:1024
    s_add_u32 s50, s44, 47104
    buffer_load_dwordx4 v[208:211], v225, s[8:11], s50 offen offset:0
    buffer_load_dwordx4 v[212:215], v225, s[12:15], s50 offen offset:0
    s_add_u32 s50, s44, 47104
    buffer_load_dwordx4 v[216:219], v225, s[8:11], s50 offen offset:1024
    buffer_load_dwordx4 v[220:223], v225, s[12:15], s50 offen offset:1024
    ds_read_b64_tr_b16 v[128:129], v224 offset:192
    ds_read_b64_tr_b16 v[130:131], v224 offset:3008
    ds_read_b64_tr_b16 v[132:133], v224 offset:11456
    ds_read_b64_tr_b16 v[134:135], v224 offset:14272
    ds_read_b64_tr_b16 v[136:137], v224 offset:22720
    ds_read_b64_tr_b16 v[138:139], v224 offset:25536
    ds_read_b64_tr_b16 v[140:141], v224 offset:33984
    ds_read_b64_tr_b16 v[142:143], v224 offset:36800
    ds_read_b64_tr_b16 v[144:145], v226 offset:192
    ds_read_b64_tr_b16 v[146:147], v226 offset:3008
    ds_read_b64_tr_b16 v[148:149], v226 offset:11456
    ds_read_b64_tr_b16 v[150:151], v226 offset:14272
    ds_read_b64_tr_b16 v[152:153], v226 offset:22720
    ds_read_b64_tr_b16 v[154:155], v226 offset:25536
    ds_read_b64_tr_b16 v[156:157], v226 offset:33984
    ds_read_b64_tr_b16 v[158:159], v226 offset:36800
    s_waitcnt lgkmcnt(0)
    v_xor_b32 v160, 0x80008000, v144
    v_xor_b32 v161, 0x80008000, v145
    v_xor_b32 v162, 0x80008000, v146
    v_xor_b32 v163, 0x80008000, v147
    v_xor_b32 v164, 0x80008000, v148
    v_xor_b32 v165, 0x80008000, v149
    v_xor_b32 v166, 0x80008000, v150
    v_xor_b32 v167, 0x80008000, v151
    v_xor_b32 v168, 0x80008000, v152
    v_xor_b32 v169, 0x80008000, v153
    v_xor_b32 v170, 0x80008000, v154
    v_xor_b32 v171, 0x80008000, v155
    v_xor_b32 v172, 0x80008000, v156
    v_xor_b32 v173, 0x80008000, v157
    v_xor_b32 v174, 0x80008000, v158
    v_xor_b32 v175, 0x80008000, v159
    v_mfma_f32_32x32x16_bf16 v[48:63], v[128:131], v[16:19], 0
    v_mfma_f32_32x32x16_bf16 v[64:79], v[128:131], v[32:35], 0
    v_mfma_f32_32x32x16_bf16 v[48:63], v[132:135], v[20:23], v[48:63]
    v_mfma_f32_32x32x16_bf16 v[64:79], v[132:135], v[36:39], v[64:79]
    v_mfma_f32_32x32x16_bf16 v[48:63], v[136:139], v[24:27], v[48:63]
    v_mfma_f32_32x32x16_bf16 v[64:79], v[136:139], v[40:43], v[64:79]
    v_mfma_f32_32x32x16_bf16 v[48:63], v[140:143], v[28:31], v[48:63]
    v_mfma_f32_32x32x16_bf16 v[64:79], v[140:143], v[44:47], v[64:79]
    v_mfma_f32_32x32x16_bf16 v[48:63], v[160:163], v[32:35], v[48:63]
    v_mfma_f32_32x32x16_bf16 v[64:79], v[144:147], v[16:19], v[64:79]
    v_mfma_f32_32x32x16_bf16 v[48:63], v[164:167], v[36:39], v[48:63]
    v_mfma_f32_32x32x16_bf16 v[64:79], v[148:151], v[20:23], v[64:79]
    v_mfma_f32_32x32x16_bf16 v[48:63], v[168:171], v[40:43], v[48:63]
    v_mfma_f32_32x32x16_bf16 v[64:79], v[152:155], v[24:27], v[64:79]
    v_mfma_f32_32x32x16_bf16 v[48:63], v[172:175], v[44:47], v[48:63]
    v_mfma_f32_32x32x16_bf16 v[64:79], v[156:159], v[28:31], v[64:79]
    s_nop 15
    s_nop 3
    v_cvt_pk_bf16_f32 v48, v48, v49
    v_cvt_pk_bf16_f32 v49, v50, v51
    v_cvt_pk_bf16_f32 v50, v52, v53
    v_cvt_pk_bf16_f32 v51, v54, v55
    v_cvt_pk_bf16_f32 v56, v56, v57
    v_cvt_pk_bf16_f32 v57, v58, v59
    v_cvt_pk_bf16_f32 v58, v60, v61
    v_cvt_pk_bf16_f32 v59, v62, v63
    v_cvt_pk_bf16_f32 v64, v64, v65
    v_cvt_pk_bf16_f32 v65, v66, v67
    v_cvt_pk_bf16_f32 v66, v68, v69
    v_cvt_pk_bf16_f32 v67, v70, v71
    v_cvt_pk_bf16_f32 v72, v72, v73
    v_cvt_pk_bf16_f32 v73, v74, v75
    v_cvt_pk_bf16_f32 v74, v76, v77
    v_cvt_pk_bf16_f32 v75, v78, v79
    s_waitcnt vmcnt(0)
    s_nop 1
    v_mfma_f32_32x32x16_bf16 v[80:95], v[176:179], v[48:51], v[80:95]
    v_mfma_f32_32x32x16_bf16 v[80:95], v[180:183], v[64:67], v[80:95]
    v_mfma_f32_32x32x16_bf16 v[80:95], v[184:187], v[56:59], v[80:95]
    v_mfma_f32_32x32x16_bf16 v[80:95], v[188:191], v[72:75], v[80:95]
    v_mfma_f32_32x32x16_bf16 v[96:111], v[192:195], v[48:51], v[96:111]
    v_mfma_f32_32x32x16_bf16 v[96:111], v[196:199], v[64:67], v[96:111]
    v_mfma_f32_32x32x16_bf16 v[96:111], v[200:203], v[56:59], v[96:111]
    v_mfma_f32_32x32x16_bf16 v[96:111], v[204:207], v[72:75], v[96:111]
    v_mfma_f32_32x32x16_bf16 v[112:127], v[208:211], v[48:51], v[112:127]
    v_mfma_f32_32x32x16_bf16 v[112:127], v[212:215], v[64:67], v[112:127]
    v_mfma_f32_32x32x16_bf16 v[112:127], v[216:219], v[56:59], v[112:127]
    v_mfma_f32_32x32x16_bf16 v[112:127], v[220:223], v[72:75], v[112:127]
    s_add_u32 s50, s44, 8192
    buffer_load_dwordx4 v[176:179], v225, s[8:11], s50 offen offset:0
    buffer_load_dwordx4 v[180:183], v225, s[12:15], s50 offen offset:0
    s_add_u32 s50, s44, 8192
    buffer_load_dwordx4 v[184:187], v225, s[8:11], s50 offen offset:1024
    buffer_load_dwordx4 v[188:191], v225, s[12:15], s50 offen offset:1024
    s_add_u32 s50, s44, 28672
    buffer_load_dwordx4 v[192:195], v225, s[8:11], s50 offen offset:0
    buffer_load_dwordx4 v[196:199], v225, s[12:15], s50 offen offset:0
    s_add_u32 s50, s44, 28672
    buffer_load_dwordx4 v[200:203], v225, s[8:11], s50 offen offset:1024
    buffer_load_dwordx4 v[204:207], v225, s[12:15], s50 offen offset:1024
    s_add_u32 s50, s44, 49152
    buffer_load_dwordx4 v[208:211], v225, s[8:11], s50 offen offset:0
    buffer_load_dwordx4 v[212:215], v225, s[12:15], s50 offen offset:0
    s_add_u32 s50, s44, 49152
    buffer_load_dwordx4 v[216:219], v225, s[8:11], s50 offen offset:1024
    buffer_load_dwordx4 v[220:223], v225, s[12:15], s50 offen offset:1024
    ds_read_b64_tr_b16 v[128:129], v224 offset:256
    ds_read_b64_tr_b16 v[130:131], v224 offset:3072
    ds_read_b64_tr_b16 v[132:133], v224 offset:11520
    ds_read_b64_tr_b16 v[134:135], v224 offset:14336
    ds_read_b64_tr_b16 v[136:137], v224 offset:22784
    ds_read_b64_tr_b16 v[138:139], v224 offset:25600
    ds_read_b64_tr_b16 v[140:141], v224 offset:34048
    ds_read_b64_tr_b16 v[142:143], v224 offset:36864
    ds_read_b64_tr_b16 v[144:145], v226 offset:256
    ds_read_b64_tr_b16 v[146:147], v226 offset:3072
    ds_read_b64_tr_b16 v[148:149], v226 offset:11520
    ds_read_b64_tr_b16 v[150:151], v226 offset:14336
    ds_read_b64_tr_b16 v[152:153], v226 offset:22784
    ds_read_b64_tr_b16 v[154:155], v226 offset:25600
    ds_read_b64_tr_b16 v[156:157], v226 offset:34048
    ds_read_b64_tr_b16 v[158:159], v226 offset:36864
    s_waitcnt lgkmcnt(0)
    v_xor_b32 v160, 0x80008000, v144
    v_xor_b32 v161, 0x80008000, v145
    v_xor_b32 v162, 0x80008000, v146
    v_xor_b32 v163, 0x80008000, v147
    v_xor_b32 v164, 0x80008000, v148
    v_xor_b32 v165, 0x80008000, v149
    v_xor_b32 v166, 0x80008000, v150
    v_xor_b32 v167, 0x80008000, v151
    v_xor_b32 v168, 0x80008000, v152
    v_xor_b32 v169, 0x80008000, v153
    v_xor_b32 v170, 0x80008000, v154
    v_xor_b32 v171, 0x80008000, v155
    v_xor_b32 v172, 0x80008000, v156
    v_xor_b32 v173, 0x80008000, v157
    v_xor_b32 v174, 0x80008000, v158
    v_xor_b32 v175, 0x80008000, v159
    v_mfma_f32_32x32x16_bf16 v[48:63], v[128:131], v[16:19], 0
    v_mfma_f32_32x32x16_bf16 v[64:79], v[128:131], v[32:35], 0
    v_mfma_f32_32x32x16_bf16 v[48:63], v[132:135], v[20:23], v[48:63]
    v_mfma_f32_32x32x16_bf16 v[64:79], v[132:135], v[36:39], v[64:79]
    v_mfma_f32_32x32x16_bf16 v[48:63], v[136:139], v[24:27], v[48:63]
    v_mfma_f32_32x32x16_bf16 v[64:79], v[136:139], v[40:43], v[64:79]
    v_mfma_f32_32x32x16_bf16 v[48:63], v[140:143], v[28:31], v[48:63]
    v_mfma_f32_32x32x16_bf16 v[64:79], v[140:143], v[44:47], v[64:79]
    v_mfma_f32_32x32x16_bf16 v[48:63], v[160:163], v[32:35], v[48:63]
    v_mfma_f32_32x32x16_bf16 v[64:79], v[144:147], v[16:19], v[64:79]
    v_mfma_f32_32x32x16_bf16 v[48:63], v[164:167], v[36:39], v[48:63]
    v_mfma_f32_32x32x16_bf16 v[64:79], v[148:151], v[20:23], v[64:79]
    v_mfma_f32_32x32x16_bf16 v[48:63], v[168:171], v[40:43], v[48:63]
    v_mfma_f32_32x32x16_bf16 v[64:79], v[152:155], v[24:27], v[64:79]
    v_mfma_f32_32x32x16_bf16 v[48:63], v[172:175], v[44:47], v[48:63]
    v_mfma_f32_32x32x16_bf16 v[64:79], v[156:159], v[28:31], v[64:79]
    s_nop 15
    s_nop 3
    v_cvt_pk_bf16_f32 v48, v48, v49
    v_cvt_pk_bf16_f32 v49, v50, v51
    v_cvt_pk_bf16_f32 v50, v52, v53
    v_cvt_pk_bf16_f32 v51, v54, v55
    v_cvt_pk_bf16_f32 v56, v56, v57
    v_cvt_pk_bf16_f32 v57, v58, v59
    v_cvt_pk_bf16_f32 v58, v60, v61
    v_cvt_pk_bf16_f32 v59, v62, v63
    v_cvt_pk_bf16_f32 v64, v64, v65
    v_cvt_pk_bf16_f32 v65, v66, v67
    v_cvt_pk_bf16_f32 v66, v68, v69
    v_cvt_pk_bf16_f32 v67, v70, v71
    v_cvt_pk_bf16_f32 v72, v72, v73
    v_cvt_pk_bf16_f32 v73, v74, v75
    v_cvt_pk_bf16_f32 v74, v76, v77
    v_cvt_pk_bf16_f32 v75, v78, v79
    s_waitcnt vmcnt(0)
    s_nop 1
    v_mfma_f32_32x32x16_bf16 v[80:95], v[176:179], v[48:51], v[80:95]
    v_mfma_f32_32x32x16_bf16 v[80:95], v[180:183], v[64:67], v[80:95]
    v_mfma_f32_32x32x16_bf16 v[80:95], v[184:187], v[56:59], v[80:95]
    v_mfma_f32_32x32x16_bf16 v[80:95], v[188:191], v[72:75], v[80:95]
    v_mfma_f32_32x32x16_bf16 v[96:111], v[192:195], v[48:51], v[96:111]
    v_mfma_f32_32x32x16_bf16 v[96:111], v[196:199], v[64:67], v[96:111]
    v_mfma_f32_32x32x16_bf16 v[96:111], v[200:203], v[56:59], v[96:111]
    v_mfma_f32_32x32x16_bf16 v[96:111], v[204:207], v[72:75], v[96:111]
    v_mfma_f32_32x32x16_bf16 v[112:127], v[208:211], v[48:51], v[112:127]
    v_mfma_f32_32x32x16_bf16 v[112:127], v[212:215], v[64:67], v[112:127]
    v_mfma_f32_32x32x16_bf16 v[112:127], v[216:219], v[56:59], v[112:127]
    v_mfma_f32_32x32x16_bf16 v[112:127], v[220:223], v[72:75], v[112:127]
    s_add_u32 s50, s44, 10240
    buffer_load_dwordx4 v[176:179], v225, s[8:11], s50 offen offset:0
    buffer_load_dwordx4 v[180:183], v225, s[12:15], s50 offen offset:0
    s_add_u32 s50, s44, 10240
    buffer_load_dwordx4 v[184:187], v225, s[8:11], s50 offen offset:1024
    buffer_load_dwordx4 v[188:191], v225, s[12:15], s50 offen offset:1024
    s_add_u32 s50, s44, 30720
    buffer_load_dwordx4 v[192:195], v225, s[8:11], s50 offen offset:0
    buffer_load_dwordx4 v[196:199], v225, s[12:15], s50 offen offset:0
    s_add_u32 s50, s44, 30720
    buffer_load_dwordx4 v[200:203], v225, s[8:11], s50 offen offset:1024
    buffer_load_dwordx4 v[204:207], v225, s[12:15], s50 offen offset:1024
    s_add_u32 s50, s44, 51200
    buffer_load_dwordx4 v[208:211], v225, s[8:11], s50 offen offset:0
    buffer_load_dwordx4 v[212:215], v225, s[12:15], s50 offen offset:0
    s_add_u32 s50, s44, 51200
    buffer_load_dwordx4 v[216:219], v225, s[8:11], s50 offen offset:1024
    buffer_load_dwordx4 v[220:223], v225, s[12:15], s50 offen offset:1024
    ds_read_b64_tr_b16 v[128:129], v224 offset:320
    ds_read_b64_tr_b16 v[130:131], v224 offset:3136
    ds_read_b64_tr_b16 v[132:133], v224 offset:11584
    ds_read_b64_tr_b16 v[134:135], v224 offset:14400
    ds_read_b64_tr_b16 v[136:137], v224 offset:22848
    ds_read_b64_tr_b16 v[138:139], v224 offset:25664
    ds_read_b64_tr_b16 v[140:141], v224 offset:34112
    ds_read_b64_tr_b16 v[142:143], v224 offset:36928
    ds_read_b64_tr_b16 v[144:145], v226 offset:320
    ds_read_b64_tr_b16 v[146:147], v226 offset:3136
    ds_read_b64_tr_b16 v[148:149], v226 offset:11584
    ds_read_b64_tr_b16 v[150:151], v226 offset:14400
    ds_read_b64_tr_b16 v[152:153], v226 offset:22848
    ds_read_b64_tr_b16 v[154:155], v226 offset:25664
    ds_read_b64_tr_b16 v[156:157], v226 offset:34112
    ds_read_b64_tr_b16 v[158:159], v226 offset:36928
    s_waitcnt lgkmcnt(0)
    v_xor_b32 v160, 0x80008000, v144
    v_xor_b32 v161, 0x80008000, v145
    v_xor_b32 v162, 0x80008000, v146
    v_xor_b32 v163, 0x80008000, v147
    v_xor_b32 v164, 0x80008000, v148
    v_xor_b32 v165, 0x80008000, v149
    v_xor_b32 v166, 0x80008000, v150
    v_xor_b32 v167, 0x80008000, v151
    v_xor_b32 v168, 0x80008000, v152
    v_xor_b32 v169, 0x80008000, v153
    v_xor_b32 v170, 0x80008000, v154
    v_xor_b32 v171, 0x80008000, v155
    v_xor_b32 v172, 0x80008000, v156
    v_xor_b32 v173, 0x80008000, v157
    v_xor_b32 v174, 0x80008000, v158
    v_xor_b32 v175, 0x80008000, v159
    v_mfma_f32_32x32x16_bf16 v[48:63], v[128:131], v[16:19], 0
    v_mfma_f32_32x32x16_bf16 v[64:79], v[128:131], v[32:35], 0
    v_mfma_f32_32x32x16_bf16 v[48:63], v[132:135], v[20:23], v[48:63]
    v_mfma_f32_32x32x16_bf16 v[64:79], v[132:135], v[36:39], v[64:79]
    v_mfma_f32_32x32x16_bf16 v[48:63], v[136:139], v[24:27], v[48:63]
    v_mfma_f32_32x32x16_bf16 v[64:79], v[136:139], v[40:43], v[64:79]
    v_mfma_f32_32x32x16_bf16 v[48:63], v[140:143], v[28:31], v[48:63]
    v_mfma_f32_32x32x16_bf16 v[64:79], v[140:143], v[44:47], v[64:79]
    v_mfma_f32_32x32x16_bf16 v[48:63], v[160:163], v[32:35], v[48:63]
    v_mfma_f32_32x32x16_bf16 v[64:79], v[144:147], v[16:19], v[64:79]
    v_mfma_f32_32x32x16_bf16 v[48:63], v[164:167], v[36:39], v[48:63]
    v_mfma_f32_32x32x16_bf16 v[64:79], v[148:151], v[20:23], v[64:79]
    v_mfma_f32_32x32x16_bf16 v[48:63], v[168:171], v[40:43], v[48:63]
    v_mfma_f32_32x32x16_bf16 v[64:79], v[152:155], v[24:27], v[64:79]
    v_mfma_f32_32x32x16_bf16 v[48:63], v[172:175], v[44:47], v[48:63]
    v_mfma_f32_32x32x16_bf16 v[64:79], v[156:159], v[28:31], v[64:79]
    s_nop 15
    s_nop 3
    v_cvt_pk_bf16_f32 v48, v48, v49
    v_cvt_pk_bf16_f32 v49, v50, v51
    v_cvt_pk_bf16_f32 v50, v52, v53
    v_cvt_pk_bf16_f32 v51, v54, v55
    v_cvt_pk_bf16_f32 v56, v56, v57
    v_cvt_pk_bf16_f32 v57, v58, v59
    v_cvt_pk_bf16_f32 v58, v60, v61
    v_cvt_pk_bf16_f32 v59, v62, v63
    v_cvt_pk_bf16_f32 v64, v64, v65
    v_cvt_pk_bf16_f32 v65, v66, v67
    v_cvt_pk_bf16_f32 v66, v68, v69
    v_cvt_pk_bf16_f32 v67, v70, v71
    v_cvt_pk_bf16_f32 v72, v72, v73
    v_cvt_pk_bf16_f32 v73, v74, v75
    v_cvt_pk_bf16_f32 v74, v76, v77
    v_cvt_pk_bf16_f32 v75, v78, v79
    s_waitcnt vmcnt(0)
    s_nop 1
    v_mfma_f32_32x32x16_bf16 v[80:95], v[176:179], v[48:51], v[80:95]
    v_mfma_f32_32x32x16_bf16 v[80:95], v[180:183], v[64:67], v[80:95]
    v_mfma_f32_32x32x16_bf16 v[80:95], v[184:187], v[56:59], v[80:95]
    v_mfma_f32_32x32x16_bf16 v[80:95], v[188:191], v[72:75], v[80:95]
    v_mfma_f32_32x32x16_bf16 v[96:111], v[192:195], v[48:51], v[96:111]
    v_mfma_f32_32x32x16_bf16 v[96:111], v[196:199], v[64:67], v[96:111]
    v_mfma_f32_32x32x16_bf16 v[96:111], v[200:203], v[56:59], v[96:111]
    v_mfma_f32_32x32x16_bf16 v[96:111], v[204:207], v[72:75], v[96:111]
    v_mfma_f32_32x32x16_bf16 v[112:127], v[208:211], v[48:51], v[112:127]
    v_mfma_f32_32x32x16_bf16 v[112:127], v[212:215], v[64:67], v[112:127]
    v_mfma_f32_32x32x16_bf16 v[112:127], v[216:219], v[56:59], v[112:127]
    v_mfma_f32_32x32x16_bf16 v[112:127], v[220:223], v[72:75], v[112:127]
    s_add_u32 s50, s44, 12288
    buffer_load_dwordx4 v[176:179], v225, s[8:11], s50 offen offset:0
    buffer_load_dwordx4 v[180:183], v225, s[12:15], s50 offen offset:0
    s_add_u32 s50, s44, 12288
    buffer_load_dwordx4 v[184:187], v225, s[8:11], s50 offen offset:1024
    buffer_load_dwordx4 v[188:191], v225, s[12:15], s50 offen offset:1024
    s_add_u32 s50, s44, 32768
    buffer_load_dwordx4 v[192:195], v225, s[8:11], s50 offen offset:0
    buffer_load_dwordx4 v[196:199], v225, s[12:15], s50 offen offset:0
    s_add_u32 s50, s44, 32768
    buffer_load_dwordx4 v[200:203], v225, s[8:11], s50 offen offset:1024
    buffer_load_dwordx4 v[204:207], v225, s[12:15], s50 offen offset:1024
    s_add_u32 s50, s44, 53248
    buffer_load_dwordx4 v[208:211], v225, s[8:11], s50 offen offset:0
    buffer_load_dwordx4 v[212:215], v225, s[12:15], s50 offen offset:0
    s_add_u32 s50, s44, 53248
    buffer_load_dwordx4 v[216:219], v225, s[8:11], s50 offen offset:1024
    buffer_load_dwordx4 v[220:223], v225, s[12:15], s50 offen offset:1024
    ds_read_b64_tr_b16 v[128:129], v224 offset:384
    ds_read_b64_tr_b16 v[130:131], v224 offset:3200
    ds_read_b64_tr_b16 v[132:133], v224 offset:11648
    ds_read_b64_tr_b16 v[134:135], v224 offset:14464
    ds_read_b64_tr_b16 v[136:137], v224 offset:22912
    ds_read_b64_tr_b16 v[138:139], v224 offset:25728
    ds_read_b64_tr_b16 v[140:141], v224 offset:34176
    ds_read_b64_tr_b16 v[142:143], v224 offset:36992
    ds_read_b64_tr_b16 v[144:145], v226 offset:384
    ds_read_b64_tr_b16 v[146:147], v226 offset:3200
    ds_read_b64_tr_b16 v[148:149], v226 offset:11648
    ds_read_b64_tr_b16 v[150:151], v226 offset:14464
    ds_read_b64_tr_b16 v[152:153], v226 offset:22912
    ds_read_b64_tr_b16 v[154:155], v226 offset:25728
    ds_read_b64_tr_b16 v[156:157], v226 offset:34176
    ds_read_b64_tr_b16 v[158:159], v226 offset:36992
    s_waitcnt lgkmcnt(0)
    v_xor_b32 v160, 0x80008000, v144
    v_xor_b32 v161, 0x80008000, v145
    v_xor_b32 v162, 0x80008000, v146
    v_xor_b32 v163, 0x80008000, v147
    v_xor_b32 v164, 0x80008000, v148
    v_xor_b32 v165, 0x80008000, v149
    v_xor_b32 v166, 0x80008000, v150
    v_xor_b32 v167, 0x80008000, v151
    v_xor_b32 v168, 0x80008000, v152
    v_xor_b32 v169, 0x80008000, v153
    v_xor_b32 v170, 0x80008000, v154
    v_xor_b32 v171, 0x80008000, v155
    v_xor_b32 v172, 0x80008000, v156
    v_xor_b32 v173, 0x80008000, v157
    v_xor_b32 v174, 0x80008000, v158
    v_xor_b32 v175, 0x80008000, v159
    v_mfma_f32_32x32x16_bf16 v[48:63], v[128:131], v[16:19], 0
    v_mfma_f32_32x32x16_bf16 v[64:79], v[128:131], v[32:35], 0
    v_mfma_f32_32x32x16_bf16 v[48:63], v[132:135], v[20:23], v[48:63]
    v_mfma_f32_32x32x16_bf16 v[64:79], v[132:135], v[36:39], v[64:79]
    v_mfma_f32_32x32x16_bf16 v[48:63], v[136:139], v[24:27], v[48:63]
    v_mfma_f32_32x32x16_bf16 v[64:79], v[136:139], v[40:43], v[64:79]
    v_mfma_f32_32x32x16_bf16 v[48:63], v[140:143], v[28:31], v[48:63]
    v_mfma_f32_32x32x16_bf16 v[64:79], v[140:143], v[44:47], v[64:79]
    v_mfma_f32_32x32x16_bf16 v[48:63], v[160:163], v[32:35], v[48:63]
    v_mfma_f32_32x32x16_bf16 v[64:79], v[144:147], v[16:19], v[64:79]
    v_mfma_f32_32x32x16_bf16 v[48:63], v[164:167], v[36:39], v[48:63]
    v_mfma_f32_32x32x16_bf16 v[64:79], v[148:151], v[20:23], v[64:79]
    v_mfma_f32_32x32x16_bf16 v[48:63], v[168:171], v[40:43], v[48:63]
    v_mfma_f32_32x32x16_bf16 v[64:79], v[152:155], v[24:27], v[64:79]
    v_mfma_f32_32x32x16_bf16 v[48:63], v[172:175], v[44:47], v[48:63]
    v_mfma_f32_32x32x16_bf16 v[64:79], v[156:159], v[28:31], v[64:79]
    s_nop 15
    s_nop 3
    v_cvt_pk_bf16_f32 v48, v48, v49
    v_cvt_pk_bf16_f32 v49, v50, v51
    v_cvt_pk_bf16_f32 v50, v52, v53
    v_cvt_pk_bf16_f32 v51, v54, v55
    v_cvt_pk_bf16_f32 v56, v56, v57
    v_cvt_pk_bf16_f32 v57, v58, v59
    v_cvt_pk_bf16_f32 v58, v60, v61
    v_cvt_pk_bf16_f32 v59, v62, v63
    v_cvt_pk_bf16_f32 v64, v64, v65
    v_cvt_pk_bf16_f32 v65, v66, v67
    v_cvt_pk_bf16_f32 v66, v68, v69
    v_cvt_pk_bf16_f32 v67, v70, v71
    v_cvt_pk_bf16_f32 v72, v72, v73
    v_cvt_pk_bf16_f32 v73, v74, v75
    v_cvt_pk_bf16_f32 v74, v76, v77
    v_cvt_pk_bf16_f32 v75, v78, v79
    s_waitcnt vmcnt(0)
    s_nop 1
    v_mfma_f32_32x32x16_bf16 v[80:95], v[176:179], v[48:51], v[80:95]
    v_mfma_f32_32x32x16_bf16 v[80:95], v[180:183], v[64:67], v[80:95]
    v_mfma_f32_32x32x16_bf16 v[80:95], v[184:187], v[56:59], v[80:95]
    v_mfma_f32_32x32x16_bf16 v[80:95], v[188:191], v[72:75], v[80:95]
    v_mfma_f32_32x32x16_bf16 v[96:111], v[192:195], v[48:51], v[96:111]
    v_mfma_f32_32x32x16_bf16 v[96:111], v[196:199], v[64:67], v[96:111]
    v_mfma_f32_32x32x16_bf16 v[96:111], v[200:203], v[56:59], v[96:111]
    v_mfma_f32_32x32x16_bf16 v[96:111], v[204:207], v[72:75], v[96:111]
    v_mfma_f32_32x32x16_bf16 v[112:127], v[208:211], v[48:51], v[112:127]
    v_mfma_f32_32x32x16_bf16 v[112:127], v[212:215], v[64:67], v[112:127]
    v_mfma_f32_32x32x16_bf16 v[112:127], v[216:219], v[56:59], v[112:127]
    v_mfma_f32_32x32x16_bf16 v[112:127], v[220:223], v[72:75], v[112:127]
    s_add_u32 s50, s44, 14336
    buffer_load_dwordx4 v[176:179], v225, s[8:11], s50 offen offset:0
    buffer_load_dwordx4 v[180:183], v225, s[12:15], s50 offen offset:0
    s_add_u32 s50, s44, 14336
    buffer_load_dwordx4 v[184:187], v225, s[8:11], s50 offen offset:1024
    buffer_load_dwordx4 v[188:191], v225, s[12:15], s50 offen offset:1024
    s_add_u32 s50, s44, 34816
    buffer_load_dwordx4 v[192:195], v225, s[8:11], s50 offen offset:0
    buffer_load_dwordx4 v[196:199], v225, s[12:15], s50 offen offset:0
    s_add_u32 s50, s44, 34816
    buffer_load_dwordx4 v[200:203], v225, s[8:11], s50 offen offset:1024
    buffer_load_dwordx4 v[204:207], v225, s[12:15], s50 offen offset:1024
    s_add_u32 s50, s44, 55296
    buffer_load_dwordx4 v[208:211], v225, s[8:11], s50 offen offset:0
    buffer_load_dwordx4 v[212:215], v225, s[12:15], s50 offen offset:0
    s_add_u32 s50, s44, 55296
    buffer_load_dwordx4 v[216:219], v225, s[8:11], s50 offen offset:1024
    buffer_load_dwordx4 v[220:223], v225, s[12:15], s50 offen offset:1024
    ds_read_b64_tr_b16 v[128:129], v224 offset:448
    ds_read_b64_tr_b16 v[130:131], v224 offset:3264
    ds_read_b64_tr_b16 v[132:133], v224 offset:11712
    ds_read_b64_tr_b16 v[134:135], v224 offset:14528
    ds_read_b64_tr_b16 v[136:137], v224 offset:22976
    ds_read_b64_tr_b16 v[138:139], v224 offset:25792
    ds_read_b64_tr_b16 v[140:141], v224 offset:34240
    ds_read_b64_tr_b16 v[142:143], v224 offset:37056
    ds_read_b64_tr_b16 v[144:145], v226 offset:448
    ds_read_b64_tr_b16 v[146:147], v226 offset:3264
    ds_read_b64_tr_b16 v[148:149], v226 offset:11712
    ds_read_b64_tr_b16 v[150:151], v226 offset:14528
    ds_read_b64_tr_b16 v[152:153], v226 offset:22976
    ds_read_b64_tr_b16 v[154:155], v226 offset:25792
    ds_read_b64_tr_b16 v[156:157], v226 offset:34240
    ds_read_b64_tr_b16 v[158:159], v226 offset:37056
    s_waitcnt lgkmcnt(0)
    v_xor_b32 v160, 0x80008000, v144
    v_xor_b32 v161, 0x80008000, v145
    v_xor_b32 v162, 0x80008000, v146
    v_xor_b32 v163, 0x80008000, v147
    v_xor_b32 v164, 0x80008000, v148
    v_xor_b32 v165, 0x80008000, v149
    v_xor_b32 v166, 0x80008000, v150
    v_xor_b32 v167, 0x80008000, v151
    v_xor_b32 v168, 0x80008000, v152
    v_xor_b32 v169, 0x80008000, v153
    v_xor_b32 v170, 0x80008000, v154
    v_xor_b32 v171, 0x80008000, v155
    v_xor_b32 v172, 0x80008000, v156
    v_xor_b32 v173, 0x80008000, v157
    v_xor_b32 v174, 0x80008000, v158
    v_xor_b32 v175, 0x80008000, v159
    v_mfma_f32_32x32x16_bf16 v[48:63], v[128:131], v[16:19], 0
    v_mfma_f32_32x32x16_bf16 v[64:79], v[128:131], v[32:35], 0
    v_mfma_f32_32x32x16_bf16 v[48:63], v[132:135], v[20:23], v[48:63]
    v_mfma_f32_32x32x16_bf16 v[64:79], v[132:135], v[36:39], v[64:79]
    v_mfma_f32_32x32x16_bf16 v[48:63], v[136:139], v[24:27], v[48:63]
    v_mfma_f32_32x32x16_bf16 v[64:79], v[136:139], v[40:43], v[64:79]
    v_mfma_f32_32x32x16_bf16 v[48:63], v[140:143], v[28:31], v[48:63]
    v_mfma_f32_32x32x16_bf16 v[64:79], v[140:143], v[44:47], v[64:79]
    v_mfma_f32_32x32x16_bf16 v[48:63], v[160:163], v[32:35], v[48:63]
    v_mfma_f32_32x32x16_bf16 v[64:79], v[144:147], v[16:19], v[64:79]
    v_mfma_f32_32x32x16_bf16 v[48:63], v[164:167], v[36:39], v[48:63]
    v_mfma_f32_32x32x16_bf16 v[64:79], v[148:151], v[20:23], v[64:79]
    v_mfma_f32_32x32x16_bf16 v[48:63], v[168:171], v[40:43], v[48:63]
    v_mfma_f32_32x32x16_bf16 v[64:79], v[152:155], v[24:27], v[64:79]
    v_mfma_f32_32x32x16_bf16 v[48:63], v[172:175], v[44:47], v[48:63]
    v_mfma_f32_32x32x16_bf16 v[64:79], v[156:159], v[28:31], v[64:79]
    s_nop 15
    s_nop 3
    v_cvt_pk_bf16_f32 v48, v48, v49
    v_cvt_pk_bf16_f32 v49, v50, v51
    v_cvt_pk_bf16_f32 v50, v52, v53
    v_cvt_pk_bf16_f32 v51, v54, v55
    v_cvt_pk_bf16_f32 v56, v56, v57
    v_cvt_pk_bf16_f32 v57, v58, v59
    v_cvt_pk_bf16_f32 v58, v60, v61
    v_cvt_pk_bf16_f32 v59, v62, v63
    v_cvt_pk_bf16_f32 v64, v64, v65
    v_cvt_pk_bf16_f32 v65, v66, v67
    v_cvt_pk_bf16_f32 v66, v68, v69
    v_cvt_pk_bf16_f32 v67, v70, v71
    v_cvt_pk_bf16_f32 v72, v72, v73
    v_cvt_pk_bf16_f32 v73, v74, v75
    v_cvt_pk_bf16_f32 v74, v76, v77
    v_cvt_pk_bf16_f32 v75, v78, v79
    s_waitcnt vmcnt(0)
    s_nop 1
    v_mfma_f32_32x32x16_bf16 v[80:95], v[176:179], v[48:51], v[80:95]
    v_mfma_f32_32x32x16_bf16 v[80:95], v[180:183], v[64:67], v[80:95]
    v_mfma_f32_32x32x16_bf16 v[80:95], v[184:187], v[56:59], v[80:95]
    v_mfma_f32_32x32x16_bf16 v[80:95], v[188:191], v[72:75], v[80:95]
    v_mfma_f32_32x32x16_bf16 v[96:111], v[192:195], v[48:51], v[96:111]
    v_mfma_f32_32x32x16_bf16 v[96:111], v[196:199], v[64:67], v[96:111]
    v_mfma_f32_32x32x16_bf16 v[96:111], v[200:203], v[56:59], v[96:111]
    v_mfma_f32_32x32x16_bf16 v[96:111], v[204:207], v[72:75], v[96:111]
    v_mfma_f32_32x32x16_bf16 v[112:127], v[208:211], v[48:51], v[112:127]
    v_mfma_f32_32x32x16_bf16 v[112:127], v[212:215], v[64:67], v[112:127]
    v_mfma_f32_32x32x16_bf16 v[112:127], v[216:219], v[56:59], v[112:127]
    v_mfma_f32_32x32x16_bf16 v[112:127], v[220:223], v[72:75], v[112:127]
    s_add_u32 s50, s44, 16384
    buffer_load_dwordx4 v[176:179], v225, s[8:11], s50 offen offset:0
    buffer_load_dwordx4 v[180:183], v225, s[12:15], s50 offen offset:0
    s_add_u32 s50, s44, 16384
    buffer_load_dwordx4 v[184:187], v225, s[8:11], s50 offen offset:1024
    buffer_load_dwordx4 v[188:191], v225, s[12:15], s50 offen offset:1024
    s_add_u32 s50, s44, 36864
    buffer_load_dwordx4 v[192:195], v225, s[8:11], s50 offen offset:0
    buffer_load_dwordx4 v[196:199], v225, s[12:15], s50 offen offset:0
    s_add_u32 s50, s44, 36864
    buffer_load_dwordx4 v[200:203], v225, s[8:11], s50 offen offset:1024
    buffer_load_dwordx4 v[204:207], v225, s[12:15], s50 offen offset:1024
    s_add_u32 s50, s44, 57344
    buffer_load_dwordx4 v[208:211], v225, s[8:11], s50 offen offset:0
    buffer_load_dwordx4 v[212:215], v225, s[12:15], s50 offen offset:0
    s_add_u32 s50, s44, 57344
    buffer_load_dwordx4 v[216:219], v225, s[8:11], s50 offen offset:1024
    buffer_load_dwordx4 v[220:223], v225, s[12:15], s50 offen offset:1024
    ds_read_b64_tr_b16 v[128:129], v224 offset:512
    ds_read_b64_tr_b16 v[130:131], v224 offset:3328
    ds_read_b64_tr_b16 v[132:133], v224 offset:11776
    ds_read_b64_tr_b16 v[134:135], v224 offset:14592
    ds_read_b64_tr_b16 v[136:137], v224 offset:23040
    ds_read_b64_tr_b16 v[138:139], v224 offset:25856
    ds_read_b64_tr_b16 v[140:141], v224 offset:34304
    ds_read_b64_tr_b16 v[142:143], v224 offset:37120
    ds_read_b64_tr_b16 v[144:145], v226 offset:512
    ds_read_b64_tr_b16 v[146:147], v226 offset:3328
    ds_read_b64_tr_b16 v[148:149], v226 offset:11776
    ds_read_b64_tr_b16 v[150:151], v226 offset:14592
    ds_read_b64_tr_b16 v[152:153], v226 offset:23040
    ds_read_b64_tr_b16 v[154:155], v226 offset:25856
    ds_read_b64_tr_b16 v[156:157], v226 offset:34304
    ds_read_b64_tr_b16 v[158:159], v226 offset:37120
    s_waitcnt lgkmcnt(0)
    v_xor_b32 v160, 0x80008000, v144
    v_xor_b32 v161, 0x80008000, v145
    v_xor_b32 v162, 0x80008000, v146
    v_xor_b32 v163, 0x80008000, v147
    v_xor_b32 v164, 0x80008000, v148
    v_xor_b32 v165, 0x80008000, v149
    v_xor_b32 v166, 0x80008000, v150
    v_xor_b32 v167, 0x80008000, v151
    v_xor_b32 v168, 0x80008000, v152
    v_xor_b32 v169, 0x80008000, v153
    v_xor_b32 v170, 0x80008000, v154
    v_xor_b32 v171, 0x80008000, v155
    v_xor_b32 v172, 0x80008000, v156
    v_xor_b32 v173, 0x80008000, v157
    v_xor_b32 v174, 0x80008000, v158
    v_xor_b32 v175, 0x80008000, v159
    v_mfma_f32_32x32x16_bf16 v[48:63], v[128:131], v[16:19], 0
    v_mfma_f32_32x32x16_bf16 v[64:79], v[128:131], v[32:35], 0
    v_mfma_f32_32x32x16_bf16 v[48:63], v[132:135], v[20:23], v[48:63]
    v_mfma_f32_32x32x16_bf16 v[64:79], v[132:135], v[36:39], v[64:79]
    v_mfma_f32_32x32x16_bf16 v[48:63], v[136:139], v[24:27], v[48:63]
    v_mfma_f32_32x32x16_bf16 v[64:79], v[136:139], v[40:43], v[64:79]
    v_mfma_f32_32x32x16_bf16 v[48:63], v[140:143], v[28:31], v[48:63]
    v_mfma_f32_32x32x16_bf16 v[64:79], v[140:143], v[44:47], v[64:79]
    v_mfma_f32_32x32x16_bf16 v[48:63], v[160:163], v[32:35], v[48:63]
    v_mfma_f32_32x32x16_bf16 v[64:79], v[144:147], v[16:19], v[64:79]
    v_mfma_f32_32x32x16_bf16 v[48:63], v[164:167], v[36:39], v[48:63]
    v_mfma_f32_32x32x16_bf16 v[64:79], v[148:151], v[20:23], v[64:79]
    v_mfma_f32_32x32x16_bf16 v[48:63], v[168:171], v[40:43], v[48:63]
    v_mfma_f32_32x32x16_bf16 v[64:79], v[152:155], v[24:27], v[64:79]
    v_mfma_f32_32x32x16_bf16 v[48:63], v[172:175], v[44:47], v[48:63]
    v_mfma_f32_32x32x16_bf16 v[64:79], v[156:159], v[28:31], v[64:79]
    s_nop 15
    s_nop 3
    v_cvt_pk_bf16_f32 v48, v48, v49
    v_cvt_pk_bf16_f32 v49, v50, v51
    v_cvt_pk_bf16_f32 v50, v52, v53
    v_cvt_pk_bf16_f32 v51, v54, v55
    v_cvt_pk_bf16_f32 v56, v56, v57
    v_cvt_pk_bf16_f32 v57, v58, v59
    v_cvt_pk_bf16_f32 v58, v60, v61
    v_cvt_pk_bf16_f32 v59, v62, v63
    v_cvt_pk_bf16_f32 v64, v64, v65
    v_cvt_pk_bf16_f32 v65, v66, v67
    v_cvt_pk_bf16_f32 v66, v68, v69
    v_cvt_pk_bf16_f32 v67, v70, v71
    v_cvt_pk_bf16_f32 v72, v72, v73
    v_cvt_pk_bf16_f32 v73, v74, v75
    v_cvt_pk_bf16_f32 v74, v76, v77
    v_cvt_pk_bf16_f32 v75, v78, v79
    s_waitcnt vmcnt(0)
    s_nop 1
    v_mfma_f32_32x32x16_bf16 v[80:95], v[176:179], v[48:51], v[80:95]
    v_mfma_f32_32x32x16_bf16 v[80:95], v[180:183], v[64:67], v[80:95]
    v_mfma_f32_32x32x16_bf16 v[80:95], v[184:187], v[56:59], v[80:95]
    v_mfma_f32_32x32x16_bf16 v[80:95], v[188:191], v[72:75], v[80:95]
    v_mfma_f32_32x32x16_bf16 v[96:111], v[192:195], v[48:51], v[96:111]
    v_mfma_f32_32x32x16_bf16 v[96:111], v[196:199], v[64:67], v[96:111]
    v_mfma_f32_32x32x16_bf16 v[96:111], v[200:203], v[56:59], v[96:111]
    v_mfma_f32_32x32x16_bf16 v[96:111], v[204:207], v[72:75], v[96:111]
    v_mfma_f32_32x32x16_bf16 v[112:127], v[208:211], v[48:51], v[112:127]
    v_mfma_f32_32x32x16_bf16 v[112:127], v[212:215], v[64:67], v[112:127]
    v_mfma_f32_32x32x16_bf16 v[112:127], v[216:219], v[56:59], v[112:127]
    v_mfma_f32_32x32x16_bf16 v[112:127], v[220:223], v[72:75], v[112:127]
    s_add_u32 s50, s44, 18432
    buffer_load_dwordx4 v[176:179], v225, s[8:11], s50 offen offset:0
    buffer_load_dwordx4 v[180:183], v225, s[12:15], s50 offen offset:0
    s_add_u32 s50, s44, 18432
    buffer_load_dwordx4 v[184:187], v225, s[8:11], s50 offen offset:1024
    buffer_load_dwordx4 v[188:191], v225, s[12:15], s50 offen offset:1024
    s_add_u32 s50, s44, 38912
    buffer_load_dwordx4 v[192:195], v225, s[8:11], s50 offen offset:0
    buffer_load_dwordx4 v[196:199], v225, s[12:15], s50 offen offset:0
    s_add_u32 s50, s44, 38912
    buffer_load_dwordx4 v[200:203], v225, s[8:11], s50 offen offset:1024
    buffer_load_dwordx4 v[204:207], v225, s[12:15], s50 offen offset:1024
    s_add_u32 s50, s44, 59392
    buffer_load_dwordx4 v[208:211], v225, s[8:11], s50 offen offset:0
    buffer_load_dwordx4 v[212:215], v225, s[12:15], s50 offen offset:0
    s_add_u32 s50, s44, 59392
    buffer_load_dwordx4 v[216:219], v225, s[8:11], s50 offen offset:1024
    buffer_load_dwordx4 v[220:223], v225, s[12:15], s50 offen offset:1024
    ds_read_b64_tr_b16 v[128:129], v224 offset:576
    ds_read_b64_tr_b16 v[130:131], v224 offset:3392
    ds_read_b64_tr_b16 v[132:133], v224 offset:11840
    ds_read_b64_tr_b16 v[134:135], v224 offset:14656
    ds_read_b64_tr_b16 v[136:137], v224 offset:23104
    ds_read_b64_tr_b16 v[138:139], v224 offset:25920
    ds_read_b64_tr_b16 v[140:141], v224 offset:34368
    ds_read_b64_tr_b16 v[142:143], v224 offset:37184
    ds_read_b64_tr_b16 v[144:145], v226 offset:576
    ds_read_b64_tr_b16 v[146:147], v226 offset:3392
    ds_read_b64_tr_b16 v[148:149], v226 offset:11840
    ds_read_b64_tr_b16 v[150:151], v226 offset:14656
    ds_read_b64_tr_b16 v[152:153], v226 offset:23104
    ds_read_b64_tr_b16 v[154:155], v226 offset:25920
    ds_read_b64_tr_b16 v[156:157], v226 offset:34368
    ds_read_b64_tr_b16 v[158:159], v226 offset:37184
    s_waitcnt lgkmcnt(0)
    v_xor_b32 v160, 0x80008000, v144
    v_xor_b32 v161, 0x80008000, v145
    v_xor_b32 v162, 0x80008000, v146
    v_xor_b32 v163, 0x80008000, v147
    v_xor_b32 v164, 0x80008000, v148
    v_xor_b32 v165, 0x80008000, v149
    v_xor_b32 v166, 0x80008000, v150
    v_xor_b32 v167, 0x80008000, v151
    v_xor_b32 v168, 0x80008000, v152
    v_xor_b32 v169, 0x80008000, v153
    v_xor_b32 v170, 0x80008000, v154
    v_xor_b32 v171, 0x80008000, v155
    v_xor_b32 v172, 0x80008000, v156
    v_xor_b32 v173, 0x80008000, v157
    v_xor_b32 v174, 0x80008000, v158
    v_xor_b32 v175, 0x80008000, v159
    v_mfma_f32_32x32x16_bf16 v[48:63], v[128:131], v[16:19], 0
    v_mfma_f32_32x32x16_bf16 v[64:79], v[128:131], v[32:35], 0
    v_mfma_f32_32x32x16_bf16 v[48:63], v[132:135], v[20:23], v[48:63]
    v_mfma_f32_32x32x16_bf16 v[64:79], v[132:135], v[36:39], v[64:79]
    v_mfma_f32_32x32x16_bf16 v[48:63], v[136:139], v[24:27], v[48:63]
    v_mfma_f32_32x32x16_bf16 v[64:79], v[136:139], v[40:43], v[64:79]
    v_mfma_f32_32x32x16_bf16 v[48:63], v[140:143], v[28:31], v[48:63]
    v_mfma_f32_32x32x16_bf16 v[64:79], v[140:143], v[44:47], v[64:79]
    v_mfma_f32_32x32x16_bf16 v[48:63], v[160:163], v[32:35], v[48:63]
    v_mfma_f32_32x32x16_bf16 v[64:79], v[144:147], v[16:19], v[64:79]
    v_mfma_f32_32x32x16_bf16 v[48:63], v[164:167], v[36:39], v[48:63]
    v_mfma_f32_32x32x16_bf16 v[64:79], v[148:151], v[20:23], v[64:79]
    v_mfma_f32_32x32x16_bf16 v[48:63], v[168:171], v[40:43], v[48:63]
    v_mfma_f32_32x32x16_bf16 v[64:79], v[152:155], v[24:27], v[64:79]
    v_mfma_f32_32x32x16_bf16 v[48:63], v[172:175], v[44:47], v[48:63]
    v_mfma_f32_32x32x16_bf16 v[64:79], v[156:159], v[28:31], v[64:79]
    s_nop 15
    s_nop 3
    v_cvt_pk_bf16_f32 v48, v48, v49
    v_cvt_pk_bf16_f32 v49, v50, v51
    v_cvt_pk_bf16_f32 v50, v52, v53
    v_cvt_pk_bf16_f32 v51, v54, v55
    v_cvt_pk_bf16_f32 v56, v56, v57
    v_cvt_pk_bf16_f32 v57, v58, v59
    v_cvt_pk_bf16_f32 v58, v60, v61
    v_cvt_pk_bf16_f32 v59, v62, v63
    v_cvt_pk_bf16_f32 v64, v64, v65
    v_cvt_pk_bf16_f32 v65, v66, v67
    v_cvt_pk_bf16_f32 v66, v68, v69
    v_cvt_pk_bf16_f32 v67, v70, v71
    v_cvt_pk_bf16_f32 v72, v72, v73
    v_cvt_pk_bf16_f32 v73, v74, v75
    v_cvt_pk_bf16_f32 v74, v76, v77
    v_cvt_pk_bf16_f32 v75, v78, v79
    s_waitcnt vmcnt(0)
    s_nop 1
    v_mfma_f32_32x32x16_bf16 v[80:95], v[176:179], v[48:51], v[80:95]
    v_mfma_f32_32x32x16_bf16 v[80:95], v[180:183], v[64:67], v[80:95]
    v_mfma_f32_32x32x16_bf16 v[80:95], v[184:187], v[56:59], v[80:95]
    v_mfma_f32_32x32x16_bf16 v[80:95], v[188:191], v[72:75], v[80:95]
    v_mfma_f32_32x32x16_bf16 v[96:111], v[192:195], v[48:51], v[96:111]
    v_mfma_f32_32x32x16_bf16 v[96:111], v[196:199], v[64:67], v[96:111]
    v_mfma_f32_32x32x16_bf16 v[96:111], v[200:203], v[56:59], v[96:111]
    v_mfma_f32_32x32x16_bf16 v[96:111], v[204:207], v[72:75], v[96:111]
    v_mfma_f32_32x32x16_bf16 v[112:127], v[208:211], v[48:51], v[112:127]
    v_mfma_f32_32x32x16_bf16 v[112:127], v[212:215], v[64:67], v[112:127]
    v_mfma_f32_32x32x16_bf16 v[112:127], v[216:219], v[56:59], v[112:127]
    v_mfma_f32_32x32x16_bf16 v[112:127], v[220:223], v[72:75], v[112:127]
    s_nop 15
    s_nop 3
    v_mul_u32_u24 v2, 2304, v5
    s_mul_i32 s50, s40, 192
    s_add_u32 s50, s50, 1152
    v_add_u32 v2, s50, v2
    v_lshl_add_u32 v2, v4, 4, v2
    v_cvt_pk_bf16_f32 v80, v80, v81
    v_cvt_pk_bf16_f32 v81, v82, v83
    v_cvt_pk_bf16_f32 v82, v84, v85
    v_cvt_pk_bf16_f32 v83, v86, v87
    v_cvt_pk_bf16_f32 v88, v88, v89
    v_cvt_pk_bf16_f32 v89, v90, v91
    v_cvt_pk_bf16_f32 v90, v92, v93
    v_cvt_pk_bf16_f32 v91, v94, v95
    s_nop 1
    v_permlane32_swap_b32 v80, v82
    v_permlane32_swap_b32 v81, v83
    v_permlane32_swap_b32 v88, v90
    v_permlane32_swap_b32 v89, v91
    buffer_store_dwordx4 v[80:83], v2, s[16:19], 0 offen offset:0
    buffer_store_dwordx4 v[88:91], v2, s[16:19], 0 offen offset:32
    v_cvt_pk_bf16_f32 v96, v96, v97
    v_cvt_pk_bf16_f32 v97, v98, v99
    v_cvt_pk_bf16_f32 v98, v100, v101
    v_cvt_pk_bf16_f32 v99, v102, v103
    v_cvt_pk_bf16_f32 v104, v104, v105
    v_cvt_pk_bf16_f32 v105, v106, v107
    v_cvt_pk_bf16_f32 v106, v108, v109
    v_cvt_pk_bf16_f32 v107, v110, v111
    s_nop 1
    v_permlane32_swap_b32 v96, v98
    v_permlane32_swap_b32 v97, v99
    v_permlane32_swap_b32 v104, v106
    v_permlane32_swap_b32 v105, v107
    buffer_store_dwordx4 v[96:99], v2, s[16:19], 0 offen offset:64
    buffer_store_dwordx4 v[104:107], v2, s[16:19], 0 offen offset:96
    v_cvt_pk_bf16_f32 v112, v112, v113
    v_cvt_pk_bf16_f32 v113, v114, v115
    v_cvt_pk_bf16_f32 v114, v116, v117
    v_cvt_pk_bf16_f32 v115, v118, v119
    v_cvt_pk_bf16_f32 v120, v120, v121
    v_cvt_pk_bf16_f32 v121, v122, v123
    v_cvt_pk_bf16_f32 v122, v124, v125
    v_cvt_pk_bf16_f32 v123, v126, v127
    s_nop 1
    v_permlane32_swap_b32 v112, v114
    v_permlane32_swap_b32 v113, v115
    v_permlane32_swap_b32 v120, v122
    v_permlane32_swap_b32 v121, v123
    buffer_store_dwordx4 v[112:115], v2, s[16:19], 0 offen offset:128
    buffer_store_dwordx4 v[120:123], v2, s[16:19], 0 offen offset:160
L_b3_end_oproj_kernel_1:
L_op_end:
    s_endpgm
.section .rodata,"a"
.p2align 6
.amdhsa_kernel oproj_kernel
  .amdhsa_next_free_vgpr 256
  .amdhsa_next_free_sgpr 100
  .amdhsa_accum_offset 256
  .amdhsa_group_segment_fixed_size 0
  .amdhsa_kernarg_size 96
  .amdhsa_user_sgpr_count 2
  .amdhsa_user_sgpr_kernarg_segment_ptr 1
  .amdhsa_system_sgpr_workgroup_id_x 1
.end_amdhsa_kernel
.text
```
